```python
import torch

def _softmax(x, axis=-1):
    return torch.softmax(x, dim=axis)
def _gelu(x):
    return torch.nn.functional.gelu(x, approximate="tanh")
def _silu(x):
    return torch.nn.functional.silu(x)
def _sigmoid(x):
    return torch.sigmoid(x)
def _layernorm(x, axis=-1, eps=1e-5):
    m = x.mean(dim=axis, keepdim=True)
    v = x.var(dim=axis, keepdim=True, unbiased=False)
    return (x - m) / torch.sqrt(v + eps)
def _scatter_add(tgt, idx, src, axis=0):
    return tgt.clone().index_add_(axis, idx, src)
def _segment_sum(src, seg, n):
    out = torch.zeros((n,) + src.shape[1:], dtype=src.dtype)
    return out.index_add_(0, seg, src)
def _pad(x, pw):
    flat = tuple(v for pair in reversed(pw) for v in pair)
    return torch.nn.functional.pad(x, flat)

kernel_name = 'standalone__mha_softmax__near_ridge'

def setup_inputs():

    _w = (lambda a: (lambda t: t.to(torch.bfloat16) if t.is_floating_point() else t)(torch.as_tensor(a)))
    B, H, Sq, Sk, D = 8, 32, 496, 1024, 128
    return {
        "q": _w((lambda *s: torch.randn(*s, dtype=torch.bfloat16) * 0.8)(B, H, Sq, D)),
        "k": _w((lambda *s: torch.randn(*s, dtype=torch.bfloat16) * 0.8)(B, H, Sk, D)),
        "v": _w((lambda *s: torch.randn(*s, dtype=torch.bfloat16) * 0.05)(B, H, Sk, D)),
    }

def reference(q, k, v):
    scale = q.shape[-1] ** -0.5
    scores = torch.einsum("bhqd,bhkd->bhqk", q, k) * scale
    p = _softmax(scores, axis=-1)
    return torch.einsum("bhqk,bhkd->bhqd", p, v)
```

```asm
; @launch grid=(256,1,1) block=(256,1,1) lds=143424
.amdgcn_target "amdgcn-amd-amdhsa--gfx950"
.text
.globl standalone__mha_softmax__near_ridge_kernel
.p2align 8
.type standalone__mha_softmax__near_ridge_kernel,@function
standalone__mha_softmax__near_ridge_kernel:
    s_load_dwordx8 s[4:11], s[0:1], 0
    s_cmpk_ge_u32 s2, 0x100
    s_cbranch_scc1 L_end
    s_getpc_b64 s[52:53]
L_pc:
    s_bfe_u32 s50, s2, 0x30003
    s_lshl_b32 s50, s50, 13
    v_lshl_add_u32 v30, v0, 5, s50
    v_min_u32 v30, L_end - L_pc, v30
    v_add_co_u32 v30, vcc, s52, v30
    v_mov_b32 v31, s53
    v_lshrrev_b32 v1, 6, v0
    v_addc_co_u32 v31, vcc, 0, v31, vcc
    global_load_dword v29, v[30:31], off
    s_mov_b32 s40, 0
    v_readfirstlane_b32 s28, v1
    s_movk_i32 s41, 16896
    s_mov_b32 s18, 262144
    s_mov_b32 s19, 0x20000
    s_mov_b32 s14, 126976
    s_mov_b32 s15, s19
    s_mul_i32 s50, s2, s14
    s_lshl_b32 s51, s2, 18
    s_and_b32 s42, s28, 2
    s_add_u32 s42, s42, s28
    s_add_u32 s42, s42, 2
    s_mul_i32 s42, s42, s41
L_restart:
    v_mbcnt_lo_u32_b32 v2, -1, 0
    v_mbcnt_hi_u32_b32 v2, -1, v2
    s_lshl_b32 s37, s28, 15
    v_lshlrev_b32 v122, 4, v2
    v_lshrrev_b32 v5, 4, v2
    v_and_b32 v9, 15, v2
    v_lshlrev_b32 v119, 4, v9
    v_lshl_add_u32 v119, v5, 11, v119
    v_add_u32 v119, s37, v119
    s_lshl_b32 s54, s28, 11
    s_mul_i32 s45, s28, 2112
    s_movk_i32 s53, 1056
    s_mov_b32 s52, 0
    s_add_u32 m0, s45, 0
    s_waitcnt lgkmcnt(0)
    s_add_u32 s16, s6, s51
    s_addc_u32 s17, s7, 0
    buffer_load_dwordx4 v122, s[16:19], s54 offen offset:0 nt lds
    s_add_u32 m0, s45, 32
    s_add_u32 s12, s4, s50
    s_addc_u32 s13, s5, 0
    buffer_load_dwordx4 v122, s[16:19], s54 offen offset:1024 nt lds
    s_sub_u32 m0, s42, s53
L_q01:
    s_add_u32 m0, m0, s53
    s_cmpk_eq_u32 s52, 0x800
    s_cselect_b32 s52, 0x2000, s52
    buffer_load_dwordx4 v119, s[12:15], s52 offen offset:0 nt lds
    s_addk_i32 s52, 0x100
    s_cmpk_lg_u32 s52, 0x2800
    s_cbranch_scc1 L_q01
    v_add_u32 v119, 16384, v119
    s_mov_b32 s34, 0x3e0293ee
    s_mov_b32 s35, 0x3e0293ee
    s_mov_b32 s22, 262144
    s_mov_b32 s23, 0x20000
    s_mov_b32 s26, 126976
    s_mov_b32 s27, 0x20000
    s_add_u32 s20, s8, s51
    s_addc_u32 s21, s9, 0
    s_add_u32 s24, s10, s50
    s_addc_u32 s25, s11, 0
    s_mov_b32 s36, 1056
    v_and_b32 v3, 7, v2
    v_mul_lo_u32 v120, v3, s36
    v_bfe_u32 v4, v2, 3, 1
    v_lshl_add_u32 v120, v4, 8, v120
    v_lshl_add_u32 v120, v5, 4, v120
    v_bfe_u32 v6, v2, 2, 3
    v_mul_lo_u32 v121, v6, s36
    v_lshrrev_b32 v7, 5, v2
    v_lshl_add_u32 v121, v7, 8, v121
    v_and_b32 v8, 3, v2
    v_lshl_add_u32 v121, v8, 3, v121
    v_add_u32 v121, 67584, v121
    s_and_b32 s39, s28, 1
    s_lshr_b32 s37, s28, 1
    s_lshl_b32 s37, s37, 2
    s_add_u32 s37, s37, s39
    s_mul_i32 s37, s37, s41
    s_movk_i32 s39, 272
    v_mul_lo_u32 v123, v9, s39
    v_lshl_add_u32 v123, v5, 3, v123
    v_add_u32 v123, s37, v123
    v_lshl_add_u32 v124, v5, 4, v122
    v_add_u32 v124, s37, v124
    s_lshl_b32 s39, s28, 15
    s_mov_b64 s[48:49], 0
    v_mov_b32 v11, 143360
    v_mov_b32 v12, 0
    ds_write_b32 v11, v12 offset:0
    s_add_u32 s55, s54, 8192
    s_lshl_b32 s30, s28, 12
    s_add_u32 s30, s30, 16384
    s_mul_i32 s31, s28, 4224
    s_add_u32 s32, s31, 84480
    s_add_u32 s31, s31, 16896
    v_mov_b32 v80, 0
    v_mov_b32 v81, 0
    v_mov_b32 v82, 0
    v_mov_b32 v83, 0
    v_mov_b32 v84, 0
    v_mov_b32 v85, 0
    v_mov_b32 v86, 0
    v_mov_b32 v87, 0
    s_waitcnt vmcnt(16) lgkmcnt(0)
    s_barrier
    ds_read_b128 a[128:131], v120 offset:0
    ds_read_b128 a[132:135], v120 offset:64
    ds_read_b128 a[136:139], v120 offset:128
    ds_read_b128 a[140:143], v120 offset:192
    ds_read_b128 a[144:147], v120 offset:512
    ds_read_b128 a[148:151], v120 offset:576
    ds_read_b128 a[152:155], v120 offset:640
    ds_read_b128 a[156:159], v120 offset:704
    s_waitcnt vmcnt(8)
    v_add_u32 v65, s42, v120
    ds_read_b128 v[128:131], v65 offset:0
    ds_read_b128 v[132:135], v65 offset:64
    ds_read_b128 v[136:139], v65 offset:128
    ds_read_b128 v[140:143], v65 offset:192
    ds_read_b128 v[144:147], v65 offset:512
    ds_read_b128 v[148:151], v65 offset:576
    ds_read_b128 v[152:155], v65 offset:640
    ds_read_b128 v[156:159], v65 offset:704
    s_add_u32 m0, s45, 67584
    s_nop 0
    buffer_load_dwordx4 v122, s[20:23], s54 offen offset:0 nt lds
    s_add_u32 m0, s45, 67616
    s_nop 0
    buffer_load_dwordx4 v122, s[20:23], s54 offen offset:1024 nt lds
    s_waitcnt lgkmcnt(0)
    s_add_u32 m0, s42, 0
    v_lshlrev_b32 v40, 16, v128
    buffer_load_dwordx4 v119, s[12:15], 0 offen offset:0 nt lds
    v_and_b32 v41, 0xffff0000, v128
    v_lshlrev_b32 v42, 16, v129
    v_and_b32 v43, 0xffff0000, v129
    v_lshlrev_b32 v44, 16, v130
    v_and_b32 v45, 0xffff0000, v130
    v_lshlrev_b32 v46, 16, v131
    v_and_b32 v47, 0xffff0000, v131
    v_pk_mul_f32 v[40:41], v[40:41], s[34:35]
    v_pk_mul_f32 v[42:43], v[42:43], s[34:35]
    v_pk_mul_f32 v[44:45], v[44:45], s[34:35]
    v_pk_mul_f32 v[46:47], v[46:47], s[34:35]
    v_cvt_pk_bf16_f32 v128, v40, v41
    v_cvt_pk_bf16_f32 v129, v42, v43
    v_cvt_pk_bf16_f32 v130, v44, v45
    v_cvt_pk_bf16_f32 v131, v46, v47
    v_lshlrev_b32 v40, 16, v132
    v_and_b32 v41, 0xffff0000, v132
    v_lshlrev_b32 v42, 16, v133
    v_and_b32 v43, 0xffff0000, v133
    v_lshlrev_b32 v44, 16, v134
    v_and_b32 v45, 0xffff0000, v134
    v_lshlrev_b32 v46, 16, v135
    v_and_b32 v47, 0xffff0000, v135
    v_pk_mul_f32 v[40:41], v[40:41], s[34:35]
    v_pk_mul_f32 v[42:43], v[42:43], s[34:35]
    v_pk_mul_f32 v[44:45], v[44:45], s[34:35]
    v_pk_mul_f32 v[46:47], v[46:47], s[34:35]
    v_cvt_pk_bf16_f32 v132, v40, v41
    v_cvt_pk_bf16_f32 v133, v42, v43
    v_cvt_pk_bf16_f32 v134, v44, v45
    v_cvt_pk_bf16_f32 v135, v46, v47
    v_lshlrev_b32 v40, 16, v136
    v_and_b32 v41, 0xffff0000, v136
    v_lshlrev_b32 v42, 16, v137
    v_and_b32 v43, 0xffff0000, v137
    v_lshlrev_b32 v44, 16, v138
    v_and_b32 v45, 0xffff0000, v138
    v_lshlrev_b32 v46, 16, v139
    v_and_b32 v47, 0xffff0000, v139
    v_pk_mul_f32 v[40:41], v[40:41], s[34:35]
    v_pk_mul_f32 v[42:43], v[42:43], s[34:35]
    s_add_u32 m0, s42, 800
    v_pk_mul_f32 v[44:45], v[44:45], s[34:35]
    buffer_load_dwordx4 v119, s[12:15], 0 offen offset:256 nt lds
    v_pk_mul_f32 v[46:47], v[46:47], s[34:35]
    v_cvt_pk_bf16_f32 v136, v40, v41
    v_cvt_pk_bf16_f32 v137, v42, v43
    v_cvt_pk_bf16_f32 v138, v44, v45
    v_cvt_pk_bf16_f32 v139, v46, v47
    v_lshlrev_b32 v40, 16, v140
    v_and_b32 v41, 0xffff0000, v140
    v_lshlrev_b32 v42, 16, v141
    v_and_b32 v43, 0xffff0000, v141
    v_lshlrev_b32 v44, 16, v142
    v_and_b32 v45, 0xffff0000, v142
    v_lshlrev_b32 v46, 16, v143
    v_and_b32 v47, 0xffff0000, v143
    v_pk_mul_f32 v[40:41], v[40:41], s[34:35]
    v_pk_mul_f32 v[42:43], v[42:43], s[34:35]
    v_pk_mul_f32 v[44:45], v[44:45], s[34:35]
    v_pk_mul_f32 v[46:47], v[46:47], s[34:35]
    v_cvt_pk_bf16_f32 v140, v40, v41
    v_cvt_pk_bf16_f32 v141, v42, v43
    v_cvt_pk_bf16_f32 v142, v44, v45
    v_cvt_pk_bf16_f32 v143, v46, v47
    v_lshlrev_b32 v40, 16, v144
    v_and_b32 v41, 0xffff0000, v144
    v_lshlrev_b32 v42, 16, v145
    v_and_b32 v43, 0xffff0000, v145
    v_lshlrev_b32 v44, 16, v146
    v_and_b32 v45, 0xffff0000, v146
    v_lshlrev_b32 v46, 16, v147
    v_and_b32 v47, 0xffff0000, v147
    v_pk_mul_f32 v[40:41], v[40:41], s[34:35]
    v_pk_mul_f32 v[42:43], v[42:43], s[34:35]
    v_pk_mul_f32 v[44:45], v[44:45], s[34:35]
    v_pk_mul_f32 v[46:47], v[46:47], s[34:35]
    v_cvt_pk_bf16_f32 v144, v40, v41
    v_cvt_pk_bf16_f32 v145, v42, v43
    v_cvt_pk_bf16_f32 v146, v44, v45
    v_cvt_pk_bf16_f32 v147, v46, v47
    v_lshlrev_b32 v40, 16, v148
    v_and_b32 v41, 0xffff0000, v148
    v_lshlrev_b32 v42, 16, v149
    v_and_b32 v43, 0xffff0000, v149
    s_add_u32 m0, s42, 1600
    v_lshlrev_b32 v44, 16, v150
    buffer_load_dwordx4 v119, s[12:15], 0 offen offset:512 nt lds
    v_and_b32 v45, 0xffff0000, v150
    v_lshlrev_b32 v46, 16, v151
    v_and_b32 v47, 0xffff0000, v151
    v_pk_mul_f32 v[40:41], v[40:41], s[34:35]
    v_pk_mul_f32 v[42:43], v[42:43], s[34:35]
    v_pk_mul_f32 v[44:45], v[44:45], s[34:35]
    v_pk_mul_f32 v[46:47], v[46:47], s[34:35]
    v_cvt_pk_bf16_f32 v148, v40, v41
    v_cvt_pk_bf16_f32 v149, v42, v43
    v_cvt_pk_bf16_f32 v150, v44, v45
    v_cvt_pk_bf16_f32 v151, v46, v47
    v_lshlrev_b32 v40, 16, v152
    v_and_b32 v41, 0xffff0000, v152
    v_lshlrev_b32 v42, 16, v153
    v_and_b32 v43, 0xffff0000, v153
    v_lshlrev_b32 v44, 16, v154
    v_and_b32 v45, 0xffff0000, v154
    v_lshlrev_b32 v46, 16, v155
    v_and_b32 v47, 0xffff0000, v155
    v_pk_mul_f32 v[40:41], v[40:41], s[34:35]
    v_pk_mul_f32 v[42:43], v[42:43], s[34:35]
    v_pk_mul_f32 v[44:45], v[44:45], s[34:35]
    v_pk_mul_f32 v[46:47], v[46:47], s[34:35]
    v_cvt_pk_bf16_f32 v152, v40, v41
    v_cvt_pk_bf16_f32 v153, v42, v43
    v_cvt_pk_bf16_f32 v154, v44, v45
    v_cvt_pk_bf16_f32 v155, v46, v47
    v_lshlrev_b32 v40, 16, v156
    v_and_b32 v41, 0xffff0000, v156
    v_lshlrev_b32 v42, 16, v157
    v_and_b32 v43, 0xffff0000, v157
    v_lshlrev_b32 v44, 16, v158
    v_and_b32 v45, 0xffff0000, v158
    v_lshlrev_b32 v46, 16, v159
    v_and_b32 v47, 0xffff0000, v159
    v_pk_mul_f32 v[40:41], v[40:41], s[34:35]
    v_pk_mul_f32 v[42:43], v[42:43], s[34:35]
    v_pk_mul_f32 v[44:45], v[44:45], s[34:35]
    v_pk_mul_f32 v[46:47], v[46:47], s[34:35]
    v_cvt_pk_bf16_f32 v156, v40, v41
    v_cvt_pk_bf16_f32 v157, v42, v43
    v_cvt_pk_bf16_f32 v158, v44, v45
    v_cvt_pk_bf16_f32 v159, v46, v47
    v_mfma_f32_16x16x32_bf16 v[48:51], a[128:131], v[128:131], 0
    v_mfma_f32_16x16x32_bf16 v[48:51], a[132:135], v[132:135], v[48:51]
    v_mfma_f32_16x16x32_bf16 v[48:51], a[136:139], v[136:139], v[48:51]
    v_mfma_f32_16x16x32_bf16 v[48:51], a[140:143], v[140:143], v[48:51]
    v_mfma_f32_16x16x32_bf16 v[52:55], a[128:131], v[144:147], 0
    v_mfma_f32_16x16x32_bf16 v[52:55], a[132:135], v[148:151], v[52:55]
    v_mfma_f32_16x16x32_bf16 v[52:55], a[136:139], v[152:155], v[52:55]
    v_mfma_f32_16x16x32_bf16 v[52:55], a[140:143], v[156:159], v[52:55]
    s_nop 3
    v_max3_f32 v36, v48, v49, v50
    v_max_f32 v36, v36, v51
    s_nop 1
    v_max3_f32 v37, v52, v53, v54
    v_max_f32 v37, v37, v55
    s_nop 1
    v_permlane32_swap_b32 v36, v37
    v_max_f32 v36, v36, v37
    v_mov_b32 v37, v36
    s_nop 1
    v_permlane16_swap_b32 v36, v37
    v_max_f32 v36, v36, v37
    v_mov_b32 v37, v36
    s_nop 1
    v_permlane32_swap_b32 v36, v37
    v_sub_f32 v88, 0, v36
    v_sub_f32 v92, 0, v37
    v_sub_f32 v89, 0, v36
    v_sub_f32 v93, 0, v37
    v_sub_f32 v90, 0, v36
    v_sub_f32 v94, 0, v37
    v_sub_f32 v91, 0, v36
    v_sub_f32 v95, 0, v37
    s_add_u32 m0, s42, 2400
    s_nop 0
    buffer_load_dwordx4 v119, s[12:15], 0 offen offset:768 nt lds
    s_add_u32 m0, s42, 3200
    s_nop 0
    buffer_load_dwordx4 v119, s[12:15], 0 offen offset:1024 nt lds
    s_add_u32 m0, s42, 4000
    s_nop 0
    buffer_load_dwordx4 v119, s[12:15], 0 offen offset:1280 nt lds
    s_waitcnt vmcnt(8)
    v_add_u32 v65, s42, v120
    ds_read_b128 v[160:163], v65 offset:8448
    ds_read_b128 v[164:167], v65 offset:8512
    ds_read_b128 v[168:171], v65 offset:8576
    ds_read_b128 v[172:175], v65 offset:8640
    ds_read_b128 v[176:179], v65 offset:8960
    ds_read_b128 v[180:183], v65 offset:9024
    ds_read_b128 v[184:187], v65 offset:9088
    ds_read_b128 v[188:191], v65 offset:9152
    s_add_u32 m0, s42, 4800
    s_nop 0
    buffer_load_dwordx4 v119, s[12:15], 0 offen offset:1536 nt lds
    s_add_u32 m0, s42, 5600
    s_nop 0
    buffer_load_dwordx4 v119, s[12:15], 0 offen offset:1792 nt lds
    v_add_u32 v119, 8192, v119
    s_waitcnt lgkmcnt(0)
    s_add_u32 m0, s42, 8448
    v_lshlrev_b32 v40, 16, v160
    buffer_load_dwordx4 v119, s[12:15], 0 offen offset:0 nt lds
    v_and_b32 v41, 0xffff0000, v160
    v_lshlrev_b32 v42, 16, v161
    v_and_b32 v43, 0xffff0000, v161
    v_lshlrev_b32 v44, 16, v162
    v_and_b32 v45, 0xffff0000, v162
    v_lshlrev_b32 v46, 16, v163
    v_and_b32 v47, 0xffff0000, v163
    v_pk_mul_f32 v[40:41], v[40:41], s[34:35]
    v_pk_mul_f32 v[42:43], v[42:43], s[34:35]
    v_pk_mul_f32 v[44:45], v[44:45], s[34:35]
    v_pk_mul_f32 v[46:47], v[46:47], s[34:35]
    v_cvt_pk_bf16_f32 v160, v40, v41
    v_cvt_pk_bf16_f32 v161, v42, v43
    v_cvt_pk_bf16_f32 v162, v44, v45
    v_cvt_pk_bf16_f32 v163, v46, v47
    v_lshlrev_b32 v40, 16, v164
    v_and_b32 v41, 0xffff0000, v164
    v_lshlrev_b32 v42, 16, v165
    v_and_b32 v43, 0xffff0000, v165
    v_lshlrev_b32 v44, 16, v166
    v_and_b32 v45, 0xffff0000, v166
    v_lshlrev_b32 v46, 16, v167
    v_and_b32 v47, 0xffff0000, v167
    v_pk_mul_f32 v[40:41], v[40:41], s[34:35]
    v_pk_mul_f32 v[42:43], v[42:43], s[34:35]
    v_pk_mul_f32 v[44:45], v[44:45], s[34:35]
    v_pk_mul_f32 v[46:47], v[46:47], s[34:35]
    v_cvt_pk_bf16_f32 v164, v40, v41
    v_cvt_pk_bf16_f32 v165, v42, v43
    v_cvt_pk_bf16_f32 v166, v44, v45
    v_cvt_pk_bf16_f32 v167, v46, v47
    v_lshlrev_b32 v40, 16, v168
    v_and_b32 v41, 0xffff0000, v168
    v_lshlrev_b32 v42, 16, v169
    v_and_b32 v43, 0xffff0000, v169
    v_lshlrev_b32 v44, 16, v170
    v_and_b32 v45, 0xffff0000, v170
    v_lshlrev_b32 v46, 16, v171
    v_and_b32 v47, 0xffff0000, v171
    v_pk_mul_f32 v[40:41], v[40:41], s[34:35]
    v_pk_mul_f32 v[42:43], v[42:43], s[34:35]
    v_pk_mul_f32 v[44:45], v[44:45], s[34:35]
    v_pk_mul_f32 v[46:47], v[46:47], s[34:35]
    v_cvt_pk_bf16_f32 v168, v40, v41
    v_cvt_pk_bf16_f32 v169, v42, v43
    v_cvt_pk_bf16_f32 v170, v44, v45
    v_cvt_pk_bf16_f32 v171, v46, v47
    v_lshlrev_b32 v40, 16, v172
    v_and_b32 v41, 0xffff0000, v172
    v_lshlrev_b32 v42, 16, v173
    v_and_b32 v43, 0xffff0000, v173
    v_lshlrev_b32 v44, 16, v174
    v_and_b32 v45, 0xffff0000, v174
    v_lshlrev_b32 v46, 16, v175
    v_and_b32 v47, 0xffff0000, v175
    v_pk_mul_f32 v[40:41], v[40:41], s[34:35]
    v_pk_mul_f32 v[42:43], v[42:43], s[34:35]
    v_pk_mul_f32 v[44:45], v[44:45], s[34:35]
    v_pk_mul_f32 v[46:47], v[46:47], s[34:35]
    v_cvt_pk_bf16_f32 v172, v40, v41
    v_cvt_pk_bf16_f32 v173, v42, v43
    v_cvt_pk_bf16_f32 v174, v44, v45
    v_cvt_pk_bf16_f32 v175, v46, v47
    s_add_u32 m0, s42, 9248
    v_lshlrev_b32 v40, 16, v176
    buffer_load_dwordx4 v119, s[12:15], 0 offen offset:256 nt lds
    v_and_b32 v41, 0xffff0000, v176
    v_lshlrev_b32 v42, 16, v177
    v_and_b32 v43, 0xffff0000, v177
    v_lshlrev_b32 v44, 16, v178
    v_and_b32 v45, 0xffff0000, v178
    v_lshlrev_b32 v46, 16, v179
    v_and_b32 v47, 0xffff0000, v179
    v_pk_mul_f32 v[40:41], v[40:41], s[34:35]
    v_pk_mul_f32 v[42:43], v[42:43], s[34:35]
    v_pk_mul_f32 v[44:45], v[44:45], s[34:35]
    v_pk_mul_f32 v[46:47], v[46:47], s[34:35]
    v_cvt_pk_bf16_f32 v176, v40, v41
    v_cvt_pk_bf16_f32 v177, v42, v43
    v_cvt_pk_bf16_f32 v178, v44, v45
    v_cvt_pk_bf16_f32 v179, v46, v47
    v_lshlrev_b32 v40, 16, v180
    v_and_b32 v41, 0xffff0000, v180
    v_lshlrev_b32 v42, 16, v181
    v_and_b32 v43, 0xffff0000, v181
    v_lshlrev_b32 v44, 16, v182
    v_and_b32 v45, 0xffff0000, v182
    v_lshlrev_b32 v46, 16, v183
    v_and_b32 v47, 0xffff0000, v183
    v_pk_mul_f32 v[40:41], v[40:41], s[34:35]
    v_pk_mul_f32 v[42:43], v[42:43], s[34:35]
    v_pk_mul_f32 v[44:45], v[44:45], s[34:35]
    v_pk_mul_f32 v[46:47], v[46:47], s[34:35]
    v_cvt_pk_bf16_f32 v180, v40, v41
    v_cvt_pk_bf16_f32 v181, v42, v43
    v_cvt_pk_bf16_f32 v182, v44, v45
    v_cvt_pk_bf16_f32 v183, v46, v47
    v_lshlrev_b32 v40, 16, v184
    v_and_b32 v41, 0xffff0000, v184
    v_lshlrev_b32 v42, 16, v185
    v_and_b32 v43, 0xffff0000, v185
    v_lshlrev_b32 v44, 16, v186
    v_and_b32 v45, 0xffff0000, v186
    v_lshlrev_b32 v46, 16, v187
    v_and_b32 v47, 0xffff0000, v187
    v_pk_mul_f32 v[40:41], v[40:41], s[34:35]
    v_pk_mul_f32 v[42:43], v[42:43], s[34:35]
    v_pk_mul_f32 v[44:45], v[44:45], s[34:35]
    v_pk_mul_f32 v[46:47], v[46:47], s[34:35]
    v_cvt_pk_bf16_f32 v184, v40, v41
    v_cvt_pk_bf16_f32 v185, v42, v43
    v_cvt_pk_bf16_f32 v186, v44, v45
    v_cvt_pk_bf16_f32 v187, v46, v47
    v_lshlrev_b32 v40, 16, v188
    v_and_b32 v41, 0xffff0000, v188
    v_lshlrev_b32 v42, 16, v189
    v_and_b32 v43, 0xffff0000, v189
    v_lshlrev_b32 v44, 16, v190
    v_and_b32 v45, 0xffff0000, v190
    v_lshlrev_b32 v46, 16, v191
    v_and_b32 v47, 0xffff0000, v191
    v_pk_mul_f32 v[40:41], v[40:41], s[34:35]
    v_pk_mul_f32 v[42:43], v[42:43], s[34:35]
    v_pk_mul_f32 v[44:45], v[44:45], s[34:35]
    v_pk_mul_f32 v[46:47], v[46:47], s[34:35]
    v_cvt_pk_bf16_f32 v188, v40, v41
    v_cvt_pk_bf16_f32 v189, v42, v43
    v_cvt_pk_bf16_f32 v190, v44, v45
    v_cvt_pk_bf16_f32 v191, v46, v47
    v_mfma_f32_16x16x32_bf16 v[48:51], a[128:131], v[160:163], 0
    v_mfma_f32_16x16x32_bf16 v[48:51], a[132:135], v[164:167], v[48:51]
    v_mfma_f32_16x16x32_bf16 v[48:51], a[136:139], v[168:171], v[48:51]
    v_mfma_f32_16x16x32_bf16 v[48:51], a[140:143], v[172:175], v[48:51]
    v_mfma_f32_16x16x32_bf16 v[52:55], a[128:131], v[176:179], 0
    v_mfma_f32_16x16x32_bf16 v[52:55], a[132:135], v[180:183], v[52:55]
    v_mfma_f32_16x16x32_bf16 v[52:55], a[136:139], v[184:187], v[52:55]
    v_mfma_f32_16x16x32_bf16 v[52:55], a[140:143], v[188:191], v[52:55]
    s_nop 3
    v_max3_f32 v36, v48, v49, v50
    v_max_f32 v36, v36, v51
    s_nop 1
    v_max3_f32 v37, v52, v53, v54
    v_max_f32 v37, v37, v55
    s_nop 1
    v_permlane32_swap_b32 v36, v37
    v_max_f32 v36, v36, v37
    v_mov_b32 v37, v36
    s_nop 1
    v_permlane16_swap_b32 v36, v37
    v_max_f32 v36, v36, v37
    v_mov_b32 v37, v36
    s_nop 1
    v_permlane32_swap_b32 v36, v37
    v_sub_f32 v96, 0, v36
    v_sub_f32 v100, 0, v37
    v_sub_f32 v97, 0, v36
    v_sub_f32 v101, 0, v37
    v_sub_f32 v98, 0, v36
    v_sub_f32 v102, 0, v37
    v_sub_f32 v99, 0, v36
    v_sub_f32 v103, 0, v37
    s_add_u32 m0, s42, 10048
    s_nop 0
    buffer_load_dwordx4 v119, s[12:15], 0 offen offset:512 nt lds
    s_cmp_eq_u32 s40, 0
    s_cbranch_scc1 L_ov1
    v_lshrrev_b32 v64, 2, v122
    s_lshl_b32 s36, s28, 11
    v_add_u32 v64, s36, v64
    v_add_u32 v64, 135168, v64
    ds_read_b32 v88, v64 offset:0
    ds_read_b32 v92, v64 offset:256
    ds_read_b32 v96, v64 offset:512
    ds_read_b32 v100, v64 offset:768
    s_waitcnt lgkmcnt(0)
    v_mov_b32 v89, v88
    v_mov_b32 v90, v88
    v_mov_b32 v91, v88
    v_mov_b32 v93, v92
    v_mov_b32 v94, v92
    v_mov_b32 v95, v92
    v_mov_b32 v97, v96
    v_mov_b32 v98, v96
    v_mov_b32 v99, v96
    v_mov_b32 v101, v100
    v_mov_b32 v102, v100
    v_mov_b32 v103, v100
L_ov1:
    s_waitcnt vmcnt(11)
    s_barrier
    s_cmp_eq_u32 s28, 3
    s_cbranch_scc1 L_headb
L_heada:
    v_mfma_f32_16x16x32_bf16 v[64:67], a[128:131], v[128:131], v[88:91]
    s_waitcnt lgkmcnt(15)
    ds_read_b128 a[152:155], v120 offset:640
    v_mfma_f32_16x16x32_bf16 v[64:67], a[132:135], v[132:135], v[64:67]
    s_waitcnt lgkmcnt(15)
    v_mfma_f32_16x16x32_bf16 v[64:67], a[136:139], v[136:139], v[64:67]
    s_waitcnt lgkmcnt(15)
    v_mfma_f32_16x16x32_bf16 v[64:67], a[140:143], v[140:143], v[64:67]
    s_add_u32 m0, s42, 10848
    ds_read_b128 a[156:159], v120 offset:704
    buffer_load_dwordx4 v119, s[12:15], 0 offen offset:768 nt lds
    s_waitcnt lgkmcnt(15)
    s_nop 3
    v_exp_f32 v64, v64
    v_mfma_f32_16x16x32_bf16 v[68:71], a[144:147], v[128:131], v[88:91]
    s_waitcnt lgkmcnt(15)
    v_add_f32 v80, v80, v64
    v_mfma_f32_16x16x32_bf16 v[68:71], a[148:151], v[132:135], v[68:71]
    s_waitcnt lgkmcnt(1)
    v_exp_f32 v65, v65
    v_mfma_f32_16x16x32_bf16 v[68:71], a[152:155], v[136:139], v[68:71]
    s_waitcnt lgkmcnt(0)
    v_cvt_pk_bf16_f32 v72, v64, v65
    v_add_f32 v80, v80, v65
    v_mfma_f32_16x16x32_bf16 v[68:71], a[156:159], v[140:143], v[68:71]
    s_add_u32 m0, s42, 11648
    v_exp_f32 v66, v66
    ds_read_b64_tr_b16 a[160:161], v121 offset:0
    buffer_load_dwordx4 v119, s[12:15], 0 offen offset:1024 nt lds
    v_add_f32 v80, v80, v66
    ds_read_b64_tr_b16 a[162:163], v121 offset:512
    v_exp_f32 v67, v67
    s_nop 0
    v_cvt_pk_bf16_f32 v73, v66, v67
    v_add_f32 v80, v80, v67
    ds_read_b64_tr_b16 a[164:165], v121 offset:32
    v_exp_f32 v68, v68
    v_mfma_f32_16x16x32_bf16 v[64:67], a[128:131], v[144:147], v[92:95]
    ds_read_b64_tr_b16 a[166:167], v121 offset:544
    v_add_f32 v80, v80, v68
    v_mfma_f32_16x16x32_bf16 v[64:67], a[132:135], v[148:151], v[64:67]
    ds_read_b64_tr_b16 a[168:169], v121 offset:64
    v_exp_f32 v69, v69
    v_mfma_f32_16x16x32_bf16 v[64:67], a[136:139], v[152:155], v[64:67]
    v_cvt_pk_bf16_f32 v74, v68, v69
    v_add_f32 v80, v80, v69
    v_mfma_f32_16x16x32_bf16 v[64:67], a[140:143], v[156:159], v[64:67]
    ds_read_b64_tr_b16 a[170:171], v121 offset:576
    v_exp_f32 v70, v70
    ds_read_b64_tr_b16 a[172:173], v121 offset:96
    v_add_f32 v80, v80, v70
    ds_read_b64_tr_b16 a[174:175], v121 offset:608
    v_exp_f32 v71, v71
    s_nop 0
    v_cvt_pk_bf16_f32 v75, v70, v71
    v_add_f32 v80, v80, v71
    s_add_u32 m0, s42, 12448
    ds_read_b64_tr_b16 a[176:177], v121 offset:128
    v_exp_f32 v64, v64
    v_mfma_f32_16x16x32_bf16 v[68:71], a[144:147], v[144:147], v[92:95]
    ds_read_b64_tr_b16 a[178:179], v121 offset:640
    buffer_load_dwordx4 v119, s[12:15], 0 offen offset:1280 nt lds
    v_add_f32 v81, v81, v64
    v_mfma_f32_16x16x32_bf16 v[68:71], a[148:151], v[148:151], v[68:71]
    ds_read_b64_tr_b16 a[180:181], v121 offset:160
    v_exp_f32 v65, v65
    v_mfma_f32_16x16x32_bf16 v[68:71], a[152:155], v[152:155], v[68:71]
    v_cvt_pk_bf16_f32 v76, v64, v65
    v_add_f32 v81, v81, v65
    v_mfma_f32_16x16x32_bf16 v[68:71], a[156:159], v[156:159], v[68:71]
    s_waitcnt lgkmcnt(9)
    ds_read_b64_tr_b16 a[182:183], v121 offset:672
    v_exp_f32 v66, v66
    v_mfma_f32_16x16x32_bf16 a[0:3], a[160:163], v[72:75], 0
    s_waitcnt lgkmcnt(8)
    ds_read_b64_tr_b16 a[184:185], v121 offset:192
    v_add_f32 v81, v81, v66
    v_mfma_f32_16x16x32_bf16 a[4:7], a[164:167], v[72:75], 0
    s_waitcnt lgkmcnt(7)
    ds_read_b64_tr_b16 a[186:187], v121 offset:704
    v_exp_f32 v67, v67
    v_mfma_f32_16x16x32_bf16 a[8:11], a[168:171], v[72:75], 0
    s_waitcnt lgkmcnt(6)
    v_cvt_pk_bf16_f32 v77, v66, v67
    v_add_f32 v81, v81, v67
    v_mfma_f32_16x16x32_bf16 a[12:15], a[172:175], v[72:75], 0
    ds_read_b64_tr_b16 a[188:189], v121 offset:224
    v_exp_f32 v68, v68
    v_mfma_f32_16x16x32_bf16 v[64:67], a[128:131], v[160:163], v[96:99]
    ds_read_b64_tr_b16 a[190:191], v121 offset:736
    v_add_f32 v81, v81, v68
    v_mfma_f32_16x16x32_bf16 v[64:67], a[132:135], v[164:167], v[64:67]
    v_exp_f32 v69, v69
    v_mfma_f32_16x16x32_bf16 v[64:67], a[136:139], v[168:171], v[64:67]
    v_cvt_pk_bf16_f32 v78, v68, v69
    v_add_f32 v81, v81, v69
    v_mfma_f32_16x16x32_bf16 v[64:67], a[140:143], v[172:175], v[64:67]
    s_waitcnt lgkmcnt(6)
    s_add_u32 m0, s42, 13248
    v_exp_f32 v70, v70
    v_mfma_f32_16x16x32_bf16 a[16:19], a[176:179], v[72:75], 0
    s_waitcnt lgkmcnt(4)
    buffer_load_dwordx4 v119, s[12:15], 0 offen offset:1536 nt lds
    v_add_f32 v81, v81, v70
    v_mfma_f32_16x16x32_bf16 a[20:23], a[180:183], v[72:75], 0
    s_waitcnt lgkmcnt(2)
    v_exp_f32 v71, v71
    v_mfma_f32_16x16x32_bf16 a[24:27], a[184:187], v[72:75], 0
    s_waitcnt lgkmcnt(0)
    v_cvt_pk_bf16_f32 v79, v70, v71
    v_add_f32 v81, v81, v71
    v_mfma_f32_16x16x32_bf16 a[28:31], a[188:191], v[72:75], 0
    v_exp_f32 v64, v64
    v_mfma_f32_16x16x32_bf16 v[68:71], a[144:147], v[160:163], v[96:99]
    v_add_f32 v82, v82, v64
    v_mfma_f32_16x16x32_bf16 v[68:71], a[148:151], v[164:167], v[68:71]
    v_exp_f32 v65, v65
    v_mfma_f32_16x16x32_bf16 v[68:71], a[152:155], v[168:171], v[68:71]
    v_cvt_pk_bf16_f32 v72, v64, v65
    v_add_f32 v82, v82, v65
    v_mfma_f32_16x16x32_bf16 v[68:71], a[156:159], v[172:175], v[68:71]
    v_exp_f32 v66, v66
    v_mfma_f32_16x16x32_bf16 a[32:35], a[160:163], v[76:79], 0
    v_add_f32 v82, v82, v66
    v_mfma_f32_16x16x32_bf16 a[36:39], a[164:167], v[76:79], 0
    v_exp_f32 v67, v67
    v_mfma_f32_16x16x32_bf16 a[40:43], a[168:171], v[76:79], 0
    v_cvt_pk_bf16_f32 v73, v66, v67
    v_add_f32 v82, v82, v67
    v_mfma_f32_16x16x32_bf16 a[44:47], a[172:175], v[76:79], 0
    s_add_u32 m0, s42, 14048
    v_exp_f32 v68, v68
    v_mfma_f32_16x16x32_bf16 v[64:67], a[128:131], v[176:179], v[100:103]
    buffer_load_dwordx4 v119, s[12:15], 0 offen offset:1792 nt lds
    v_add_f32 v82, v82, v68
    v_mfma_f32_16x16x32_bf16 v[64:67], a[132:135], v[180:183], v[64:67]
    v_exp_f32 v69, v69
    v_mfma_f32_16x16x32_bf16 v[64:67], a[136:139], v[184:187], v[64:67]
    v_cvt_pk_bf16_f32 v74, v68, v69
    v_add_f32 v82, v82, v69
    v_mfma_f32_16x16x32_bf16 v[64:67], a[140:143], v[188:191], v[64:67]
    v_exp_f32 v70, v70
    v_mfma_f32_16x16x32_bf16 a[48:51], a[176:179], v[76:79], 0
    v_add_f32 v82, v82, v70
    v_mfma_f32_16x16x32_bf16 a[52:55], a[180:183], v[76:79], 0
    v_exp_f32 v71, v71
    v_mfma_f32_16x16x32_bf16 a[56:59], a[184:187], v[76:79], 0
    v_cvt_pk_bf16_f32 v75, v70, v71
    v_add_f32 v82, v82, v71
    v_mfma_f32_16x16x32_bf16 a[60:63], a[188:191], v[76:79], 0
    v_exp_f32 v64, v64
    v_mfma_f32_16x16x32_bf16 v[68:71], a[144:147], v[176:179], v[100:103]
    v_add_f32 v83, v83, v64
    v_mfma_f32_16x16x32_bf16 v[68:71], a[148:151], v[180:183], v[68:71]
    v_exp_f32 v65, v65
    v_mfma_f32_16x16x32_bf16 v[68:71], a[152:155], v[184:187], v[68:71]
    v_cvt_pk_bf16_f32 v76, v64, v65
    v_add_f32 v83, v83, v65
    v_mfma_f32_16x16x32_bf16 v[68:71], a[156:159], v[188:191], v[68:71]
    v_exp_f32 v66, v66
    v_mfma_f32_16x16x32_bf16 a[64:67], a[160:163], v[72:75], 0
    v_add_f32 v83, v83, v66
    v_mfma_f32_16x16x32_bf16 a[68:71], a[164:167], v[72:75], 0
    v_exp_f32 v67, v67
    v_mfma_f32_16x16x32_bf16 a[72:75], a[168:171], v[72:75], 0
    v_cvt_pk_bf16_f32 v77, v66, v67
    v_add_f32 v83, v83, v67
    v_mfma_f32_16x16x32_bf16 a[76:79], a[172:175], v[72:75], 0
    v_exp_f32 v68, v68
    s_waitcnt vmcnt(8)
    v_add_u32 v64, s42, v120
    ds_read_b128 v[192:195], v64 offset:0
    ds_read_b128 v[196:199], v64 offset:64
    ds_read_b128 v[200:203], v64 offset:128
    ds_read_b128 v[204:207], v64 offset:192
    ds_read_b128 v[208:211], v64 offset:512
    ds_read_b128 v[212:215], v64 offset:576
    ds_read_b128 v[216:219], v64 offset:640
    ds_read_b128 v[220:223], v64 offset:704
    s_waitcnt lgkmcnt(0)
    s_add_u32 m0, s45, 8448
    v_lshlrev_b32 v104, 16, v192
    buffer_load_dwordx4 v122, s[16:19], s55 offen offset:0 nt lds
    v_and_b32 v105, 0xffff0000, v192
    v_lshlrev_b32 v106, 16, v193
    v_and_b32 v107, 0xffff0000, v193
    v_lshlrev_b32 v108, 16, v194
    v_and_b32 v109, 0xffff0000, v194
    v_lshlrev_b32 v110, 16, v195
    v_and_b32 v111, 0xffff0000, v195
    v_pk_mul_f32 v[104:105], v[104:105], s[34:35]
    v_pk_mul_f32 v[106:107], v[106:107], s[34:35]
    v_pk_mul_f32 v[108:109], v[108:109], s[34:35]
    v_pk_mul_f32 v[110:111], v[110:111], s[34:35]
    v_cvt_pk_bf16_f32 v192, v104, v105
    v_cvt_pk_bf16_f32 v193, v106, v107
    v_cvt_pk_bf16_f32 v194, v108, v109
    v_cvt_pk_bf16_f32 v195, v110, v111
    v_lshlrev_b32 v104, 16, v196
    v_and_b32 v105, 0xffff0000, v196
    v_lshlrev_b32 v106, 16, v197
    v_and_b32 v107, 0xffff0000, v197
    v_lshlrev_b32 v108, 16, v198
    v_and_b32 v109, 0xffff0000, v198
    v_lshlrev_b32 v110, 16, v199
    v_and_b32 v111, 0xffff0000, v199
    v_pk_mul_f32 v[104:105], v[104:105], s[34:35]
    v_pk_mul_f32 v[106:107], v[106:107], s[34:35]
    v_pk_mul_f32 v[108:109], v[108:109], s[34:35]
    v_pk_mul_f32 v[110:111], v[110:111], s[34:35]
    v_cvt_pk_bf16_f32 v196, v104, v105
    v_cvt_pk_bf16_f32 v197, v106, v107
    v_cvt_pk_bf16_f32 v198, v108, v109
    v_cvt_pk_bf16_f32 v199, v110, v111
    s_add_u32 m0, s45, 8480
    v_lshlrev_b32 v104, 16, v200
    buffer_load_dwordx4 v122, s[16:19], s55 offen offset:1024 nt lds
    v_and_b32 v105, 0xffff0000, v200
    v_lshlrev_b32 v106, 16, v201
    v_and_b32 v107, 0xffff0000, v201
    v_lshlrev_b32 v108, 16, v202
    v_and_b32 v109, 0xffff0000, v202
    v_lshlrev_b32 v110, 16, v203
    v_and_b32 v111, 0xffff0000, v203
    v_pk_mul_f32 v[104:105], v[104:105], s[34:35]
    v_pk_mul_f32 v[106:107], v[106:107], s[34:35]
    v_pk_mul_f32 v[108:109], v[108:109], s[34:35]
    v_pk_mul_f32 v[110:111], v[110:111], s[34:35]
    v_cvt_pk_bf16_f32 v200, v104, v105
    v_cvt_pk_bf16_f32 v201, v106, v107
    v_cvt_pk_bf16_f32 v202, v108, v109
    v_cvt_pk_bf16_f32 v203, v110, v111
    v_lshlrev_b32 v104, 16, v204
    v_and_b32 v105, 0xffff0000, v204
    v_lshlrev_b32 v106, 16, v205
    v_and_b32 v107, 0xffff0000, v205
    v_lshlrev_b32 v108, 16, v206
    v_and_b32 v109, 0xffff0000, v206
    v_lshlrev_b32 v110, 16, v207
    v_and_b32 v111, 0xffff0000, v207
    v_pk_mul_f32 v[104:105], v[104:105], s[34:35]
    v_pk_mul_f32 v[106:107], v[106:107], s[34:35]
    v_pk_mul_f32 v[108:109], v[108:109], s[34:35]
    v_pk_mul_f32 v[110:111], v[110:111], s[34:35]
    v_cvt_pk_bf16_f32 v204, v104, v105
    v_cvt_pk_bf16_f32 v205, v106, v107
    v_cvt_pk_bf16_f32 v206, v108, v109
    v_cvt_pk_bf16_f32 v207, v110, v111
    s_add_u32 m0, s45, 76032
    v_lshlrev_b32 v104, 16, v208
    buffer_load_dwordx4 v122, s[20:23], s55 offen offset:0 nt lds
    v_and_b32 v105, 0xffff0000, v208
    v_lshlrev_b32 v106, 16, v209
    v_and_b32 v107, 0xffff0000, v209
    v_lshlrev_b32 v108, 16, v210
    v_and_b32 v109, 0xffff0000, v210
    v_lshlrev_b32 v110, 16, v211
    v_and_b32 v111, 0xffff0000, v211
    v_pk_mul_f32 v[104:105], v[104:105], s[34:35]
    v_pk_mul_f32 v[106:107], v[106:107], s[34:35]
    v_pk_mul_f32 v[108:109], v[108:109], s[34:35]
    v_pk_mul_f32 v[110:111], v[110:111], s[34:35]
    v_cvt_pk_bf16_f32 v208, v104, v105
    v_cvt_pk_bf16_f32 v209, v106, v107
    v_cvt_pk_bf16_f32 v210, v108, v109
    v_cvt_pk_bf16_f32 v211, v110, v111
    v_lshlrev_b32 v104, 16, v212
    v_and_b32 v105, 0xffff0000, v212
    v_lshlrev_b32 v106, 16, v213
    v_and_b32 v107, 0xffff0000, v213
    v_lshlrev_b32 v108, 16, v214
    v_and_b32 v109, 0xffff0000, v214
    v_lshlrev_b32 v110, 16, v215
    v_and_b32 v111, 0xffff0000, v215
    v_pk_mul_f32 v[104:105], v[104:105], s[34:35]
    v_pk_mul_f32 v[106:107], v[106:107], s[34:35]
    v_pk_mul_f32 v[108:109], v[108:109], s[34:35]
    v_pk_mul_f32 v[110:111], v[110:111], s[34:35]
    v_cvt_pk_bf16_f32 v212, v104, v105
    v_cvt_pk_bf16_f32 v213, v106, v107
    v_cvt_pk_bf16_f32 v214, v108, v109
    v_cvt_pk_bf16_f32 v215, v110, v111
    s_add_u32 m0, s45, 76064
    v_lshlrev_b32 v104, 16, v216
    buffer_load_dwordx4 v122, s[20:23], s55 offen offset:1024 nt lds
    v_and_b32 v105, 0xffff0000, v216
    v_lshlrev_b32 v106, 16, v217
    v_and_b32 v107, 0xffff0000, v217
    v_lshlrev_b32 v108, 16, v218
    v_and_b32 v109, 0xffff0000, v218
    v_lshlrev_b32 v110, 16, v219
    v_and_b32 v111, 0xffff0000, v219
    v_pk_mul_f32 v[104:105], v[104:105], s[34:35]
    v_pk_mul_f32 v[106:107], v[106:107], s[34:35]
    v_pk_mul_f32 v[108:109], v[108:109], s[34:35]
    v_pk_mul_f32 v[110:111], v[110:111], s[34:35]
    v_cvt_pk_bf16_f32 v216, v104, v105
    v_cvt_pk_bf16_f32 v217, v106, v107
    v_cvt_pk_bf16_f32 v218, v108, v109
    v_cvt_pk_bf16_f32 v219, v110, v111
    v_lshlrev_b32 v104, 16, v220
    v_and_b32 v105, 0xffff0000, v220
    v_lshlrev_b32 v106, 16, v221
    v_and_b32 v107, 0xffff0000, v221
    v_lshlrev_b32 v108, 16, v222
    v_and_b32 v109, 0xffff0000, v222
    v_lshlrev_b32 v110, 16, v223
    v_and_b32 v111, 0xffff0000, v223
    v_pk_mul_f32 v[104:105], v[104:105], s[34:35]
    v_pk_mul_f32 v[106:107], v[106:107], s[34:35]
    v_pk_mul_f32 v[108:109], v[108:109], s[34:35]
    v_pk_mul_f32 v[110:111], v[110:111], s[34:35]
    v_cvt_pk_bf16_f32 v220, v104, v105
    v_cvt_pk_bf16_f32 v221, v106, v107
    v_cvt_pk_bf16_f32 v222, v108, v109
    v_cvt_pk_bf16_f32 v223, v110, v111
    v_mfma_f32_16x16x32_bf16 v[64:67], a[128:131], v[192:195], 0
    v_mfma_f32_16x16x32_bf16 v[64:67], a[132:135], v[196:199], v[64:67]
    v_mfma_f32_16x16x32_bf16 v[64:67], a[136:139], v[200:203], v[64:67]
    v_mfma_f32_16x16x32_bf16 v[64:67], a[140:143], v[204:207], v[64:67]
    v_mfma_f32_16x16x32_bf16 v[108:111], a[128:131], v[208:211], 0
    v_mfma_f32_16x16x32_bf16 v[108:111], a[132:135], v[212:215], v[108:111]
    v_mfma_f32_16x16x32_bf16 v[108:111], a[136:139], v[216:219], v[108:111]
    v_mfma_f32_16x16x32_bf16 v[108:111], a[140:143], v[220:223], v[108:111]
    s_nop 3
    v_max3_f32 v84, v64, v65, v66
    v_max_f32 v84, v84, v67
    s_nop 1
    v_max3_f32 v85, v108, v109, v110
    v_max_f32 v85, v85, v111
    s_nop 1
    v_permlane32_swap_b32 v84, v85
    v_max_f32 v84, v84, v85
    v_mov_b32 v85, v84
    s_nop 1
    v_permlane16_swap_b32 v84, v85
    v_max_f32 v84, v84, v85
    v_mov_b32 v85, v84
    s_nop 1
    v_permlane32_swap_b32 v84, v85
    v_sub_f32 v104, 0, v84
    v_sub_f32 v108, 0, v85
    v_sub_f32 v105, 0, v84
    v_sub_f32 v109, 0, v85
    v_sub_f32 v106, 0, v84
    v_sub_f32 v110, 0, v85
    v_sub_f32 v107, 0, v84
    v_sub_f32 v111, 0, v85
    v_mov_b32 v84, 0
    v_mov_b32 v85, 0
    s_cmp_eq_u32 s40, 0
    s_cbranch_scc1 L_ov2
    v_lshrrev_b32 v64, 2, v122
    s_lshl_b32 s36, s28, 11
    v_add_u32 v64, s36, v64
    v_add_u32 v64, 135168, v64
    ds_read_b32 v104, v64 offset:1024
    ds_read_b32 v108, v64 offset:1280
    s_waitcnt lgkmcnt(0)
    v_mov_b32 v105, v104
    v_mov_b32 v106, v104
    v_mov_b32 v107, v104
    v_mov_b32 v109, v108
    v_mov_b32 v110, v108
    v_mov_b32 v111, v108
L_ov2:
    v_mfma_f32_16x16x32_bf16 v[64:67], a[128:131], v[192:195], v[104:107]
    v_add_f32 v83, v83, v68
    v_mfma_f32_16x16x32_bf16 v[64:67], a[132:135], v[196:199], v[64:67]
    v_exp_f32 v69, v69
    v_mfma_f32_16x16x32_bf16 v[64:67], a[136:139], v[200:203], v[64:67]
    v_cvt_pk_bf16_f32 v78, v68, v69
    v_add_f32 v83, v83, v69
    v_mfma_f32_16x16x32_bf16 v[64:67], a[140:143], v[204:207], v[64:67]
    s_add_u32 m0, s31, 0
    v_exp_f32 v70, v70
    v_mfma_f32_16x16x32_bf16 a[80:83], a[176:179], v[72:75], 0
    buffer_load_dwordx4 v122, s[16:19], s30 offen offset:0 nt lds
    v_add_f32 v83, v83, v70
    v_mfma_f32_16x16x32_bf16 a[84:87], a[180:183], v[72:75], 0
    v_exp_f32 v71, v71
    v_mfma_f32_16x16x32_bf16 a[88:91], a[184:187], v[72:75], 0
    v_cvt_pk_bf16_f32 v79, v70, v71
    v_add_f32 v83, v83, v71
    v_mfma_f32_16x16x32_bf16 a[92:95], a[188:191], v[72:75], 0
    v_exp_f32 v64, v64
    v_mfma_f32_16x16x32_bf16 v[68:71], a[144:147], v[192:195], v[104:107]
    v_add_f32 v84, v84, v64
    v_mfma_f32_16x16x32_bf16 v[68:71], a[148:151], v[196:199], v[68:71]
    v_exp_f32 v65, v65
    v_mfma_f32_16x16x32_bf16 v[68:71], a[152:155], v[200:203], v[68:71]
    v_cvt_pk_bf16_f32 v72, v64, v65
    v_add_f32 v84, v84, v65
    v_mfma_f32_16x16x32_bf16 v[68:71], a[156:159], v[204:207], v[68:71]
    s_add_u32 m0, s31, 32
    v_exp_f32 v66, v66
    v_mfma_f32_16x16x32_bf16 a[96:99], a[160:163], v[76:79], 0
    buffer_load_dwordx4 v122, s[16:19], s30 offen offset:1024 nt lds
    v_add_f32 v84, v84, v66
    v_mfma_f32_16x16x32_bf16 a[100:103], a[164:167], v[76:79], 0
    v_exp_f32 v67, v67
    v_mfma_f32_16x16x32_bf16 a[104:107], a[168:171], v[76:79], 0
    v_cvt_pk_bf16_f32 v73, v66, v67
    v_add_f32 v84, v84, v67
    v_mfma_f32_16x16x32_bf16 a[108:111], a[172:175], v[76:79], 0
    v_exp_f32 v68, v68
    v_mfma_f32_16x16x32_bf16 v[64:67], a[128:131], v[208:211], v[108:111]
    v_add_f32 v84, v84, v68
    v_mfma_f32_16x16x32_bf16 v[64:67], a[132:135], v[212:215], v[64:67]
    v_exp_f32 v69, v69
    v_mfma_f32_16x16x32_bf16 v[64:67], a[136:139], v[216:219], v[64:67]
    v_cvt_pk_bf16_f32 v74, v68, v69
    v_add_f32 v84, v84, v69
    v_mfma_f32_16x16x32_bf16 v[64:67], a[140:143], v[220:223], v[64:67]
    s_add_u32 m0, s31, 64
    v_exp_f32 v70, v70
    v_mfma_f32_16x16x32_bf16 a[112:115], a[176:179], v[76:79], 0
    buffer_load_dwordx4 v122, s[16:19], s30 offen offset:2048 nt lds
    v_add_f32 v84, v84, v70
    v_mfma_f32_16x16x32_bf16 a[116:119], a[180:183], v[76:79], 0
    v_exp_f32 v71, v71
    v_mfma_f32_16x16x32_bf16 a[120:123], a[184:187], v[76:79], 0
    v_cvt_pk_bf16_f32 v75, v70, v71
    v_add_f32 v84, v84, v71
    v_mfma_f32_16x16x32_bf16 a[124:127], a[188:191], v[76:79], 0
    v_exp_f32 v64, v64
    v_mfma_f32_16x16x32_bf16 v[68:71], a[144:147], v[208:211], v[108:111]
    v_add_f32 v85, v85, v64
    v_mfma_f32_16x16x32_bf16 v[68:71], a[148:151], v[212:215], v[68:71]
    v_exp_f32 v65, v65
    v_mfma_f32_16x16x32_bf16 v[68:71], a[152:155], v[216:219], v[68:71]
    v_cvt_pk_bf16_f32 v76, v64, v65
    v_add_f32 v85, v85, v65
    v_mfma_f32_16x16x32_bf16 v[68:71], a[156:159], v[220:223], v[68:71]
    v_exp_f32 v66, v66
    v_mfma_f32_16x16x32_bf16 v[0:3], a[160:163], v[72:75], 0
    v_add_f32 v85, v85, v66
    v_mfma_f32_16x16x32_bf16 v[4:7], a[164:167], v[72:75], 0
    v_exp_f32 v67, v67
    v_mfma_f32_16x16x32_bf16 v[8:11], a[168:171], v[72:75], 0
    v_cvt_pk_bf16_f32 v77, v66, v67
    v_add_f32 v85, v85, v67
    v_mfma_f32_16x16x32_bf16 v[12:15], a[172:175], v[72:75], 0
    v_exp_f32 v68, v68
    s_waitcnt vmcnt(7)
    v_add_u32 v64, s42, v120
    ds_read_b128 v[224:227], v64 offset:8448
    ds_read_b128 v[228:231], v64 offset:8512
    ds_read_b128 v[232:235], v64 offset:8576
    ds_read_b128 v[236:239], v64 offset:8640
    ds_read_b128 v[240:243], v64 offset:8960
    ds_read_b128 v[244:247], v64 offset:9024
    ds_read_b128 v[248:251], v64 offset:9088
    ds_read_b128 v[252:255], v64 offset:9152
    s_waitcnt lgkmcnt(0)
    s_add_u32 m0, s31, 96
    v_lshlrev_b32 v112, 16, v224
    buffer_load_dwordx4 v122, s[16:19], s30 offen offset:3072 nt lds
    v_and_b32 v113, 0xffff0000, v224
    v_lshlrev_b32 v114, 16, v225
    v_and_b32 v115, 0xffff0000, v225
    v_lshlrev_b32 v116, 16, v226
    v_and_b32 v117, 0xffff0000, v226
    v_lshlrev_b32 v118, 16, v227
    v_and_b32 v119, 0xffff0000, v227
    v_pk_mul_f32 v[112:113], v[112:113], s[34:35]
    v_pk_mul_f32 v[114:115], v[114:115], s[34:35]
    v_pk_mul_f32 v[116:117], v[116:117], s[34:35]
    v_pk_mul_f32 v[118:119], v[118:119], s[34:35]
    v_cvt_pk_bf16_f32 v224, v112, v113
    v_cvt_pk_bf16_f32 v225, v114, v115
    v_cvt_pk_bf16_f32 v226, v116, v117
    v_cvt_pk_bf16_f32 v227, v118, v119
    v_lshlrev_b32 v112, 16, v228
    v_and_b32 v113, 0xffff0000, v228
    v_lshlrev_b32 v114, 16, v229
    v_and_b32 v115, 0xffff0000, v229
    v_lshlrev_b32 v116, 16, v230
    v_and_b32 v117, 0xffff0000, v230
    v_lshlrev_b32 v118, 16, v231
    v_and_b32 v119, 0xffff0000, v231
    v_pk_mul_f32 v[112:113], v[112:113], s[34:35]
    v_pk_mul_f32 v[114:115], v[114:115], s[34:35]
    v_pk_mul_f32 v[116:117], v[116:117], s[34:35]
    v_pk_mul_f32 v[118:119], v[118:119], s[34:35]
    v_cvt_pk_bf16_f32 v228, v112, v113
    v_cvt_pk_bf16_f32 v229, v114, v115
    v_cvt_pk_bf16_f32 v230, v116, v117
    v_cvt_pk_bf16_f32 v231, v118, v119
    v_lshlrev_b32 v112, 16, v232
    v_and_b32 v113, 0xffff0000, v232
    v_lshlrev_b32 v114, 16, v233
    v_and_b32 v115, 0xffff0000, v233
    v_lshlrev_b32 v116, 16, v234
    v_and_b32 v117, 0xffff0000, v234
    v_lshlrev_b32 v118, 16, v235
    v_and_b32 v119, 0xffff0000, v235
    v_pk_mul_f32 v[112:113], v[112:113], s[34:35]
    v_pk_mul_f32 v[114:115], v[114:115], s[34:35]
    s_add_u32 m0, s32, 0
    v_pk_mul_f32 v[116:117], v[116:117], s[34:35]
    buffer_load_dwordx4 v122, s[20:23], s30 offen offset:0 nt lds
    v_pk_mul_f32 v[118:119], v[118:119], s[34:35]
    v_cvt_pk_bf16_f32 v232, v112, v113
    v_cvt_pk_bf16_f32 v233, v114, v115
    v_cvt_pk_bf16_f32 v234, v116, v117
    v_cvt_pk_bf16_f32 v235, v118, v119
    v_lshlrev_b32 v112, 16, v236
    v_and_b32 v113, 0xffff0000, v236
    v_lshlrev_b32 v114, 16, v237
    v_and_b32 v115, 0xffff0000, v237
    v_lshlrev_b32 v116, 16, v238
    v_and_b32 v117, 0xffff0000, v238
    v_lshlrev_b32 v118, 16, v239
    v_and_b32 v119, 0xffff0000, v239
    v_pk_mul_f32 v[112:113], v[112:113], s[34:35]
    v_pk_mul_f32 v[114:115], v[114:115], s[34:35]
    v_pk_mul_f32 v[116:117], v[116:117], s[34:35]
    v_pk_mul_f32 v[118:119], v[118:119], s[34:35]
    v_cvt_pk_bf16_f32 v236, v112, v113
    v_cvt_pk_bf16_f32 v237, v114, v115
    v_cvt_pk_bf16_f32 v238, v116, v117
    v_cvt_pk_bf16_f32 v239, v118, v119
    v_lshlrev_b32 v112, 16, v240
    v_and_b32 v113, 0xffff0000, v240
    v_lshlrev_b32 v114, 16, v241
    v_and_b32 v115, 0xffff0000, v241
    v_lshlrev_b32 v116, 16, v242
    v_and_b32 v117, 0xffff0000, v242
    v_lshlrev_b32 v118, 16, v243
    v_and_b32 v119, 0xffff0000, v243
    v_pk_mul_f32 v[112:113], v[112:113], s[34:35]
    v_pk_mul_f32 v[114:115], v[114:115], s[34:35]
    v_pk_mul_f32 v[116:117], v[116:117], s[34:35]
    v_pk_mul_f32 v[118:119], v[118:119], s[34:35]
    v_cvt_pk_bf16_f32 v240, v112, v113
    v_cvt_pk_bf16_f32 v241, v114, v115
    v_cvt_pk_bf16_f32 v242, v116, v117
    v_cvt_pk_bf16_f32 v243, v118, v119
    v_lshlrev_b32 v112, 16, v244
    v_and_b32 v113, 0xffff0000, v244
    v_lshlrev_b32 v114, 16, v245
    v_and_b32 v115, 0xffff0000, v245
    s_add_u32 m0, s32, 32
    v_lshlrev_b32 v116, 16, v246
    buffer_load_dwordx4 v122, s[20:23], s30 offen offset:1024 nt lds
    v_and_b32 v117, 0xffff0000, v246
    v_lshlrev_b32 v118, 16, v247
    v_and_b32 v119, 0xffff0000, v247
    v_pk_mul_f32 v[112:113], v[112:113], s[34:35]
    v_pk_mul_f32 v[114:115], v[114:115], s[34:35]
    v_pk_mul_f32 v[116:117], v[116:117], s[34:35]
    v_pk_mul_f32 v[118:119], v[118:119], s[34:35]
    v_cvt_pk_bf16_f32 v244, v112, v113
    v_cvt_pk_bf16_f32 v245, v114, v115
    v_cvt_pk_bf16_f32 v246, v116, v117
    v_cvt_pk_bf16_f32 v247, v118, v119
    v_lshlrev_b32 v112, 16, v248
    v_and_b32 v113, 0xffff0000, v248
    v_lshlrev_b32 v114, 16, v249
    v_and_b32 v115, 0xffff0000, v249
    v_lshlrev_b32 v116, 16, v250
    v_and_b32 v117, 0xffff0000, v250
    v_lshlrev_b32 v118, 16, v251
    v_and_b32 v119, 0xffff0000, v251
    v_pk_mul_f32 v[112:113], v[112:113], s[34:35]
    v_pk_mul_f32 v[114:115], v[114:115], s[34:35]
    v_pk_mul_f32 v[116:117], v[116:117], s[34:35]
    v_pk_mul_f32 v[118:119], v[118:119], s[34:35]
    v_cvt_pk_bf16_f32 v248, v112, v113
    v_cvt_pk_bf16_f32 v249, v114, v115
    v_cvt_pk_bf16_f32 v250, v116, v117
    v_cvt_pk_bf16_f32 v251, v118, v119
    v_lshlrev_b32 v112, 16, v252
    v_and_b32 v113, 0xffff0000, v252
    v_lshlrev_b32 v114, 16, v253
    v_and_b32 v115, 0xffff0000, v253
    v_lshlrev_b32 v116, 16, v254
    v_and_b32 v117, 0xffff0000, v254
    v_lshlrev_b32 v118, 16, v255
    v_and_b32 v119, 0xffff0000, v255
    v_pk_mul_f32 v[112:113], v[112:113], s[34:35]
    v_pk_mul_f32 v[114:115], v[114:115], s[34:35]
    v_pk_mul_f32 v[116:117], v[116:117], s[34:35]
    v_pk_mul_f32 v[118:119], v[118:119], s[34:35]
    v_cvt_pk_bf16_f32 v252, v112, v113
    v_cvt_pk_bf16_f32 v253, v114, v115
    v_cvt_pk_bf16_f32 v254, v116, v117
    v_cvt_pk_bf16_f32 v255, v118, v119
    v_mfma_f32_16x16x32_bf16 v[64:67], a[128:131], v[224:227], 0
    v_mfma_f32_16x16x32_bf16 v[64:67], a[132:135], v[228:231], v[64:67]
    v_mfma_f32_16x16x32_bf16 v[64:67], a[136:139], v[232:235], v[64:67]
    v_mfma_f32_16x16x32_bf16 v[64:67], a[140:143], v[236:239], v[64:67]
    v_mfma_f32_16x16x32_bf16 v[116:119], a[128:131], v[240:243], 0
    v_mfma_f32_16x16x32_bf16 v[116:119], a[132:135], v[244:247], v[116:119]
    v_mfma_f32_16x16x32_bf16 v[116:119], a[136:139], v[248:251], v[116:119]
    v_mfma_f32_16x16x32_bf16 v[116:119], a[140:143], v[252:255], v[116:119]
    s_nop 3
    v_max3_f32 v86, v64, v65, v66
    v_max_f32 v86, v86, v67
    s_nop 1
    v_max3_f32 v87, v116, v117, v118
    v_max_f32 v87, v87, v119
    s_nop 1
    v_permlane32_swap_b32 v86, v87
    v_max_f32 v86, v86, v87
    v_mov_b32 v87, v86
    s_nop 1
    v_permlane16_swap_b32 v86, v87
    v_max_f32 v86, v86, v87
    v_mov_b32 v87, v86
    s_nop 1
    v_permlane32_swap_b32 v86, v87
    v_sub_f32 v112, 0, v86
    v_sub_f32 v116, 0, v87
    v_sub_f32 v113, 0, v86
    v_sub_f32 v117, 0, v87
    v_sub_f32 v114, 0, v86
    v_sub_f32 v118, 0, v87
    v_sub_f32 v115, 0, v86
    v_sub_f32 v119, 0, v87
    v_mov_b32 v86, 0
    v_mov_b32 v87, 0
    s_cmp_eq_u32 s40, 0
    s_cbranch_scc1 L_ov3
    v_lshrrev_b32 v64, 2, v122
    s_lshl_b32 s36, s28, 11
    v_add_u32 v64, s36, v64
    v_add_u32 v64, 135168, v64
    ds_read_b32 v112, v64 offset:1536
    ds_read_b32 v116, v64 offset:1792
    s_waitcnt lgkmcnt(0)
    v_mov_b32 v113, v112
    v_mov_b32 v114, v112
    v_mov_b32 v115, v112
    v_mov_b32 v117, v116
    v_mov_b32 v118, v116
    v_mov_b32 v119, v116
L_ov3:
    s_waitcnt vmcnt(6)
    s_barrier
    v_mfma_f32_16x16x32_bf16 v[64:67], a[128:131], v[224:227], v[112:115]
    v_add_f32 v85, v85, v68
    v_mfma_f32_16x16x32_bf16 v[64:67], a[132:135], v[228:231], v[64:67]
    v_exp_f32 v69, v69
    v_mfma_f32_16x16x32_bf16 v[64:67], a[136:139], v[232:235], v[64:67]
    v_cvt_pk_bf16_f32 v78, v68, v69
    v_add_f32 v85, v85, v69
    v_mfma_f32_16x16x32_bf16 v[64:67], a[140:143], v[236:239], v[64:67]
    s_add_u32 m0, s32, 64
    v_exp_f32 v70, v70
    v_mfma_f32_16x16x32_bf16 v[16:19], a[176:179], v[72:75], 0
    buffer_load_dwordx4 v122, s[20:23], s30 offen offset:2048 nt lds
    v_add_f32 v85, v85, v70
    v_mfma_f32_16x16x32_bf16 v[20:23], a[180:183], v[72:75], 0
    v_exp_f32 v71, v71
    v_mfma_f32_16x16x32_bf16 v[24:27], a[184:187], v[72:75], 0
    v_cvt_pk_bf16_f32 v79, v70, v71
    v_add_f32 v85, v85, v71
    v_mfma_f32_16x16x32_bf16 v[28:31], a[188:191], v[72:75], 0
    v_exp_f32 v64, v64
    v_mfma_f32_16x16x32_bf16 v[68:71], a[144:147], v[224:227], v[112:115]
    v_add_f32 v86, v86, v64
    v_mfma_f32_16x16x32_bf16 v[68:71], a[148:151], v[228:231], v[68:71]
    v_exp_f32 v65, v65
    v_mfma_f32_16x16x32_bf16 v[68:71], a[152:155], v[232:235], v[68:71]
    v_cvt_pk_bf16_f32 v72, v64, v65
    v_add_f32 v86, v86, v65
    v_mfma_f32_16x16x32_bf16 v[68:71], a[156:159], v[236:239], v[68:71]
    s_add_u32 m0, s32, 96
    v_exp_f32 v66, v66
    v_mfma_f32_16x16x32_bf16 v[32:35], a[160:163], v[76:79], 0
    buffer_load_dwordx4 v122, s[20:23], s30 offen offset:3072 nt lds
    v_add_f32 v86, v86, v66
    v_mfma_f32_16x16x32_bf16 v[36:39], a[164:167], v[76:79], 0
    v_exp_f32 v67, v67
    v_mfma_f32_16x16x32_bf16 v[40:43], a[168:171], v[76:79], 0
    v_cvt_pk_bf16_f32 v73, v66, v67
    v_add_f32 v86, v86, v67
    v_mfma_f32_16x16x32_bf16 v[44:47], a[172:175], v[76:79], 0
    v_exp_f32 v68, v68
    v_mfma_f32_16x16x32_bf16 v[64:67], a[128:131], v[240:243], v[116:119]
    ds_read_b128 a[128:131], v120 offset:8448
    v_add_f32 v86, v86, v68
    v_mfma_f32_16x16x32_bf16 v[64:67], a[132:135], v[244:247], v[64:67]
    s_lshl_b32 s30, s28, 12
    v_exp_f32 v69, v69
    v_mfma_f32_16x16x32_bf16 v[64:67], a[136:139], v[248:251], v[64:67]
    s_add_u32 s30, s30, 32768
    v_cvt_pk_bf16_f32 v74, v68, v69
    v_add_f32 v86, v86, v69
    v_mfma_f32_16x16x32_bf16 v[64:67], a[140:143], v[252:255], v[64:67]
    s_mul_i32 s31, s28, 4224
    v_exp_f32 v70, v70
    v_mfma_f32_16x16x32_bf16 v[48:51], a[176:179], v[76:79], 0
    s_add_u32 s32, s31, 101376
    ds_read_b128 a[132:135], v120 offset:8512
    v_add_f32 v86, v86, v70
    v_mfma_f32_16x16x32_bf16 v[52:55], a[180:183], v[76:79], 0
    s_add_u32 s31, s31, 33792
    ds_read_b128 a[136:139], v120 offset:8576
    v_exp_f32 v71, v71
    v_mfma_f32_16x16x32_bf16 v[56:59], a[184:187], v[76:79], 0
    v_cvt_pk_bf16_f32 v75, v70, v71
    v_add_f32 v86, v86, v71
    v_mfma_f32_16x16x32_bf16 v[60:63], a[188:191], v[76:79], 0
    s_add_u32 m0, s31, 0
    v_exp_f32 v64, v64
    v_mfma_f32_16x16x32_bf16 v[68:71], a[144:147], v[240:243], v[116:119]
    ds_read_b128 a[140:143], v120 offset:8640
    buffer_load_dwordx4 v122, s[16:19], s30 offen offset:0 nt lds
    v_add_f32 v87, v87, v64
    v_mfma_f32_16x16x32_bf16 v[68:71], a[148:151], v[244:247], v[68:71]
    v_exp_f32 v65, v65
    v_mfma_f32_16x16x32_bf16 v[68:71], a[152:155], v[248:251], v[68:71]
    v_cvt_pk_bf16_f32 v76, v64, v65
    v_add_f32 v87, v87, v65
    v_mfma_f32_16x16x32_bf16 v[68:71], a[156:159], v[252:255], v[68:71]
    v_exp_f32 v66, v66
    v_mfma_f32_16x16x32_bf16 a[192:195], a[160:163], v[72:75], 0
    ds_read_b128 a[144:147], v120 offset:8960
    v_add_f32 v87, v87, v66
    v_mfma_f32_16x16x32_bf16 a[196:199], a[164:167], v[72:75], 0
    ds_read_b128 a[148:151], v120 offset:9024
    v_exp_f32 v67, v67
    v_mfma_f32_16x16x32_bf16 a[200:203], a[168:171], v[72:75], 0
    v_cvt_pk_bf16_f32 v77, v66, v67
    v_add_f32 v87, v87, v67
    v_mfma_f32_16x16x32_bf16 a[204:207], a[172:175], v[72:75], 0
    s_waitcnt lgkmcnt(5)
    s_add_u32 m0, s31, 32
    v_exp_f32 v68, v68
    v_mfma_f32_16x16x32_bf16 v[64:67], a[128:131], v[128:131], v[88:91]
    s_waitcnt lgkmcnt(4)
    ds_read_b128 a[152:155], v120 offset:9088
    buffer_load_dwordx4 v122, s[16:19], s30 offen offset:1024 nt lds
    v_add_f32 v87, v87, v68
    v_mfma_f32_16x16x32_bf16 v[64:67], a[132:135], v[132:135], v[64:67]
    s_waitcnt lgkmcnt(4)
    v_exp_f32 v69, v69
    v_mfma_f32_16x16x32_bf16 v[64:67], a[136:139], v[136:139], v[64:67]
    s_waitcnt lgkmcnt(3)
    v_cvt_pk_bf16_f32 v78, v68, v69
    v_add_f32 v87, v87, v69
    v_mfma_f32_16x16x32_bf16 v[64:67], a[140:143], v[140:143], v[64:67]
    v_exp_f32 v70, v70
    v_mfma_f32_16x16x32_bf16 a[208:211], a[176:179], v[72:75], 0
    ds_read_b128 a[156:159], v120 offset:9152
    v_add_f32 v87, v87, v70
    v_mfma_f32_16x16x32_bf16 a[212:215], a[180:183], v[72:75], 0
    v_exp_f32 v71, v71
    v_mfma_f32_16x16x32_bf16 a[216:219], a[184:187], v[72:75], 0
    v_cvt_pk_bf16_f32 v79, v70, v71
    v_add_f32 v87, v87, v71
    v_mfma_f32_16x16x32_bf16 a[220:223], a[188:191], v[72:75], 0
    s_waitcnt lgkmcnt(3)
    s_add_u32 m0, s31, 64
    v_exp_f32 v64, v64
    v_mfma_f32_16x16x32_bf16 v[68:71], a[144:147], v[128:131], v[88:91]
    s_waitcnt lgkmcnt(2)
    buffer_load_dwordx4 v122, s[16:19], s30 offen offset:2048 nt lds
    v_add_f32 v80, v80, v64
    v_mfma_f32_16x16x32_bf16 v[68:71], a[148:151], v[132:135], v[68:71]
    s_waitcnt lgkmcnt(1)
    v_exp_f32 v65, v65
    v_mfma_f32_16x16x32_bf16 v[68:71], a[152:155], v[136:139], v[68:71]
    s_waitcnt lgkmcnt(0)
    v_cvt_pk_bf16_f32 v72, v64, v65
    v_add_f32 v80, v80, v65
    v_mfma_f32_16x16x32_bf16 v[68:71], a[156:159], v[140:143], v[68:71]
    v_exp_f32 v66, v66
    v_mfma_f32_16x16x32_bf16 a[224:227], a[160:163], v[76:79], 0
    ds_read_b64_tr_b16 a[160:161], v121 offset:8448
    v_add_f32 v80, v80, v66
    v_mfma_f32_16x16x32_bf16 a[228:231], a[164:167], v[76:79], 0
    ds_read_b64_tr_b16 a[162:163], v121 offset:8960
    v_exp_f32 v67, v67
    v_mfma_f32_16x16x32_bf16 a[232:235], a[168:171], v[76:79], 0
    v_cvt_pk_bf16_f32 v73, v66, v67
    v_add_f32 v80, v80, v67
    v_mfma_f32_16x16x32_bf16 a[236:239], a[172:175], v[76:79], 0
    s_add_u32 m0, s31, 96
    ds_read_b64_tr_b16 a[164:165], v121 offset:8480
    v_exp_f32 v68, v68
    v_mfma_f32_16x16x32_bf16 v[64:67], a[128:131], v[144:147], v[92:95]
    ds_read_b64_tr_b16 a[166:167], v121 offset:8992
    buffer_load_dwordx4 v122, s[16:19], s30 offen offset:3072 nt lds
    v_add_f32 v80, v80, v68
    v_mfma_f32_16x16x32_bf16 v[64:67], a[132:135], v[148:151], v[64:67]
    ds_read_b64_tr_b16 a[168:169], v121 offset:8512
    v_exp_f32 v69, v69
    v_mfma_f32_16x16x32_bf16 v[64:67], a[136:139], v[152:155], v[64:67]
    v_cvt_pk_bf16_f32 v74, v68, v69
    v_add_f32 v80, v80, v69
    v_mfma_f32_16x16x32_bf16 v[64:67], a[140:143], v[156:159], v[64:67]
    ds_read_b64_tr_b16 a[170:171], v121 offset:9024
    v_exp_f32 v70, v70
    v_mfma_f32_16x16x32_bf16 a[240:243], a[176:179], v[76:79], 0
    ds_read_b64_tr_b16 a[172:173], v121 offset:8544
    v_add_f32 v80, v80, v70
    v_mfma_f32_16x16x32_bf16 a[244:247], a[180:183], v[76:79], 0
    ds_read_b64_tr_b16 a[174:175], v121 offset:9056
    v_exp_f32 v71, v71
    v_mfma_f32_16x16x32_bf16 a[248:251], a[184:187], v[76:79], 0
    v_cvt_pk_bf16_f32 v75, v70, v71
    v_add_f32 v80, v80, v71
    v_mfma_f32_16x16x32_bf16 a[252:255], a[188:191], v[76:79], 0
    s_add_u32 m0, s32, 0
    ds_read_b64_tr_b16 a[176:177], v121 offset:8576
    v_exp_f32 v64, v64
    v_mfma_f32_16x16x32_bf16 v[68:71], a[144:147], v[144:147], v[92:95]
    ds_read_b64_tr_b16 a[178:179], v121 offset:9088
    buffer_load_dwordx4 v122, s[20:23], s30 offen offset:0 nt lds
    v_add_f32 v81, v81, v64
    v_mfma_f32_16x16x32_bf16 v[68:71], a[148:151], v[148:151], v[68:71]
    ds_read_b64_tr_b16 a[180:181], v121 offset:8608
    v_exp_f32 v65, v65
    v_mfma_f32_16x16x32_bf16 v[68:71], a[152:155], v[152:155], v[68:71]
    v_cvt_pk_bf16_f32 v76, v64, v65
    v_add_f32 v81, v81, v65
    v_mfma_f32_16x16x32_bf16 v[68:71], a[156:159], v[156:159], v[68:71]
    s_waitcnt lgkmcnt(9)
    ds_read_b64_tr_b16 a[182:183], v121 offset:9120
    v_exp_f32 v66, v66
    v_mfma_f32_16x16x32_bf16 a[0:3], a[160:163], v[72:75], a[0:3]
    s_waitcnt lgkmcnt(8)
    ds_read_b64_tr_b16 a[184:185], v121 offset:8640
    v_add_f32 v81, v81, v66
    v_mfma_f32_16x16x32_bf16 a[4:7], a[164:167], v[72:75], a[4:7]
    s_waitcnt lgkmcnt(7)
    ds_read_b64_tr_b16 a[186:187], v121 offset:9152
    v_exp_f32 v67, v67
    v_mfma_f32_16x16x32_bf16 a[8:11], a[168:171], v[72:75], a[8:11]
    s_waitcnt lgkmcnt(6)
    v_cvt_pk_bf16_f32 v77, v66, v67
    v_add_f32 v81, v81, v67
    v_mfma_f32_16x16x32_bf16 a[12:15], a[172:175], v[72:75], a[12:15]
    s_add_u32 m0, s32, 32
    ds_read_b64_tr_b16 a[188:189], v121 offset:8672
    v_exp_f32 v68, v68
    v_mfma_f32_16x16x32_bf16 v[64:67], a[128:131], v[160:163], v[96:99]
    ds_read_b64_tr_b16 a[190:191], v121 offset:9184
    buffer_load_dwordx4 v122, s[20:23], s30 offen offset:1024 nt lds
    v_add_f32 v81, v81, v68
    v_mfma_f32_16x16x32_bf16 v[64:67], a[132:135], v[164:167], v[64:67]
    v_exp_f32 v69, v69
    v_mfma_f32_16x16x32_bf16 v[64:67], a[136:139], v[168:171], v[64:67]
    v_cvt_pk_bf16_f32 v78, v68, v69
    v_add_f32 v81, v81, v69
    v_mfma_f32_16x16x32_bf16 v[64:67], a[140:143], v[172:175], v[64:67]
    s_waitcnt lgkmcnt(6)
    v_exp_f32 v70, v70
    v_mfma_f32_16x16x32_bf16 a[16:19], a[176:179], v[72:75], a[16:19]
    s_waitcnt lgkmcnt(4)
    v_add_f32 v81, v81, v70
    v_mfma_f32_16x16x32_bf16 a[20:23], a[180:183], v[72:75], a[20:23]
    s_waitcnt lgkmcnt(2)
    v_exp_f32 v71, v71
    v_mfma_f32_16x16x32_bf16 a[24:27], a[184:187], v[72:75], a[24:27]
    s_waitcnt lgkmcnt(0)
    v_cvt_pk_bf16_f32 v79, v70, v71
    v_add_f32 v81, v81, v71
    v_mfma_f32_16x16x32_bf16 a[28:31], a[188:191], v[72:75], a[28:31]
    s_add_u32 m0, s32, 64
    v_exp_f32 v64, v64
    v_mfma_f32_16x16x32_bf16 v[68:71], a[144:147], v[160:163], v[96:99]
    buffer_load_dwordx4 v122, s[20:23], s30 offen offset:2048 nt lds
    v_add_f32 v82, v82, v64
    v_mfma_f32_16x16x32_bf16 v[68:71], a[148:151], v[164:167], v[68:71]
    v_exp_f32 v65, v65
    v_mfma_f32_16x16x32_bf16 v[68:71], a[152:155], v[168:171], v[68:71]
    v_cvt_pk_bf16_f32 v72, v64, v65
    v_add_f32 v82, v82, v65
    v_mfma_f32_16x16x32_bf16 v[68:71], a[156:159], v[172:175], v[68:71]
    v_exp_f32 v66, v66
    v_mfma_f32_16x16x32_bf16 a[32:35], a[160:163], v[76:79], a[32:35]
    v_add_f32 v82, v82, v66
    v_mfma_f32_16x16x32_bf16 a[36:39], a[164:167], v[76:79], a[36:39]
    v_exp_f32 v67, v67
    v_mfma_f32_16x16x32_bf16 a[40:43], a[168:171], v[76:79], a[40:43]
    v_cvt_pk_bf16_f32 v73, v66, v67
    v_add_f32 v82, v82, v67
    v_mfma_f32_16x16x32_bf16 a[44:47], a[172:175], v[76:79], a[44:47]
    s_add_u32 m0, s32, 96
    v_exp_f32 v68, v68
    v_mfma_f32_16x16x32_bf16 v[64:67], a[128:131], v[176:179], v[100:103]
    buffer_load_dwordx4 v122, s[20:23], s30 offen offset:3072 nt lds
    v_add_f32 v82, v82, v68
    v_mfma_f32_16x16x32_bf16 v[64:67], a[132:135], v[180:183], v[64:67]
    v_exp_f32 v69, v69
    v_mfma_f32_16x16x32_bf16 v[64:67], a[136:139], v[184:187], v[64:67]
    v_cvt_pk_bf16_f32 v74, v68, v69
    v_add_f32 v82, v82, v69
    v_mfma_f32_16x16x32_bf16 v[64:67], a[140:143], v[188:191], v[64:67]
    v_exp_f32 v70, v70
    v_mfma_f32_16x16x32_bf16 a[48:51], a[176:179], v[76:79], a[48:51]
    v_add_f32 v82, v82, v70
    v_mfma_f32_16x16x32_bf16 a[52:55], a[180:183], v[76:79], a[52:55]
    v_exp_f32 v71, v71
    v_mfma_f32_16x16x32_bf16 a[56:59], a[184:187], v[76:79], a[56:59]
    v_cvt_pk_bf16_f32 v75, v70, v71
    v_add_f32 v82, v82, v71
    v_mfma_f32_16x16x32_bf16 a[60:63], a[188:191], v[76:79], a[60:63]
    v_exp_f32 v64, v64
    v_mfma_f32_16x16x32_bf16 v[68:71], a[144:147], v[176:179], v[100:103]
    v_add_f32 v83, v83, v64
    v_mfma_f32_16x16x32_bf16 v[68:71], a[148:151], v[180:183], v[68:71]
    v_exp_f32 v65, v65
    v_mfma_f32_16x16x32_bf16 v[68:71], a[152:155], v[184:187], v[68:71]
    v_cvt_pk_bf16_f32 v76, v64, v65
    v_add_f32 v83, v83, v65
    v_mfma_f32_16x16x32_bf16 v[68:71], a[156:159], v[188:191], v[68:71]
    v_exp_f32 v66, v66
    v_mfma_f32_16x16x32_bf16 a[64:67], a[160:163], v[72:75], a[64:67]
    v_add_f32 v83, v83, v66
    v_mfma_f32_16x16x32_bf16 a[68:71], a[164:167], v[72:75], a[68:71]
    v_exp_f32 v67, v67
    v_mfma_f32_16x16x32_bf16 a[72:75], a[168:171], v[72:75], a[72:75]
    v_cvt_pk_bf16_f32 v77, v66, v67
    v_add_f32 v83, v83, v67
    v_mfma_f32_16x16x32_bf16 a[76:79], a[172:175], v[72:75], a[76:79]
    v_exp_f32 v68, v68
    v_mfma_f32_16x16x32_bf16 v[64:67], a[128:131], v[192:195], v[104:107]
    v_add_f32 v83, v83, v68
    v_mfma_f32_16x16x32_bf16 v[64:67], a[132:135], v[196:199], v[64:67]
    v_exp_f32 v69, v69
    v_mfma_f32_16x16x32_bf16 v[64:67], a[136:139], v[200:203], v[64:67]
    v_cvt_pk_bf16_f32 v78, v68, v69
    v_add_f32 v83, v83, v69
    v_mfma_f32_16x16x32_bf16 v[64:67], a[140:143], v[204:207], v[64:67]
    v_exp_f32 v70, v70
    v_mfma_f32_16x16x32_bf16 a[80:83], a[176:179], v[72:75], a[80:83]
    v_add_f32 v83, v83, v70
    v_mfma_f32_16x16x32_bf16 a[84:87], a[180:183], v[72:75], a[84:87]
    v_exp_f32 v71, v71
    v_mfma_f32_16x16x32_bf16 a[88:91], a[184:187], v[72:75], a[88:91]
    v_cvt_pk_bf16_f32 v79, v70, v71
    v_add_f32 v83, v83, v71
    v_mfma_f32_16x16x32_bf16 a[92:95], a[188:191], v[72:75], a[92:95]
    v_exp_f32 v64, v64
    v_mfma_f32_16x16x32_bf16 v[68:71], a[144:147], v[192:195], v[104:107]
    v_add_f32 v84, v84, v64
    v_mfma_f32_16x16x32_bf16 v[68:71], a[148:151], v[196:199], v[68:71]
    v_exp_f32 v65, v65
    v_mfma_f32_16x16x32_bf16 v[68:71], a[152:155], v[200:203], v[68:71]
    v_cvt_pk_bf16_f32 v72, v64, v65
    v_add_f32 v84, v84, v65
    v_mfma_f32_16x16x32_bf16 v[68:71], a[156:159], v[204:207], v[68:71]
    v_exp_f32 v66, v66
    v_mfma_f32_16x16x32_bf16 a[96:99], a[160:163], v[76:79], a[96:99]
    v_add_f32 v84, v84, v66
    v_mfma_f32_16x16x32_bf16 a[100:103], a[164:167], v[76:79], a[100:103]
    v_exp_f32 v67, v67
    v_mfma_f32_16x16x32_bf16 a[104:107], a[168:171], v[76:79], a[104:107]
    v_cvt_pk_bf16_f32 v73, v66, v67
    v_add_f32 v84, v84, v67
    v_mfma_f32_16x16x32_bf16 a[108:111], a[172:175], v[76:79], a[108:111]
    v_exp_f32 v68, v68
    v_mfma_f32_16x16x32_bf16 v[64:67], a[128:131], v[208:211], v[108:111]
    v_add_f32 v84, v84, v68
    v_mfma_f32_16x16x32_bf16 v[64:67], a[132:135], v[212:215], v[64:67]
    v_exp_f32 v69, v69
    v_mfma_f32_16x16x32_bf16 v[64:67], a[136:139], v[216:219], v[64:67]
    v_cvt_pk_bf16_f32 v74, v68, v69
    v_add_f32 v84, v84, v69
    v_mfma_f32_16x16x32_bf16 v[64:67], a[140:143], v[220:223], v[64:67]
    v_exp_f32 v70, v70
    v_mfma_f32_16x16x32_bf16 a[112:115], a[176:179], v[76:79], a[112:115]
    v_add_f32 v84, v84, v70
    v_mfma_f32_16x16x32_bf16 a[116:119], a[180:183], v[76:79], a[116:119]
    v_exp_f32 v71, v71
    v_mfma_f32_16x16x32_bf16 a[120:123], a[184:187], v[76:79], a[120:123]
    v_cvt_pk_bf16_f32 v75, v70, v71
    v_add_f32 v84, v84, v71
    v_mfma_f32_16x16x32_bf16 a[124:127], a[188:191], v[76:79], a[124:127]
    v_exp_f32 v64, v64
    v_mfma_f32_16x16x32_bf16 v[68:71], a[144:147], v[208:211], v[108:111]
    v_add_f32 v85, v85, v64
    v_mfma_f32_16x16x32_bf16 v[68:71], a[148:151], v[212:215], v[68:71]
    v_exp_f32 v65, v65
    v_mfma_f32_16x16x32_bf16 v[68:71], a[152:155], v[216:219], v[68:71]
    v_cvt_pk_bf16_f32 v76, v64, v65
    v_add_f32 v85, v85, v65
    v_mfma_f32_16x16x32_bf16 v[68:71], a[156:159], v[220:223], v[68:71]
    v_exp_f32 v66, v66
    v_mfma_f32_16x16x32_bf16 v[0:3], a[160:163], v[72:75], v[0:3]
    v_add_f32 v85, v85, v66
    v_mfma_f32_16x16x32_bf16 v[4:7], a[164:167], v[72:75], v[4:7]
    v_exp_f32 v67, v67
    v_mfma_f32_16x16x32_bf16 v[8:11], a[168:171], v[72:75], v[8:11]
    v_cvt_pk_bf16_f32 v77, v66, v67
    v_add_f32 v85, v85, v67
    v_mfma_f32_16x16x32_bf16 v[12:15], a[172:175], v[72:75], v[12:15]
    v_exp_f32 v68, v68
    v_mfma_f32_16x16x32_bf16 v[64:67], a[128:131], v[224:227], v[112:115]
    v_add_f32 v85, v85, v68
    v_mfma_f32_16x16x32_bf16 v[64:67], a[132:135], v[228:231], v[64:67]
    v_exp_f32 v69, v69
    v_mfma_f32_16x16x32_bf16 v[64:67], a[136:139], v[232:235], v[64:67]
    v_cvt_pk_bf16_f32 v78, v68, v69
    v_add_f32 v85, v85, v69
    v_mfma_f32_16x16x32_bf16 v[64:67], a[140:143], v[236:239], v[64:67]
    v_exp_f32 v70, v70
    v_mfma_f32_16x16x32_bf16 v[16:19], a[176:179], v[72:75], v[16:19]
    v_add_f32 v85, v85, v70
    v_mfma_f32_16x16x32_bf16 v[20:23], a[180:183], v[72:75], v[20:23]
    v_exp_f32 v71, v71
    v_mfma_f32_16x16x32_bf16 v[24:27], a[184:187], v[72:75], v[24:27]
    v_cvt_pk_bf16_f32 v79, v70, v71
    v_add_f32 v85, v85, v71
    v_mfma_f32_16x16x32_bf16 v[28:31], a[188:191], v[72:75], v[28:31]
    v_exp_f32 v64, v64
    v_mfma_f32_16x16x32_bf16 v[68:71], a[144:147], v[224:227], v[112:115]
    v_add_f32 v86, v86, v64
    v_mfma_f32_16x16x32_bf16 v[68:71], a[148:151], v[228:231], v[68:71]
    v_exp_f32 v65, v65
    v_mfma_f32_16x16x32_bf16 v[68:71], a[152:155], v[232:235], v[68:71]
    v_cvt_pk_bf16_f32 v72, v64, v65
    v_add_f32 v86, v86, v65
    v_mfma_f32_16x16x32_bf16 v[68:71], a[156:159], v[236:239], v[68:71]
    v_exp_f32 v66, v66
    v_mfma_f32_16x16x32_bf16 v[32:35], a[160:163], v[76:79], v[32:35]
    v_add_f32 v86, v86, v66
    v_mfma_f32_16x16x32_bf16 v[36:39], a[164:167], v[76:79], v[36:39]
    v_exp_f32 v67, v67
    v_mfma_f32_16x16x32_bf16 v[40:43], a[168:171], v[76:79], v[40:43]
    s_waitcnt vmcnt(8)
    v_cvt_pk_bf16_f32 v73, v66, v67
    v_add_f32 v86, v86, v67
    v_mfma_f32_16x16x32_bf16 v[44:47], a[172:175], v[76:79], v[44:47]
    s_barrier
    v_exp_f32 v68, v68
    v_mfma_f32_16x16x32_bf16 v[64:67], a[128:131], v[240:243], v[116:119]
    ds_read_b128 a[128:131], v120 offset:16896
    v_add_f32 v86, v86, v68
    v_mfma_f32_16x16x32_bf16 v[64:67], a[132:135], v[244:247], v[64:67]
    v_exp_f32 v69, v69
    v_mfma_f32_16x16x32_bf16 v[64:67], a[136:139], v[248:251], v[64:67]
    v_cvt_pk_bf16_f32 v74, v68, v69
    v_add_f32 v86, v86, v69
    v_mfma_f32_16x16x32_bf16 v[64:67], a[140:143], v[252:255], v[64:67]
    v_exp_f32 v70, v70
    v_mfma_f32_16x16x32_bf16 v[48:51], a[176:179], v[76:79], v[48:51]
    ds_read_b128 a[132:135], v120 offset:16960
    v_add_f32 v86, v86, v70
    v_mfma_f32_16x16x32_bf16 v[52:55], a[180:183], v[76:79], v[52:55]
    ds_read_b128 a[136:139], v120 offset:17024
    v_exp_f32 v71, v71
    v_mfma_f32_16x16x32_bf16 v[56:59], a[184:187], v[76:79], v[56:59]
    v_cvt_pk_bf16_f32 v75, v70, v71
    v_add_f32 v86, v86, v71
    v_mfma_f32_16x16x32_bf16 v[60:63], a[188:191], v[76:79], v[60:63]
    v_exp_f32 v64, v64
    v_mfma_f32_16x16x32_bf16 v[68:71], a[144:147], v[240:243], v[116:119]
    s_mov_b32 s29, 1
    ds_read_b128 a[140:143], v120 offset:17088
    v_add_f32 v87, v87, v64
    v_add_u32 v121, s41, v121
    v_mfma_f32_16x16x32_bf16 v[68:71], a[148:151], v[244:247], v[68:71]
    v_exp_f32 v65, v65
    v_mfma_f32_16x16x32_bf16 v[68:71], a[152:155], v[248:251], v[68:71]
    v_cvt_pk_bf16_f32 v76, v64, v65
    v_add_f32 v87, v87, v65
    v_mfma_f32_16x16x32_bf16 v[68:71], a[156:159], v[252:255], v[68:71]
    v_exp_f32 v66, v66
    v_mfma_f32_16x16x32_bf16 a[192:195], a[160:163], v[72:75], a[192:195]
    ds_read_b128 a[144:147], v120 offset:17408
    v_add_f32 v87, v87, v66
    v_mfma_f32_16x16x32_bf16 a[196:199], a[164:167], v[72:75], a[196:199]
    ds_read_b128 a[148:151], v120 offset:17472
    v_exp_f32 v67, v67
    v_mfma_f32_16x16x32_bf16 a[200:203], a[168:171], v[72:75], a[200:203]
    v_cvt_pk_bf16_f32 v77, v66, v67
    v_add_f32 v87, v87, v67
    v_mfma_f32_16x16x32_bf16 a[204:207], a[172:175], v[72:75], a[204:207]
    s_waitcnt lgkmcnt(5)
    v_exp_f32 v68, v68
    v_add_u32 v120, s41, v120
.p2align 6
L_loopa:
    v_mfma_f32_16x16x32_bf16 v[64:67], a[128:131], v[128:131], v[88:91]
    s_waitcnt lgkmcnt(4)
    ds_read_b128 a[152:155], v120 offset:640
    v_add_f32 v87, v87, v68
    v_mfma_f32_16x16x32_bf16 v[64:67], a[132:135], v[132:135], v[64:67]
    s_waitcnt lgkmcnt(4)
    v_exp_f32 v69, v69
    v_mfma_f32_16x16x32_bf16 v[64:67], a[136:139], v[136:139], v[64:67]
    s_waitcnt lgkmcnt(3)
    v_cvt_pk_bf16_f32 v78, v68, v69
    v_add_f32 v87, v87, v69
    v_mfma_f32_16x16x32_bf16 v[64:67], a[140:143], v[140:143], v[64:67]
    v_exp_f32_e64 v70, v70
    v_mfma_f32_16x16x32_bf16 a[208:211], a[176:179], v[72:75], a[208:211]
    ds_read_b128 a[156:159], v120 offset:704
    v_add_f32_e64 v87, v87, v70
    v_mfma_f32_16x16x32_bf16 a[212:215], a[180:183], v[72:75], a[212:215]
    v_exp_f32_e64 v71, v71
    v_mfma_f32_16x16x32_bf16 a[216:219], a[184:187], v[72:75], a[216:219]
    v_cvt_pk_bf16_f32 v79, v70, v71
    v_add_f32_e64 v87, v87, v71
    v_mfma_f32_16x16x32_bf16 a[220:223], a[188:191], v[72:75], a[220:223]
    s_waitcnt lgkmcnt(3)
    v_exp_f32 v64, v64
    v_mfma_f32_16x16x32_bf16 v[68:71], a[144:147], v[128:131], v[88:91]
    s_waitcnt lgkmcnt(2)
    v_add_f32 v80, v80, v64
    v_mfma_f32_16x16x32_bf16 v[68:71], a[148:151], v[132:135], v[68:71]
    s_waitcnt lgkmcnt(1)
    v_exp_f32 v65, v65
    v_mfma_f32_16x16x32_bf16 v[68:71], a[152:155], v[136:139], v[68:71]
    s_waitcnt lgkmcnt(0)
    v_cvt_pk_bf16_f32 v72, v64, v65
    v_add_f32 v80, v80, v65
    v_mfma_f32_16x16x32_bf16 v[68:71], a[156:159], v[140:143], v[68:71]
    v_exp_f32_e64 v66, v66
    v_mfma_f32_16x16x32_bf16 a[224:227], a[160:163], v[76:79], a[224:227]
    ds_read_b64_tr_b16 a[160:161], v121 offset:0
    v_add_f32_e64 v80, v80, v66
    v_mfma_f32_16x16x32_bf16 a[228:231], a[164:167], v[76:79], a[228:231]
    ds_read_b64_tr_b16 a[162:163], v121 offset:512
    v_exp_f32_e64 v67, v67
    v_mfma_f32_16x16x32_bf16 a[232:235], a[168:171], v[76:79], a[232:235]
    v_cvt_pk_bf16_f32 v73, v66, v67
    v_add_f32_e64 v80, v80, v67
    v_mfma_f32_16x16x32_bf16 a[236:239], a[172:175], v[76:79], a[236:239]
    ds_read_b64_tr_b16 a[164:165], v121 offset:32
    v_exp_f32_e64 v68, v68
    v_mfma_f32_16x16x32_bf16 v[64:67], a[128:131], v[144:147], v[92:95]
    ds_read_b64_tr_b16 a[166:167], v121 offset:544
    v_add_f32_e64 v80, v80, v68
    v_mfma_f32_16x16x32_bf16 v[64:67], a[132:135], v[148:151], v[64:67]
    ds_read_b64_tr_b16 a[168:169], v121 offset:64
    v_exp_f32_e64 v69, v69
    v_mfma_f32_16x16x32_bf16 v[64:67], a[136:139], v[152:155], v[64:67]
    v_cvt_pk_bf16_f32 v74, v68, v69
    v_add_f32_e64 v80, v80, v69
    v_mfma_f32_16x16x32_bf16 v[64:67], a[140:143], v[156:159], v[64:67]
    ds_read_b64_tr_b16 a[170:171], v121 offset:576
    v_exp_f32_e64 v70, v70
    v_mfma_f32_16x16x32_bf16 a[240:243], a[176:179], v[76:79], a[240:243]
    ds_read_b64_tr_b16 a[172:173], v121 offset:96
    v_add_f32_e64 v80, v80, v70
    v_mfma_f32_16x16x32_bf16 a[244:247], a[180:183], v[76:79], a[244:247]
    ds_read_b64_tr_b16 a[174:175], v121 offset:608
    v_exp_f32_e64 v71, v71
    v_mfma_f32_16x16x32_bf16 a[248:251], a[184:187], v[76:79], a[248:251]
    v_cvt_pk_bf16_f32 v75, v70, v71
    v_add_f32_e64 v80, v80, v71
    v_mfma_f32_16x16x32_bf16 a[252:255], a[188:191], v[76:79], a[252:255]
    ds_read_b64_tr_b16 a[176:177], v121 offset:128
    v_exp_f32_e64 v64, v64
    v_mfma_f32_16x16x32_bf16 v[68:71], a[144:147], v[144:147], v[92:95]
    ds_read_b64_tr_b16 a[178:179], v121 offset:640
    v_add_f32_e64 v81, v81, v64
    v_mfma_f32_16x16x32_bf16 v[68:71], a[148:151], v[148:151], v[68:71]
    ds_read_b64_tr_b16 a[180:181], v121 offset:160
    v_exp_f32_e64 v65, v65
    v_mfma_f32_16x16x32_bf16 v[68:71], a[152:155], v[152:155], v[68:71]
    v_cvt_pk_bf16_f32 v76, v64, v65
    v_add_f32_e64 v81, v81, v65
    v_mfma_f32_16x16x32_bf16 v[68:71], a[156:159], v[156:159], v[68:71]
    s_waitcnt lgkmcnt(9)
    ds_read_b64_tr_b16 a[182:183], v121 offset:672
    v_exp_f32 v66, v66
    v_mfma_f32_16x16x32_bf16 a[0:3], a[160:163], v[72:75], a[0:3]
    s_waitcnt lgkmcnt(8)
    ds_read_b64_tr_b16 a[184:185], v121 offset:192
    v_add_f32 v81, v81, v66
    v_mfma_f32_16x16x32_bf16 a[4:7], a[164:167], v[72:75], a[4:7]
    s_waitcnt lgkmcnt(7)
    ds_read_b64_tr_b16 a[186:187], v121 offset:704
    v_exp_f32 v67, v67
    v_mfma_f32_16x16x32_bf16 a[8:11], a[168:171], v[72:75], a[8:11]
    s_waitcnt lgkmcnt(6)
    v_cvt_pk_bf16_f32 v77, v66, v67
    v_add_f32 v81, v81, v67
    v_mfma_f32_16x16x32_bf16 a[12:15], a[172:175], v[72:75], a[12:15]
    ds_read_b64_tr_b16 a[188:189], v121 offset:224
    v_exp_f32_e64 v68, v68
    v_mfma_f32_16x16x32_bf16 v[64:67], a[128:131], v[160:163], v[96:99]
    ds_read_b64_tr_b16 a[190:191], v121 offset:736
    v_add_f32_e64 v81, v81, v68
    v_mfma_f32_16x16x32_bf16 v[64:67], a[132:135], v[164:167], v[64:67]
    v_exp_f32_e64 v69, v69
    v_mfma_f32_16x16x32_bf16 v[64:67], a[136:139], v[168:171], v[64:67]
    v_cvt_pk_bf16_f32 v78, v68, v69
    v_add_f32_e64 v81, v81, v69
    v_mfma_f32_16x16x32_bf16 v[64:67], a[140:143], v[172:175], v[64:67]
    s_waitcnt lgkmcnt(6)
    v_exp_f32 v70, v70
    v_mfma_f32_16x16x32_bf16 a[16:19], a[176:179], v[72:75], a[16:19]
    s_waitcnt lgkmcnt(4)
    v_add_f32 v81, v81, v70
    v_mfma_f32_16x16x32_bf16 a[20:23], a[180:183], v[72:75], a[20:23]
    s_waitcnt lgkmcnt(2)
    v_exp_f32 v71, v71
    v_mfma_f32_16x16x32_bf16 a[24:27], a[184:187], v[72:75], a[24:27]
    s_waitcnt lgkmcnt(0)
    v_cvt_pk_bf16_f32 v79, v70, v71
    v_add_f32 v81, v81, v71
    v_mfma_f32_16x16x32_bf16 a[28:31], a[188:191], v[72:75], a[28:31]
    v_exp_f32_e64 v64, v64
    v_mfma_f32_16x16x32_bf16 v[68:71], a[144:147], v[160:163], v[96:99]
    v_add_f32_e64 v82, v82, v64
    v_mfma_f32_16x16x32_bf16 v[68:71], a[148:151], v[164:167], v[68:71]
    v_exp_f32_e64 v65, v65
    v_mfma_f32_16x16x32_bf16 v[68:71], a[152:155], v[168:171], v[68:71]
    v_cvt_pk_bf16_f32 v72, v64, v65
    v_add_f32_e64 v82, v82, v65
    v_mfma_f32_16x16x32_bf16 v[68:71], a[156:159], v[172:175], v[68:71]
    v_exp_f32_e64 v66, v66
    v_mfma_f32_16x16x32_bf16 a[32:35], a[160:163], v[76:79], a[32:35]
    v_add_f32_e64 v82, v82, v66
    v_mfma_f32_16x16x32_bf16 a[36:39], a[164:167], v[76:79], a[36:39]
    v_exp_f32_e64 v67, v67
    v_mfma_f32_16x16x32_bf16 a[40:43], a[168:171], v[76:79], a[40:43]
    v_cvt_pk_bf16_f32 v73, v66, v67
    v_add_f32_e64 v82, v82, v67
    v_mfma_f32_16x16x32_bf16 a[44:47], a[172:175], v[76:79], a[44:47]
    v_exp_f32_e64 v68, v68
    v_mfma_f32_16x16x32_bf16 v[64:67], a[128:131], v[176:179], v[100:103]
    v_add_f32_e64 v82, v82, v68
    v_mfma_f32_16x16x32_bf16 v[64:67], a[132:135], v[180:183], v[64:67]
    v_exp_f32_e64 v69, v69
    v_mfma_f32_16x16x32_bf16 v[64:67], a[136:139], v[184:187], v[64:67]
    v_cvt_pk_bf16_f32 v74, v68, v69
    v_add_f32_e64 v82, v82, v69
    v_mfma_f32_16x16x32_bf16 v[64:67], a[140:143], v[188:191], v[64:67]
    v_exp_f32_e64 v70, v70
    v_mfma_f32_16x16x32_bf16 a[48:51], a[176:179], v[76:79], a[48:51]
    v_add_f32_e64 v82, v82, v70
    v_mfma_f32_16x16x32_bf16 a[52:55], a[180:183], v[76:79], a[52:55]
    v_exp_f32_e64 v71, v71
    v_mfma_f32_16x16x32_bf16 a[56:59], a[184:187], v[76:79], a[56:59]
    v_cvt_pk_bf16_f32 v75, v70, v71
    v_add_f32_e64 v82, v82, v71
    v_mfma_f32_16x16x32_bf16 a[60:63], a[188:191], v[76:79], a[60:63]
    v_exp_f32_e64 v64, v64
    v_mfma_f32_16x16x32_bf16 v[68:71], a[144:147], v[176:179], v[100:103]
    v_add_f32_e64 v83, v83, v64
    v_mfma_f32_16x16x32_bf16 v[68:71], a[148:151], v[180:183], v[68:71]
    v_exp_f32_e64 v65, v65
    v_mfma_f32_16x16x32_bf16 v[68:71], a[152:155], v[184:187], v[68:71]
    v_cvt_pk_bf16_f32 v76, v64, v65
    v_add_f32_e64 v83, v83, v65
    v_mfma_f32_16x16x32_bf16 v[68:71], a[156:159], v[188:191], v[68:71]
    v_exp_f32_e64 v66, v66
    v_mfma_f32_16x16x32_bf16 a[64:67], a[160:163], v[72:75], a[64:67]
    v_add_f32_e64 v83, v83, v66
    v_mfma_f32_16x16x32_bf16 a[68:71], a[164:167], v[72:75], a[68:71]
    v_exp_f32_e64 v67, v67
    v_mfma_f32_16x16x32_bf16 a[72:75], a[168:171], v[72:75], a[72:75]
    v_cvt_pk_bf16_f32 v77, v66, v67
    v_add_f32_e64 v83, v83, v67
    v_mfma_f32_16x16x32_bf16 a[76:79], a[172:175], v[72:75], a[76:79]
    v_exp_f32_e64 v68, v68
    v_mfma_f32_16x16x32_bf16 v[64:67], a[128:131], v[192:195], v[104:107]
    v_add_f32_e64 v83, v83, v68
    v_mfma_f32_16x16x32_bf16 v[64:67], a[132:135], v[196:199], v[64:67]
    v_exp_f32_e64 v69, v69
    v_mfma_f32_16x16x32_bf16 v[64:67], a[136:139], v[200:203], v[64:67]
    v_cvt_pk_bf16_f32 v78, v68, v69
    v_add_f32_e64 v83, v83, v69
    v_mfma_f32_16x16x32_bf16 v[64:67], a[140:143], v[204:207], v[64:67]
    v_exp_f32_e64 v70, v70
    v_mfma_f32_16x16x32_bf16 a[80:83], a[176:179], v[72:75], a[80:83]
    v_add_f32_e64 v83, v83, v70
    v_mfma_f32_16x16x32_bf16 a[84:87], a[180:183], v[72:75], a[84:87]
    v_exp_f32_e64 v71, v71
    v_mfma_f32_16x16x32_bf16 a[88:91], a[184:187], v[72:75], a[88:91]
    v_cvt_pk_bf16_f32 v79, v70, v71
    v_add_f32_e64 v83, v83, v71
    v_mfma_f32_16x16x32_bf16 a[92:95], a[188:191], v[72:75], a[92:95]
    v_exp_f32_e64 v64, v64
    v_mfma_f32_16x16x32_bf16 v[68:71], a[144:147], v[192:195], v[104:107]
    v_add_f32_e64 v84, v84, v64
    v_mfma_f32_16x16x32_bf16 v[68:71], a[148:151], v[196:199], v[68:71]
    v_exp_f32_e64 v65, v65
    v_mfma_f32_16x16x32_bf16 v[68:71], a[152:155], v[200:203], v[68:71]
    v_cvt_pk_bf16_f32 v72, v64, v65
    v_add_f32_e64 v84, v84, v65
    v_mfma_f32_16x16x32_bf16 v[68:71], a[156:159], v[204:207], v[68:71]
    v_exp_f32_e64 v66, v66
    v_mfma_f32_16x16x32_bf16 a[96:99], a[160:163], v[76:79], a[96:99]
    v_add_f32_e64 v84, v84, v66
    v_mfma_f32_16x16x32_bf16 a[100:103], a[164:167], v[76:79], a[100:103]
    v_exp_f32_e64 v67, v67
    v_mfma_f32_16x16x32_bf16 a[104:107], a[168:171], v[76:79], a[104:107]
    v_cvt_pk_bf16_f32 v73, v66, v67
    v_add_f32_e64 v84, v84, v67
    v_mfma_f32_16x16x32_bf16 a[108:111], a[172:175], v[76:79], a[108:111]
    v_exp_f32_e64 v68, v68
    v_mfma_f32_16x16x32_bf16 v[64:67], a[128:131], v[208:211], v[108:111]
    v_add_f32_e64 v84, v84, v68
    v_mfma_f32_16x16x32_bf16 v[64:67], a[132:135], v[212:215], v[64:67]
    v_exp_f32_e64 v69, v69
    v_mfma_f32_16x16x32_bf16 v[64:67], a[136:139], v[216:219], v[64:67]
    v_cvt_pk_bf16_f32 v74, v68, v69
    v_add_f32_e64 v84, v84, v69
    v_mfma_f32_16x16x32_bf16 v[64:67], a[140:143], v[220:223], v[64:67]
    v_exp_f32_e64 v70, v70
    v_mfma_f32_16x16x32_bf16 a[112:115], a[176:179], v[76:79], a[112:115]
    v_add_f32_e64 v84, v84, v70
    v_mfma_f32_16x16x32_bf16 a[116:119], a[180:183], v[76:79], a[116:119]
    v_exp_f32_e64 v71, v71
    v_mfma_f32_16x16x32_bf16 a[120:123], a[184:187], v[76:79], a[120:123]
    v_cvt_pk_bf16_f32 v75, v70, v71
    v_add_f32_e64 v84, v84, v71
    v_mfma_f32_16x16x32_bf16 a[124:127], a[188:191], v[76:79], a[124:127]
    v_exp_f32_e64 v64, v64
    v_mfma_f32_16x16x32_bf16 v[68:71], a[144:147], v[208:211], v[108:111]
    v_add_f32_e64 v85, v85, v64
    v_mfma_f32_16x16x32_bf16 v[68:71], a[148:151], v[212:215], v[68:71]
    v_exp_f32_e64 v65, v65
    v_mfma_f32_16x16x32_bf16 v[68:71], a[152:155], v[216:219], v[68:71]
    v_cvt_pk_bf16_f32 v76, v64, v65
    v_add_f32_e64 v85, v85, v65
    v_mfma_f32_16x16x32_bf16 v[68:71], a[156:159], v[220:223], v[68:71]
    v_exp_f32_e64 v66, v66
    v_mfma_f32_16x16x32_bf16 v[0:3], a[160:163], v[72:75], v[0:3]
    v_add_f32_e64 v85, v85, v66
    v_mfma_f32_16x16x32_bf16 v[4:7], a[164:167], v[72:75], v[4:7]
    v_exp_f32_e64 v67, v67
    v_mfma_f32_16x16x32_bf16 v[8:11], a[168:171], v[72:75], v[8:11]
    v_cvt_pk_bf16_f32 v77, v66, v67
    v_add_f32_e64 v85, v85, v67
    v_mfma_f32_16x16x32_bf16 v[12:15], a[172:175], v[72:75], v[12:15]
    v_exp_f32_e64 v68, v68
    v_mfma_f32_16x16x32_bf16 v[64:67], a[128:131], v[224:227], v[112:115]
    v_add_f32_e64 v85, v85, v68
    v_mfma_f32_16x16x32_bf16 v[64:67], a[132:135], v[228:231], v[64:67]
    v_exp_f32_e64 v69, v69
    v_mfma_f32_16x16x32_bf16 v[64:67], a[136:139], v[232:235], v[64:67]
    v_cvt_pk_bf16_f32 v78, v68, v69
    v_add_f32_e64 v85, v85, v69
    v_mfma_f32_16x16x32_bf16 v[64:67], a[140:143], v[236:239], v[64:67]
    v_exp_f32_e64 v70, v70
    v_mfma_f32_16x16x32_bf16 v[16:19], a[176:179], v[72:75], v[16:19]
    v_add_f32_e64 v85, v85, v70
    v_mfma_f32_16x16x32_bf16 v[20:23], a[180:183], v[72:75], v[20:23]
    v_exp_f32_e64 v71, v71
    v_mfma_f32_16x16x32_bf16 v[24:27], a[184:187], v[72:75], v[24:27]
    v_cvt_pk_bf16_f32 v79, v70, v71
    v_add_f32_e64 v85, v85, v71
    v_mfma_f32_16x16x32_bf16 v[28:31], a[188:191], v[72:75], v[28:31]
    v_exp_f32_e64 v64, v64
    v_mfma_f32_16x16x32_bf16 v[68:71], a[144:147], v[224:227], v[112:115]
    v_add_f32_e64 v86, v86, v64
    v_mfma_f32_16x16x32_bf16 v[68:71], a[148:151], v[228:231], v[68:71]
    v_exp_f32_e64 v65, v65
    v_mfma_f32_16x16x32_bf16 v[68:71], a[152:155], v[232:235], v[68:71]
    v_cvt_pk_bf16_f32 v72, v64, v65
    v_add_f32_e64 v86, v86, v65
    v_mfma_f32_16x16x32_bf16 v[68:71], a[156:159], v[236:239], v[68:71]
    v_exp_f32_e64 v66, v66
    v_mfma_f32_16x16x32_bf16 v[32:35], a[160:163], v[76:79], v[32:35]
    v_add_f32_e64 v86, v86, v66
    v_mfma_f32_16x16x32_bf16 v[36:39], a[164:167], v[76:79], v[36:39]
    v_exp_f32_e64 v67, v67
    v_mfma_f32_16x16x32_bf16 v[40:43], a[168:171], v[76:79], v[40:43]
    v_cvt_pk_bf16_f32 v73, v66, v67
    v_add_f32_e64 v86, v86, v67
    v_mfma_f32_16x16x32_bf16 v[44:47], a[172:175], v[76:79], v[44:47]
    v_exp_f32_e64 v68, v68
    v_mfma_f32_16x16x32_bf16 v[64:67], a[128:131], v[240:243], v[116:119]
    ds_read_b128 a[128:131], v120 offset:8448
    v_add_f32_e64 v86, v86, v68
    v_mfma_f32_16x16x32_bf16 v[64:67], a[132:135], v[244:247], v[64:67]
    v_exp_f32_e64 v69, v69
    v_mfma_f32_16x16x32_bf16 v[64:67], a[136:139], v[248:251], v[64:67]
    v_cvt_pk_bf16_f32 v74, v68, v69
    v_add_f32_e64 v86, v86, v69
    v_mfma_f32_16x16x32_bf16 v[64:67], a[140:143], v[252:255], v[64:67]
    v_exp_f32_e64 v70, v70
    v_mfma_f32_16x16x32_bf16 v[48:51], a[176:179], v[76:79], v[48:51]
    ds_read_b128 a[132:135], v120 offset:8512
    v_add_f32_e64 v86, v86, v70
    v_mfma_f32_16x16x32_bf16 v[52:55], a[180:183], v[76:79], v[52:55]
    ds_read_b128 a[136:139], v120 offset:8576
    v_exp_f32_e64 v71, v71
    v_mfma_f32_16x16x32_bf16 v[56:59], a[184:187], v[76:79], v[56:59]
    v_cvt_pk_bf16_f32 v75, v70, v71
    v_add_f32_e64 v86, v86, v71
    v_mfma_f32_16x16x32_bf16 v[60:63], a[188:191], v[76:79], v[60:63]
    v_exp_f32_e64 v64, v64
    v_mfma_f32_16x16x32_bf16 v[68:71], a[144:147], v[240:243], v[116:119]
    ds_read_b128 a[140:143], v120 offset:8640
    v_add_f32_e64 v87, v87, v64
    v_mfma_f32_16x16x32_bf16 v[68:71], a[148:151], v[244:247], v[68:71]
    v_exp_f32_e64 v65, v65
    v_mfma_f32_16x16x32_bf16 v[68:71], a[152:155], v[248:251], v[68:71]
    v_cvt_pk_bf16_f32 v76, v64, v65
    v_add_f32_e64 v87, v87, v65
    v_mfma_f32_16x16x32_bf16 v[68:71], a[156:159], v[252:255], v[68:71]
    v_exp_f32_e64 v66, v66
    v_mfma_f32_16x16x32_bf16 a[192:195], a[160:163], v[72:75], a[192:195]
    ds_read_b128 a[144:147], v120 offset:8960
    v_add_f32_e64 v87, v87, v66
    v_mfma_f32_16x16x32_bf16 a[196:199], a[164:167], v[72:75], a[196:199]
    ds_read_b128 a[148:151], v120 offset:9024
    v_exp_f32_e64 v67, v67
    v_mfma_f32_16x16x32_bf16 a[200:203], a[168:171], v[72:75], a[200:203]
    v_cvt_pk_bf16_f32 v77, v66, v67
    v_add_f32_e64 v87, v87, v67
    v_mfma_f32_16x16x32_bf16 a[204:207], a[172:175], v[72:75], a[204:207]
    s_waitcnt lgkmcnt(5)
    v_exp_f32 v68, v68
    v_mfma_f32_16x16x32_bf16 v[64:67], a[128:131], v[128:131], v[88:91]
    s_waitcnt lgkmcnt(4)
    ds_read_b128 a[152:155], v120 offset:9088
    v_add_f32 v87, v87, v68
    v_mfma_f32_16x16x32_bf16 v[64:67], a[132:135], v[132:135], v[64:67]
    s_waitcnt lgkmcnt(4)
    v_exp_f32 v69, v69
    v_mfma_f32_16x16x32_bf16 v[64:67], a[136:139], v[136:139], v[64:67]
    s_waitcnt lgkmcnt(3)
    v_cvt_pk_bf16_f32 v78, v68, v69
    v_add_f32 v87, v87, v69
    v_mfma_f32_16x16x32_bf16 v[64:67], a[140:143], v[140:143], v[64:67]
    v_exp_f32_e64 v70, v70
    v_mfma_f32_16x16x32_bf16 a[208:211], a[176:179], v[72:75], a[208:211]
    ds_read_b128 a[156:159], v120 offset:9152
    v_add_f32_e64 v87, v87, v70
    v_mfma_f32_16x16x32_bf16 a[212:215], a[180:183], v[72:75], a[212:215]
    v_exp_f32_e64 v71, v71
    v_mfma_f32_16x16x32_bf16 a[216:219], a[184:187], v[72:75], a[216:219]
    v_cvt_pk_bf16_f32 v79, v70, v71
    v_add_f32_e64 v87, v87, v71
    v_mfma_f32_16x16x32_bf16 a[220:223], a[188:191], v[72:75], a[220:223]
    s_waitcnt lgkmcnt(3)
    v_exp_f32 v64, v64
    v_mfma_f32_16x16x32_bf16 v[68:71], a[144:147], v[128:131], v[88:91]
    s_waitcnt lgkmcnt(2)
    v_add_f32 v80, v80, v64
    v_mfma_f32_16x16x32_bf16 v[68:71], a[148:151], v[132:135], v[68:71]
    s_waitcnt lgkmcnt(1)
    v_exp_f32 v65, v65
    v_mfma_f32_16x16x32_bf16 v[68:71], a[152:155], v[136:139], v[68:71]
    s_waitcnt lgkmcnt(0)
    v_cvt_pk_bf16_f32 v72, v64, v65
    v_add_f32 v80, v80, v65
    v_mfma_f32_16x16x32_bf16 v[68:71], a[156:159], v[140:143], v[68:71]
    v_exp_f32_e64 v66, v66
    v_mfma_f32_16x16x32_bf16 a[224:227], a[160:163], v[76:79], a[224:227]
    ds_read_b64_tr_b16 a[160:161], v121 offset:8448
    v_add_f32_e64 v80, v80, v66
    v_mfma_f32_16x16x32_bf16 a[228:231], a[164:167], v[76:79], a[228:231]
    ds_read_b64_tr_b16 a[162:163], v121 offset:8960
    v_exp_f32_e64 v67, v67
    v_mfma_f32_16x16x32_bf16 a[232:235], a[168:171], v[76:79], a[232:235]
    v_cvt_pk_bf16_f32 v73, v66, v67
    v_add_f32_e64 v80, v80, v67
    v_mfma_f32_16x16x32_bf16 a[236:239], a[172:175], v[76:79], a[236:239]
    ds_read_b64_tr_b16 a[164:165], v121 offset:8480
    v_exp_f32_e64 v68, v68
    v_mfma_f32_16x16x32_bf16 v[64:67], a[128:131], v[144:147], v[92:95]
    ds_read_b64_tr_b16 a[166:167], v121 offset:8992
    v_add_f32_e64 v80, v80, v68
    v_mfma_f32_16x16x32_bf16 v[64:67], a[132:135], v[148:151], v[64:67]
    ds_read_b64_tr_b16 a[168:169], v121 offset:8512
    v_exp_f32_e64 v69, v69
    v_mfma_f32_16x16x32_bf16 v[64:67], a[136:139], v[152:155], v[64:67]
    v_cvt_pk_bf16_f32 v74, v68, v69
    v_add_f32_e64 v80, v80, v69
    v_mfma_f32_16x16x32_bf16 v[64:67], a[140:143], v[156:159], v[64:67]
    ds_read_b64_tr_b16 a[170:171], v121 offset:9024
    v_exp_f32_e64 v70, v70
    v_mfma_f32_16x16x32_bf16 a[240:243], a[176:179], v[76:79], a[240:243]
    ds_read_b64_tr_b16 a[172:173], v121 offset:8544
    v_add_f32_e64 v80, v80, v70
    v_mfma_f32_16x16x32_bf16 a[244:247], a[180:183], v[76:79], a[244:247]
    ds_read_b64_tr_b16 a[174:175], v121 offset:9056
    v_exp_f32_e64 v71, v71
    v_mfma_f32_16x16x32_bf16 a[248:251], a[184:187], v[76:79], a[248:251]
    v_cvt_pk_bf16_f32 v75, v70, v71
    v_add_f32_e64 v80, v80, v71
    v_mfma_f32_16x16x32_bf16 a[252:255], a[188:191], v[76:79], a[252:255]
    ds_read_b64_tr_b16 a[176:177], v121 offset:8576
    v_exp_f32_e64 v64, v64
    v_mfma_f32_16x16x32_bf16 v[68:71], a[144:147], v[144:147], v[92:95]
    ds_read_b64_tr_b16 a[178:179], v121 offset:9088
    v_add_f32_e64 v81, v81, v64
    v_mfma_f32_16x16x32_bf16 v[68:71], a[148:151], v[148:151], v[68:71]
    ds_read_b64_tr_b16 a[180:181], v121 offset:8608
    v_exp_f32_e64 v65, v65
    v_mfma_f32_16x16x32_bf16 v[68:71], a[152:155], v[152:155], v[68:71]
    v_cvt_pk_bf16_f32 v76, v64, v65
    v_add_f32_e64 v81, v81, v65
    v_mfma_f32_16x16x32_bf16 v[68:71], a[156:159], v[156:159], v[68:71]
    s_waitcnt lgkmcnt(9)
    ds_read_b64_tr_b16 a[182:183], v121 offset:9120
    v_exp_f32 v66, v66
    v_mfma_f32_16x16x32_bf16 a[0:3], a[160:163], v[72:75], a[0:3]
    s_waitcnt lgkmcnt(8)
    ds_read_b64_tr_b16 a[184:185], v121 offset:8640
    v_add_f32 v81, v81, v66
    v_mfma_f32_16x16x32_bf16 a[4:7], a[164:167], v[72:75], a[4:7]
    s_waitcnt lgkmcnt(7)
    ds_read_b64_tr_b16 a[186:187], v121 offset:9152
    v_exp_f32 v67, v67
    v_mfma_f32_16x16x32_bf16 a[8:11], a[168:171], v[72:75], a[8:11]
    s_waitcnt lgkmcnt(6)
    v_cvt_pk_bf16_f32 v77, v66, v67
    v_add_f32 v81, v81, v67
    v_mfma_f32_16x16x32_bf16 a[12:15], a[172:175], v[72:75], a[12:15]
    ds_read_b64_tr_b16 a[188:189], v121 offset:8672
    v_exp_f32_e64 v68, v68
    v_mfma_f32_16x16x32_bf16 v[64:67], a[128:131], v[160:163], v[96:99]
    ds_read_b64_tr_b16 a[190:191], v121 offset:9184
    v_add_f32_e64 v81, v81, v68
    v_mfma_f32_16x16x32_bf16 v[64:67], a[132:135], v[164:167], v[64:67]
    v_exp_f32_e64 v69, v69
    v_mfma_f32_16x16x32_bf16 v[64:67], a[136:139], v[168:171], v[64:67]
    v_cvt_pk_bf16_f32 v78, v68, v69
    v_add_f32_e64 v81, v81, v69
    v_mfma_f32_16x16x32_bf16 v[64:67], a[140:143], v[172:175], v[64:67]
    s_waitcnt lgkmcnt(6)
    v_exp_f32 v70, v70
    v_mfma_f32_16x16x32_bf16 a[16:19], a[176:179], v[72:75], a[16:19]
    s_waitcnt lgkmcnt(4)
    v_add_f32 v81, v81, v70
    v_mfma_f32_16x16x32_bf16 a[20:23], a[180:183], v[72:75], a[20:23]
    s_waitcnt lgkmcnt(2)
    v_exp_f32 v71, v71
    v_mfma_f32_16x16x32_bf16 a[24:27], a[184:187], v[72:75], a[24:27]
    s_waitcnt lgkmcnt(0)
    v_cvt_pk_bf16_f32 v79, v70, v71
    v_add_f32 v81, v81, v71
    v_mfma_f32_16x16x32_bf16 a[28:31], a[188:191], v[72:75], a[28:31]
    v_exp_f32_e64 v64, v64
    v_mfma_f32_16x16x32_bf16 v[68:71], a[144:147], v[160:163], v[96:99]
    v_add_f32_e64 v82, v82, v64
    v_mfma_f32_16x16x32_bf16 v[68:71], a[148:151], v[164:167], v[68:71]
    v_exp_f32_e64 v65, v65
    v_mfma_f32_16x16x32_bf16 v[68:71], a[152:155], v[168:171], v[68:71]
    s_and_b32 s36, s29, 3
    v_cvt_pk_bf16_f32 v72, v64, v65
    v_add_f32 v82, v82, v65
    v_mfma_f32_16x16x32_bf16 v[68:71], a[156:159], v[172:175], v[68:71]
    s_cmp_eq_u32 s36, 3
    v_exp_f32 v66, v66
    v_mfma_f32_16x16x32_bf16 a[32:35], a[160:163], v[76:79], a[32:35]
    s_cselect_b32 s33, -50688, s41
    v_add_f32_e64 v82, v82, v66
    v_mfma_f32_16x16x32_bf16 a[36:39], a[164:167], v[76:79], a[36:39]
    s_add_u32 s29, s29, 1
    v_exp_f32 v67, v67
    v_mfma_f32_16x16x32_bf16 a[40:43], a[168:171], v[76:79], a[40:43]
    s_cmp_lt_u32 s29, 14
    v_cvt_pk_bf16_f32 v73, v66, v67
    v_add_f32 v82, v82, v67
    v_mfma_f32_16x16x32_bf16 a[44:47], a[172:175], v[76:79], a[44:47]
    v_exp_f32_e64 v68, v68
    v_mfma_f32_16x16x32_bf16 v[64:67], a[128:131], v[176:179], v[100:103]
    v_add_f32 v82, v82, v68
    v_add_u32 v120, s33, v120
    v_mfma_f32_16x16x32_bf16 v[64:67], a[132:135], v[180:183], v[64:67]
    v_exp_f32_e64 v69, v69
    v_mfma_f32_16x16x32_bf16 v[64:67], a[136:139], v[184:187], v[64:67]
    v_cvt_pk_bf16_f32 v74, v68, v69
    v_add_f32_e64 v82, v82, v69
    v_mfma_f32_16x16x32_bf16 v[64:67], a[140:143], v[188:191], v[64:67]
    v_exp_f32_e64 v70, v70
    v_mfma_f32_16x16x32_bf16 a[48:51], a[176:179], v[76:79], a[48:51]
    v_add_f32 v82, v82, v70
    v_add_u32 v121, s33, v121
    v_mfma_f32_16x16x32_bf16 a[52:55], a[180:183], v[76:79], a[52:55]
    v_exp_f32_e64 v71, v71
    v_mfma_f32_16x16x32_bf16 a[56:59], a[184:187], v[76:79], a[56:59]
    v_cvt_pk_bf16_f32 v75, v70, v71
    v_add_f32_e64 v82, v82, v71
    v_mfma_f32_16x16x32_bf16 a[60:63], a[188:191], v[76:79], a[60:63]
    v_exp_f32_e64 v64, v64
    v_mfma_f32_16x16x32_bf16 v[68:71], a[144:147], v[176:179], v[100:103]
    v_add_f32_e64 v83, v83, v64
    v_mfma_f32_16x16x32_bf16 v[68:71], a[148:151], v[180:183], v[68:71]
    v_exp_f32_e64 v65, v65
    v_mfma_f32_16x16x32_bf16 v[68:71], a[152:155], v[184:187], v[68:71]
    v_cvt_pk_bf16_f32 v76, v64, v65
    v_add_f32_e64 v83, v83, v65
    v_mfma_f32_16x16x32_bf16 v[68:71], a[156:159], v[188:191], v[68:71]
    v_exp_f32_e64 v66, v66
    v_mfma_f32_16x16x32_bf16 a[64:67], a[160:163], v[72:75], a[64:67]
    v_add_f32_e64 v83, v83, v66
    v_mfma_f32_16x16x32_bf16 a[68:71], a[164:167], v[72:75], a[68:71]
    v_exp_f32_e64 v67, v67
    v_mfma_f32_16x16x32_bf16 a[72:75], a[168:171], v[72:75], a[72:75]
    v_cvt_pk_bf16_f32 v77, v66, v67
    v_add_f32_e64 v83, v83, v67
    v_mfma_f32_16x16x32_bf16 a[76:79], a[172:175], v[72:75], a[76:79]
    v_exp_f32_e64 v68, v68
    v_mfma_f32_16x16x32_bf16 v[64:67], a[128:131], v[192:195], v[104:107]
    v_add_f32_e64 v83, v83, v68
    v_mfma_f32_16x16x32_bf16 v[64:67], a[132:135], v[196:199], v[64:67]
    v_exp_f32_e64 v69, v69
    v_mfma_f32_16x16x32_bf16 v[64:67], a[136:139], v[200:203], v[64:67]
    v_cvt_pk_bf16_f32 v78, v68, v69
    v_add_f32_e64 v83, v83, v69
    v_mfma_f32_16x16x32_bf16 v[64:67], a[140:143], v[204:207], v[64:67]
    v_exp_f32_e64 v70, v70
    v_mfma_f32_16x16x32_bf16 a[80:83], a[176:179], v[72:75], a[80:83]
    v_add_f32_e64 v83, v83, v70
    v_mfma_f32_16x16x32_bf16 a[84:87], a[180:183], v[72:75], a[84:87]
    v_exp_f32_e64 v71, v71
    v_mfma_f32_16x16x32_bf16 a[88:91], a[184:187], v[72:75], a[88:91]
    v_cvt_pk_bf16_f32 v79, v70, v71
    v_add_f32_e64 v83, v83, v71
    v_mfma_f32_16x16x32_bf16 a[92:95], a[188:191], v[72:75], a[92:95]
    v_exp_f32_e64 v64, v64
    v_mfma_f32_16x16x32_bf16 v[68:71], a[144:147], v[192:195], v[104:107]
    v_add_f32_e64 v84, v84, v64
    v_mfma_f32_16x16x32_bf16 v[68:71], a[148:151], v[196:199], v[68:71]
    v_exp_f32_e64 v65, v65
    v_mfma_f32_16x16x32_bf16 v[68:71], a[152:155], v[200:203], v[68:71]
    v_cvt_pk_bf16_f32 v72, v64, v65
    v_add_f32_e64 v84, v84, v65
    v_mfma_f32_16x16x32_bf16 v[68:71], a[156:159], v[204:207], v[68:71]
    v_exp_f32_e64 v66, v66
    v_mfma_f32_16x16x32_bf16 a[96:99], a[160:163], v[76:79], a[96:99]
    v_add_f32_e64 v84, v84, v66
    v_mfma_f32_16x16x32_bf16 a[100:103], a[164:167], v[76:79], a[100:103]
    v_exp_f32_e64 v67, v67
    v_mfma_f32_16x16x32_bf16 a[104:107], a[168:171], v[76:79], a[104:107]
    v_cvt_pk_bf16_f32 v73, v66, v67
    v_add_f32_e64 v84, v84, v67
    v_mfma_f32_16x16x32_bf16 a[108:111], a[172:175], v[76:79], a[108:111]
    v_exp_f32_e64 v68, v68
    v_mfma_f32_16x16x32_bf16 v[64:67], a[128:131], v[208:211], v[108:111]
    v_add_f32_e64 v84, v84, v68
    v_mfma_f32_16x16x32_bf16 v[64:67], a[132:135], v[212:215], v[64:67]
    v_exp_f32_e64 v69, v69
    v_mfma_f32_16x16x32_bf16 v[64:67], a[136:139], v[216:219], v[64:67]
    v_cvt_pk_bf16_f32 v74, v68, v69
    v_add_f32_e64 v84, v84, v69
    v_mfma_f32_16x16x32_bf16 v[64:67], a[140:143], v[220:223], v[64:67]
    v_exp_f32_e64 v70, v70
    v_mfma_f32_16x16x32_bf16 a[112:115], a[176:179], v[76:79], a[112:115]
    v_add_f32_e64 v84, v84, v70
    v_mfma_f32_16x16x32_bf16 a[116:119], a[180:183], v[76:79], a[116:119]
    v_exp_f32_e64 v71, v71
    v_mfma_f32_16x16x32_bf16 a[120:123], a[184:187], v[76:79], a[120:123]
    v_cvt_pk_bf16_f32 v75, v70, v71
    v_add_f32_e64 v84, v84, v71
    v_mfma_f32_16x16x32_bf16 a[124:127], a[188:191], v[76:79], a[124:127]
    v_exp_f32_e64 v64, v64
    v_mfma_f32_16x16x32_bf16 v[68:71], a[144:147], v[208:211], v[108:111]
    v_add_f32_e64 v85, v85, v64
    v_mfma_f32_16x16x32_bf16 v[68:71], a[148:151], v[212:215], v[68:71]
    v_exp_f32_e64 v65, v65
    v_mfma_f32_16x16x32_bf16 v[68:71], a[152:155], v[216:219], v[68:71]
    v_cvt_pk_bf16_f32 v76, v64, v65
    v_add_f32_e64 v85, v85, v65
    v_mfma_f32_16x16x32_bf16 v[68:71], a[156:159], v[220:223], v[68:71]
    v_exp_f32_e64 v66, v66
    v_mfma_f32_16x16x32_bf16 v[0:3], a[160:163], v[72:75], v[0:3]
    v_add_f32_e64 v85, v85, v66
    v_mfma_f32_16x16x32_bf16 v[4:7], a[164:167], v[72:75], v[4:7]
    v_exp_f32_e64 v67, v67
    v_mfma_f32_16x16x32_bf16 v[8:11], a[168:171], v[72:75], v[8:11]
    v_cvt_pk_bf16_f32 v77, v66, v67
    v_add_f32_e64 v85, v85, v67
    v_mfma_f32_16x16x32_bf16 v[12:15], a[172:175], v[72:75], v[12:15]
    v_exp_f32_e64 v68, v68
    v_mfma_f32_16x16x32_bf16 v[64:67], a[128:131], v[224:227], v[112:115]
    v_add_f32_e64 v85, v85, v68
    v_mfma_f32_16x16x32_bf16 v[64:67], a[132:135], v[228:231], v[64:67]
    v_exp_f32_e64 v69, v69
    v_mfma_f32_16x16x32_bf16 v[64:67], a[136:139], v[232:235], v[64:67]
    v_cvt_pk_bf16_f32 v78, v68, v69
    v_add_f32_e64 v85, v85, v69
    v_mfma_f32_16x16x32_bf16 v[64:67], a[140:143], v[236:239], v[64:67]
    v_exp_f32_e64 v70, v70
    v_mfma_f32_16x16x32_bf16 v[16:19], a[176:179], v[72:75], v[16:19]
    v_add_f32_e64 v85, v85, v70
    v_mfma_f32_16x16x32_bf16 v[20:23], a[180:183], v[72:75], v[20:23]
    v_exp_f32_e64 v71, v71
    v_mfma_f32_16x16x32_bf16 v[24:27], a[184:187], v[72:75], v[24:27]
    v_cvt_pk_bf16_f32 v79, v70, v71
    v_add_f32_e64 v85, v85, v71
    v_mfma_f32_16x16x32_bf16 v[28:31], a[188:191], v[72:75], v[28:31]
    s_waitcnt vmcnt(0)
    v_exp_f32 v64, v64
    v_mfma_f32_16x16x32_bf16 v[68:71], a[144:147], v[224:227], v[112:115]
    s_barrier
    v_add_f32 v86, v86, v64
    v_mfma_f32_16x16x32_bf16 v[68:71], a[148:151], v[228:231], v[68:71]
    v_exp_f32_e64 v65, v65
    v_mfma_f32_16x16x32_bf16 v[68:71], a[152:155], v[232:235], v[68:71]
    v_cvt_pk_bf16_f32 v72, v64, v65
    v_add_f32_e64 v86, v86, v65
    v_mfma_f32_16x16x32_bf16 v[68:71], a[156:159], v[236:239], v[68:71]
    v_exp_f32_e64 v66, v66
    v_mfma_f32_16x16x32_bf16 v[32:35], a[160:163], v[76:79], v[32:35]
    v_add_f32_e64 v86, v86, v66
    v_mfma_f32_16x16x32_bf16 v[36:39], a[164:167], v[76:79], v[36:39]
    v_exp_f32_e64 v67, v67
    v_mfma_f32_16x16x32_bf16 v[40:43], a[168:171], v[76:79], v[40:43]
    v_cvt_pk_bf16_f32 v73, v66, v67
    v_add_f32_e64 v86, v86, v67
    v_mfma_f32_16x16x32_bf16 v[44:47], a[172:175], v[76:79], v[44:47]
    v_exp_f32_e64 v68, v68
    v_mfma_f32_16x16x32_bf16 v[64:67], a[128:131], v[240:243], v[116:119]
    ds_read_b128 a[128:131], v120 offset:0
    v_add_f32_e64 v86, v86, v68
    v_mfma_f32_16x16x32_bf16 v[64:67], a[132:135], v[244:247], v[64:67]
    v_exp_f32_e64 v69, v69
    v_mfma_f32_16x16x32_bf16 v[64:67], a[136:139], v[248:251], v[64:67]
    v_cvt_pk_bf16_f32 v74, v68, v69
    v_add_f32_e64 v86, v86, v69
    v_mfma_f32_16x16x32_bf16 v[64:67], a[140:143], v[252:255], v[64:67]
    v_exp_f32_e64 v70, v70
    v_mfma_f32_16x16x32_bf16 v[48:51], a[176:179], v[76:79], v[48:51]
    ds_read_b128 a[132:135], v120 offset:64
    v_add_f32_e64 v86, v86, v70
    v_mfma_f32_16x16x32_bf16 v[52:55], a[180:183], v[76:79], v[52:55]
    ds_read_b128 a[136:139], v120 offset:128
    v_exp_f32_e64 v71, v71
    v_mfma_f32_16x16x32_bf16 v[56:59], a[184:187], v[76:79], v[56:59]
    v_cvt_pk_bf16_f32 v75, v70, v71
    v_add_f32_e64 v86, v86, v71
    v_mfma_f32_16x16x32_bf16 v[60:63], a[188:191], v[76:79], v[60:63]
    v_exp_f32_e64 v64, v64
    v_mfma_f32_16x16x32_bf16 v[68:71], a[144:147], v[240:243], v[116:119]
    ds_read_b128 a[140:143], v120 offset:192
    v_add_f32_e64 v87, v87, v64
    v_mfma_f32_16x16x32_bf16 v[68:71], a[148:151], v[244:247], v[68:71]
    v_exp_f32_e64 v65, v65
    v_mfma_f32_16x16x32_bf16 v[68:71], a[152:155], v[248:251], v[68:71]
    v_cvt_pk_bf16_f32 v76, v64, v65
    v_add_f32_e64 v87, v87, v65
    v_mfma_f32_16x16x32_bf16 v[68:71], a[156:159], v[252:255], v[68:71]
    v_exp_f32_e64 v66, v66
    v_mfma_f32_16x16x32_bf16 a[192:195], a[160:163], v[72:75], a[192:195]
    ds_read_b128 a[144:147], v120 offset:512
    v_add_f32_e64 v87, v87, v66
    v_mfma_f32_16x16x32_bf16 a[196:199], a[164:167], v[72:75], a[196:199]
    ds_read_b128 a[148:151], v120 offset:576
    v_exp_f32_e64 v67, v67
    v_mfma_f32_16x16x32_bf16 a[200:203], a[168:171], v[72:75], a[200:203]
    v_cvt_pk_bf16_f32 v77, v66, v67
    v_add_f32_e64 v87, v87, v67
    v_mfma_f32_16x16x32_bf16 a[204:207], a[172:175], v[72:75], a[204:207]
    s_waitcnt lgkmcnt(5)
    v_exp_f32 v68, v68
    s_cbranch_scc1 L_loopa
    v_mfma_f32_16x16x32_bf16 v[64:67], a[128:131], v[128:131], v[88:91]
    s_waitcnt lgkmcnt(4)
    ds_read_b128 a[152:155], v120 offset:640
    v_add_f32 v87, v87, v68
    v_mfma_f32_16x16x32_bf16 v[64:67], a[132:135], v[132:135], v[64:67]
    s_waitcnt lgkmcnt(4)
    v_exp_f32 v69, v69
    v_mfma_f32_16x16x32_bf16 v[64:67], a[136:139], v[136:139], v[64:67]
    s_waitcnt lgkmcnt(3)
    v_cvt_pk_bf16_f32 v78, v68, v69
    v_add_f32 v87, v87, v69
    v_mfma_f32_16x16x32_bf16 v[64:67], a[140:143], v[140:143], v[64:67]
    v_exp_f32 v70, v70
    v_mfma_f32_16x16x32_bf16 a[208:211], a[176:179], v[72:75], a[208:211]
    ds_read_b128 a[156:159], v120 offset:704
    v_add_f32 v87, v87, v70
    v_mfma_f32_16x16x32_bf16 a[212:215], a[180:183], v[72:75], a[212:215]
    v_exp_f32 v71, v71
    v_mfma_f32_16x16x32_bf16 a[216:219], a[184:187], v[72:75], a[216:219]
    v_cvt_pk_bf16_f32 v79, v70, v71
    v_add_f32 v87, v87, v71
    v_mfma_f32_16x16x32_bf16 a[220:223], a[188:191], v[72:75], a[220:223]
    s_waitcnt lgkmcnt(3)
    v_exp_f32 v64, v64
    v_mfma_f32_16x16x32_bf16 v[68:71], a[144:147], v[128:131], v[88:91]
    s_waitcnt lgkmcnt(2)
    v_add_f32 v80, v80, v64
    v_mfma_f32_16x16x32_bf16 v[68:71], a[148:151], v[132:135], v[68:71]
    s_waitcnt lgkmcnt(1)
    v_exp_f32 v65, v65
    v_mfma_f32_16x16x32_bf16 v[68:71], a[152:155], v[136:139], v[68:71]
    s_waitcnt lgkmcnt(0)
    v_cvt_pk_bf16_f32 v72, v64, v65
    v_add_f32 v80, v80, v65
    v_mfma_f32_16x16x32_bf16 v[68:71], a[156:159], v[140:143], v[68:71]
    v_exp_f32 v66, v66
    v_mfma_f32_16x16x32_bf16 a[224:227], a[160:163], v[76:79], a[224:227]
    ds_read_b64_tr_b16 a[160:161], v121 offset:0
    v_add_f32 v80, v80, v66
    v_mfma_f32_16x16x32_bf16 a[228:231], a[164:167], v[76:79], a[228:231]
    ds_read_b64_tr_b16 a[162:163], v121 offset:512
    v_exp_f32 v67, v67
    v_mfma_f32_16x16x32_bf16 a[232:235], a[168:171], v[76:79], a[232:235]
    v_cvt_pk_bf16_f32 v73, v66, v67
    v_add_f32 v80, v80, v67
    v_mfma_f32_16x16x32_bf16 a[236:239], a[172:175], v[76:79], a[236:239]
    ds_read_b64_tr_b16 a[164:165], v121 offset:32
    v_exp_f32 v68, v68
    v_mfma_f32_16x16x32_bf16 v[64:67], a[128:131], v[144:147], v[92:95]
    ds_read_b64_tr_b16 a[166:167], v121 offset:544
    v_add_f32 v80, v80, v68
    v_mfma_f32_16x16x32_bf16 v[64:67], a[132:135], v[148:151], v[64:67]
    ds_read_b64_tr_b16 a[168:169], v121 offset:64
    v_exp_f32 v69, v69
    v_mfma_f32_16x16x32_bf16 v[64:67], a[136:139], v[152:155], v[64:67]
    v_cvt_pk_bf16_f32 v74, v68, v69
    v_add_f32 v80, v80, v69
    v_mfma_f32_16x16x32_bf16 v[64:67], a[140:143], v[156:159], v[64:67]
    ds_read_b64_tr_b16 a[170:171], v121 offset:576
    v_exp_f32 v70, v70
    v_mfma_f32_16x16x32_bf16 a[240:243], a[176:179], v[76:79], a[240:243]
    ds_read_b64_tr_b16 a[172:173], v121 offset:96
    v_add_f32 v80, v80, v70
    v_mfma_f32_16x16x32_bf16 a[244:247], a[180:183], v[76:79], a[244:247]
    ds_read_b64_tr_b16 a[174:175], v121 offset:608
    v_exp_f32 v71, v71
    v_mfma_f32_16x16x32_bf16 a[248:251], a[184:187], v[76:79], a[248:251]
    v_cvt_pk_bf16_f32 v75, v70, v71
    v_add_f32 v80, v80, v71
    v_mfma_f32_16x16x32_bf16 a[252:255], a[188:191], v[76:79], a[252:255]
    ds_read_b64_tr_b16 a[176:177], v121 offset:128
    v_exp_f32 v64, v64
    v_mfma_f32_16x16x32_bf16 v[68:71], a[144:147], v[144:147], v[92:95]
    ds_read_b64_tr_b16 a[178:179], v121 offset:640
    v_add_f32 v81, v81, v64
    v_mfma_f32_16x16x32_bf16 v[68:71], a[148:151], v[148:151], v[68:71]
    ds_read_b64_tr_b16 a[180:181], v121 offset:160
    v_exp_f32 v65, v65
    v_mfma_f32_16x16x32_bf16 v[68:71], a[152:155], v[152:155], v[68:71]
    v_cvt_pk_bf16_f32 v76, v64, v65
    v_add_f32 v81, v81, v65
    v_mfma_f32_16x16x32_bf16 v[68:71], a[156:159], v[156:159], v[68:71]
    s_waitcnt lgkmcnt(9)
    ds_read_b64_tr_b16 a[182:183], v121 offset:672
    v_exp_f32 v66, v66
    v_mfma_f32_16x16x32_bf16 a[0:3], a[160:163], v[72:75], a[0:3]
    s_waitcnt lgkmcnt(8)
    ds_read_b64_tr_b16 a[184:185], v121 offset:192
    v_add_f32 v81, v81, v66
    v_mfma_f32_16x16x32_bf16 a[4:7], a[164:167], v[72:75], a[4:7]
    s_waitcnt lgkmcnt(7)
    ds_read_b64_tr_b16 a[186:187], v121 offset:704
    v_exp_f32 v67, v67
    v_mfma_f32_16x16x32_bf16 a[8:11], a[168:171], v[72:75], a[8:11]
    s_waitcnt lgkmcnt(6)
    v_cvt_pk_bf16_f32 v77, v66, v67
    v_add_f32 v81, v81, v67
    v_mfma_f32_16x16x32_bf16 a[12:15], a[172:175], v[72:75], a[12:15]
    ds_read_b64_tr_b16 a[188:189], v121 offset:224
    v_exp_f32 v68, v68
    v_mfma_f32_16x16x32_bf16 v[64:67], a[128:131], v[160:163], v[96:99]
    ds_read_b64_tr_b16 a[190:191], v121 offset:736
    v_add_f32 v81, v81, v68
    v_mfma_f32_16x16x32_bf16 v[64:67], a[132:135], v[164:167], v[64:67]
    v_exp_f32 v69, v69
    v_mfma_f32_16x16x32_bf16 v[64:67], a[136:139], v[168:171], v[64:67]
    v_cvt_pk_bf16_f32 v78, v68, v69
    v_add_f32 v81, v81, v69
    v_mfma_f32_16x16x32_bf16 v[64:67], a[140:143], v[172:175], v[64:67]
    s_waitcnt lgkmcnt(6)
    v_exp_f32 v70, v70
    v_mfma_f32_16x16x32_bf16 a[16:19], a[176:179], v[72:75], a[16:19]
    s_waitcnt lgkmcnt(4)
    v_add_f32 v81, v81, v70
    v_mfma_f32_16x16x32_bf16 a[20:23], a[180:183], v[72:75], a[20:23]
    s_waitcnt lgkmcnt(2)
    v_exp_f32 v71, v71
    v_mfma_f32_16x16x32_bf16 a[24:27], a[184:187], v[72:75], a[24:27]
    s_waitcnt lgkmcnt(0)
    v_cvt_pk_bf16_f32 v79, v70, v71
    v_add_f32 v81, v81, v71
    v_mfma_f32_16x16x32_bf16 a[28:31], a[188:191], v[72:75], a[28:31]
    v_exp_f32 v64, v64
    v_mfma_f32_16x16x32_bf16 v[68:71], a[144:147], v[160:163], v[96:99]
    v_add_f32 v82, v82, v64
    v_mfma_f32_16x16x32_bf16 v[68:71], a[148:151], v[164:167], v[68:71]
    v_exp_f32 v65, v65
    v_mfma_f32_16x16x32_bf16 v[68:71], a[152:155], v[168:171], v[68:71]
    v_cvt_pk_bf16_f32 v72, v64, v65
    v_add_f32 v82, v82, v65
    v_mfma_f32_16x16x32_bf16 v[68:71], a[156:159], v[172:175], v[68:71]
    v_exp_f32 v66, v66
    v_mfma_f32_16x16x32_bf16 a[32:35], a[160:163], v[76:79], a[32:35]
    v_add_f32 v82, v82, v66
    v_mfma_f32_16x16x32_bf16 a[36:39], a[164:167], v[76:79], a[36:39]
    v_exp_f32 v67, v67
    v_mfma_f32_16x16x32_bf16 a[40:43], a[168:171], v[76:79], a[40:43]
    v_cvt_pk_bf16_f32 v73, v66, v67
    v_add_f32 v82, v82, v67
    v_mfma_f32_16x16x32_bf16 a[44:47], a[172:175], v[76:79], a[44:47]
    v_exp_f32 v68, v68
    v_mfma_f32_16x16x32_bf16 v[64:67], a[128:131], v[176:179], v[100:103]
    ds_read_b128 a[128:131], v120 offset:8448
    v_add_f32 v82, v82, v68
    v_mfma_f32_16x16x32_bf16 v[64:67], a[132:135], v[180:183], v[64:67]
    v_exp_f32 v69, v69
    v_mfma_f32_16x16x32_bf16 v[64:67], a[136:139], v[184:187], v[64:67]
    v_cvt_pk_bf16_f32 v74, v68, v69
    v_add_f32 v82, v82, v69
    v_mfma_f32_16x16x32_bf16 v[64:67], a[140:143], v[188:191], v[64:67]
    v_exp_f32 v70, v70
    v_mfma_f32_16x16x32_bf16 a[48:51], a[176:179], v[76:79], a[48:51]
    ds_read_b128 a[132:135], v120 offset:8512
    v_add_f32 v82, v82, v70
    v_mfma_f32_16x16x32_bf16 a[52:55], a[180:183], v[76:79], a[52:55]
    ds_read_b128 a[136:139], v120 offset:8576
    v_exp_f32 v71, v71
    v_mfma_f32_16x16x32_bf16 a[56:59], a[184:187], v[76:79], a[56:59]
    v_cvt_pk_bf16_f32 v75, v70, v71
    v_add_f32 v82, v82, v71
    v_mfma_f32_16x16x32_bf16 a[60:63], a[188:191], v[76:79], a[60:63]
    v_exp_f32 v64, v64
    v_mfma_f32_16x16x32_bf16 v[68:71], a[144:147], v[176:179], v[100:103]
    ds_read_b128 a[140:143], v120 offset:8640
    v_add_f32 v83, v83, v64
    v_mfma_f32_16x16x32_bf16 v[68:71], a[148:151], v[180:183], v[68:71]
    v_exp_f32 v65, v65
    v_mfma_f32_16x16x32_bf16 v[68:71], a[152:155], v[184:187], v[68:71]
    v_cvt_pk_bf16_f32 v76, v64, v65
    v_add_f32 v83, v83, v65
    v_mfma_f32_16x16x32_bf16 v[68:71], a[156:159], v[188:191], v[68:71]
    v_exp_f32 v66, v66
    v_mfma_f32_16x16x32_bf16 a[64:67], a[160:163], v[72:75], a[64:67]
    ds_read_b128 a[144:147], v120 offset:8960
    v_add_f32 v83, v83, v66
    v_mfma_f32_16x16x32_bf16 a[68:71], a[164:167], v[72:75], a[68:71]
    ds_read_b128 a[148:151], v120 offset:9024
    v_exp_f32 v67, v67
    v_mfma_f32_16x16x32_bf16 a[72:75], a[168:171], v[72:75], a[72:75]
    v_cvt_pk_bf16_f32 v77, v66, v67
    v_add_f32 v83, v83, v67
    v_mfma_f32_16x16x32_bf16 a[76:79], a[172:175], v[72:75], a[76:79]
    s_waitcnt lgkmcnt(5)
    v_exp_f32 v68, v68
    v_mfma_f32_16x16x32_bf16 v[64:67], a[128:131], v[128:131], v[88:91]
    s_waitcnt lgkmcnt(4)
    ds_read_b128 a[152:155], v120 offset:9088
    v_add_f32 v83, v83, v68
    v_mfma_f32_16x16x32_bf16 v[64:67], a[132:135], v[132:135], v[64:67]
    s_waitcnt lgkmcnt(4)
    v_exp_f32 v69, v69
    v_mfma_f32_16x16x32_bf16 v[64:67], a[136:139], v[136:139], v[64:67]
    s_waitcnt lgkmcnt(3)
    v_cvt_pk_bf16_f32 v78, v68, v69
    v_add_f32 v83, v83, v69
    v_mfma_f32_16x16x32_bf16 v[64:67], a[140:143], v[140:143], v[64:67]
    v_exp_f32 v70, v70
    v_mfma_f32_16x16x32_bf16 a[80:83], a[176:179], v[72:75], a[80:83]
    ds_read_b128 a[156:159], v120 offset:9152
    v_add_f32 v83, v83, v70
    v_mfma_f32_16x16x32_bf16 a[84:87], a[180:183], v[72:75], a[84:87]
    v_exp_f32 v71, v71
    v_mfma_f32_16x16x32_bf16 a[88:91], a[184:187], v[72:75], a[88:91]
    v_cvt_pk_bf16_f32 v79, v70, v71
    v_add_f32 v83, v83, v71
    v_mfma_f32_16x16x32_bf16 a[92:95], a[188:191], v[72:75], a[92:95]
    s_waitcnt lgkmcnt(3)
    v_exp_f32 v64, v64
    v_mfma_f32_16x16x32_bf16 v[68:71], a[144:147], v[128:131], v[88:91]
    s_waitcnt lgkmcnt(2)
    v_add_f32 v80, v80, v64
    v_mfma_f32_16x16x32_bf16 v[68:71], a[148:151], v[132:135], v[68:71]
    s_waitcnt lgkmcnt(1)
    v_exp_f32 v65, v65
    v_mfma_f32_16x16x32_bf16 v[68:71], a[152:155], v[136:139], v[68:71]
    s_waitcnt lgkmcnt(0)
    v_cvt_pk_bf16_f32 v72, v64, v65
    v_add_f32 v80, v80, v65
    v_mfma_f32_16x16x32_bf16 v[68:71], a[156:159], v[140:143], v[68:71]
    v_exp_f32 v66, v66
    v_mfma_f32_16x16x32_bf16 a[96:99], a[160:163], v[76:79], a[96:99]
    ds_read_b64_tr_b16 a[160:161], v121 offset:8448
    v_add_f32 v80, v80, v66
    v_mfma_f32_16x16x32_bf16 a[100:103], a[164:167], v[76:79], a[100:103]
    ds_read_b64_tr_b16 a[162:163], v121 offset:8960
    v_exp_f32 v67, v67
    v_mfma_f32_16x16x32_bf16 a[104:107], a[168:171], v[76:79], a[104:107]
    v_cvt_pk_bf16_f32 v73, v66, v67
    v_add_f32 v80, v80, v67
    v_mfma_f32_16x16x32_bf16 a[108:111], a[172:175], v[76:79], a[108:111]
    ds_read_b64_tr_b16 a[164:165], v121 offset:8480
    v_exp_f32 v68, v68
    v_mfma_f32_16x16x32_bf16 v[64:67], a[128:131], v[144:147], v[92:95]
    ds_read_b64_tr_b16 a[166:167], v121 offset:8992
    v_add_f32 v80, v80, v68
    v_mfma_f32_16x16x32_bf16 v[64:67], a[132:135], v[148:151], v[64:67]
    ds_read_b64_tr_b16 a[168:169], v121 offset:8512
    v_exp_f32 v69, v69
    v_mfma_f32_16x16x32_bf16 v[64:67], a[136:139], v[152:155], v[64:67]
    v_cvt_pk_bf16_f32 v74, v68, v69
    v_add_f32 v80, v80, v69
    v_mfma_f32_16x16x32_bf16 v[64:67], a[140:143], v[156:159], v[64:67]
    ds_read_b64_tr_b16 a[170:171], v121 offset:9024
    v_exp_f32 v70, v70
    v_mfma_f32_16x16x32_bf16 a[112:115], a[176:179], v[76:79], a[112:115]
    ds_read_b64_tr_b16 a[172:173], v121 offset:8544
    v_add_f32 v80, v80, v70
    v_mfma_f32_16x16x32_bf16 a[116:119], a[180:183], v[76:79], a[116:119]
    ds_read_b64_tr_b16 a[174:175], v121 offset:9056
    v_exp_f32 v71, v71
    v_mfma_f32_16x16x32_bf16 a[120:123], a[184:187], v[76:79], a[120:123]
    v_cvt_pk_bf16_f32 v75, v70, v71
    v_add_f32 v80, v80, v71
    v_mfma_f32_16x16x32_bf16 a[124:127], a[188:191], v[76:79], a[124:127]
    ds_read_b64_tr_b16 a[176:177], v121 offset:8576
    v_exp_f32 v64, v64
    v_mfma_f32_16x16x32_bf16 v[68:71], a[144:147], v[144:147], v[92:95]
    ds_read_b64_tr_b16 a[178:179], v121 offset:9088
    v_add_f32 v81, v81, v64
    v_mfma_f32_16x16x32_bf16 v[68:71], a[148:151], v[148:151], v[68:71]
    ds_read_b64_tr_b16 a[180:181], v121 offset:8608
    v_exp_f32 v65, v65
    v_mfma_f32_16x16x32_bf16 v[68:71], a[152:155], v[152:155], v[68:71]
    v_cvt_pk_bf16_f32 v76, v64, v65
    v_add_f32 v81, v81, v65
    v_mfma_f32_16x16x32_bf16 v[68:71], a[156:159], v[156:159], v[68:71]
    s_waitcnt lgkmcnt(9)
    ds_read_b64_tr_b16 a[182:183], v121 offset:9120
    v_exp_f32 v66, v66
    v_mfma_f32_16x16x32_bf16 a[0:3], a[160:163], v[72:75], a[0:3]
    s_waitcnt lgkmcnt(8)
    ds_read_b64_tr_b16 a[184:185], v121 offset:8640
    v_add_f32 v81, v81, v66
    v_mfma_f32_16x16x32_bf16 a[4:7], a[164:167], v[72:75], a[4:7]
    s_waitcnt lgkmcnt(7)
    ds_read_b64_tr_b16 a[186:187], v121 offset:9152
    v_exp_f32 v67, v67
    v_mfma_f32_16x16x32_bf16 a[8:11], a[168:171], v[72:75], a[8:11]
    s_waitcnt lgkmcnt(6)
    v_cvt_pk_bf16_f32 v77, v66, v67
    v_add_f32 v81, v81, v67
    v_mfma_f32_16x16x32_bf16 a[12:15], a[172:175], v[72:75], a[12:15]
    ds_read_b64_tr_b16 a[188:189], v121 offset:8672
    v_exp_f32 v68, v68
    v_mfma_f32_16x16x32_bf16 v[64:67], a[128:131], v[160:163], v[96:99]
    ds_read_b64_tr_b16 a[190:191], v121 offset:9184
    v_add_f32 v81, v81, v68
    v_mfma_f32_16x16x32_bf16 v[64:67], a[132:135], v[164:167], v[64:67]
    v_exp_f32 v69, v69
    v_mfma_f32_16x16x32_bf16 v[64:67], a[136:139], v[168:171], v[64:67]
    v_cvt_pk_bf16_f32 v78, v68, v69
    v_add_f32 v81, v81, v69
    v_mfma_f32_16x16x32_bf16 v[64:67], a[140:143], v[172:175], v[64:67]
    s_waitcnt lgkmcnt(6)
    v_exp_f32 v70, v70
    v_mfma_f32_16x16x32_bf16 a[16:19], a[176:179], v[72:75], a[16:19]
    s_waitcnt lgkmcnt(4)
    v_add_f32 v81, v81, v70
    v_mfma_f32_16x16x32_bf16 a[20:23], a[180:183], v[72:75], a[20:23]
    s_waitcnt lgkmcnt(2)
    v_exp_f32 v71, v71
    v_mfma_f32_16x16x32_bf16 a[24:27], a[184:187], v[72:75], a[24:27]
    s_waitcnt lgkmcnt(0)
    v_cvt_pk_bf16_f32 v79, v70, v71
    v_add_f32 v81, v81, v71
    v_mfma_f32_16x16x32_bf16 a[28:31], a[188:191], v[72:75], a[28:31]
    s_waitcnt vmcnt(0)
    v_exp_f32 v64, v64
    v_mfma_f32_16x16x32_bf16 v[68:71], a[144:147], v[160:163], v[96:99]
    s_barrier
    v_add_f32 v82, v82, v64
    v_mfma_f32_16x16x32_bf16 v[68:71], a[148:151], v[164:167], v[68:71]
    v_exp_f32 v65, v65
    v_mfma_f32_16x16x32_bf16 v[68:71], a[152:155], v[168:171], v[68:71]
    v_cvt_pk_bf16_f32 v72, v64, v65
    v_add_f32 v82, v82, v65
    v_mfma_f32_16x16x32_bf16 v[68:71], a[156:159], v[172:175], v[68:71]
    v_exp_f32 v66, v66
    v_mfma_f32_16x16x32_bf16 a[32:35], a[160:163], v[76:79], a[32:35]
    v_add_f32 v82, v82, v66
    v_mfma_f32_16x16x32_bf16 a[36:39], a[164:167], v[76:79], a[36:39]
    v_exp_f32 v67, v67
    v_mfma_f32_16x16x32_bf16 a[40:43], a[168:171], v[76:79], a[40:43]
    v_cvt_pk_bf16_f32 v73, v66, v67
    v_add_f32 v82, v82, v67
    v_mfma_f32_16x16x32_bf16 a[44:47], a[172:175], v[76:79], a[44:47]
    v_exp_f32 v68, v68
    v_mfma_f32_16x16x32_bf16 v[64:67], a[128:131], v[176:179], v[100:103]
    ds_read_b128 a[128:131], v120 offset:16896
    v_add_f32 v82, v82, v68
    v_mfma_f32_16x16x32_bf16 v[64:67], a[132:135], v[180:183], v[64:67]
    v_exp_f32 v69, v69
    v_mfma_f32_16x16x32_bf16 v[64:67], a[136:139], v[184:187], v[64:67]
    v_cvt_pk_bf16_f32 v74, v68, v69
    v_add_f32 v82, v82, v69
    v_mfma_f32_16x16x32_bf16 v[64:67], a[140:143], v[188:191], v[64:67]
    v_exp_f32 v70, v70
    v_mfma_f32_16x16x32_bf16 a[48:51], a[176:179], v[76:79], a[48:51]
    ds_read_b128 a[132:135], v120 offset:16960
    v_add_f32 v82, v82, v70
    v_mfma_f32_16x16x32_bf16 a[52:55], a[180:183], v[76:79], a[52:55]
    ds_read_b128 a[136:139], v120 offset:17024
    v_exp_f32 v71, v71
    v_mfma_f32_16x16x32_bf16 a[56:59], a[184:187], v[76:79], a[56:59]
    v_cvt_pk_bf16_f32 v75, v70, v71
    v_add_f32 v82, v82, v71
    v_mfma_f32_16x16x32_bf16 a[60:63], a[188:191], v[76:79], a[60:63]
    v_exp_f32 v64, v64
    v_mfma_f32_16x16x32_bf16 v[68:71], a[144:147], v[176:179], v[100:103]
    ds_read_b128 a[140:143], v120 offset:17088
    v_add_f32 v83, v83, v64
    v_mfma_f32_16x16x32_bf16 v[68:71], a[148:151], v[180:183], v[68:71]
    v_exp_f32 v65, v65
    v_mfma_f32_16x16x32_bf16 v[68:71], a[152:155], v[184:187], v[68:71]
    v_cvt_pk_bf16_f32 v76, v64, v65
    v_add_f32 v83, v83, v65
    v_mfma_f32_16x16x32_bf16 v[68:71], a[156:159], v[188:191], v[68:71]
    v_exp_f32 v66, v66
    v_mfma_f32_16x16x32_bf16 a[64:67], a[160:163], v[72:75], a[64:67]
    ds_read_b128 a[144:147], v120 offset:17408
    v_add_f32 v83, v83, v66
    v_mfma_f32_16x16x32_bf16 a[68:71], a[164:167], v[72:75], a[68:71]
    ds_read_b128 a[148:151], v120 offset:17472
    v_exp_f32 v67, v67
    v_mfma_f32_16x16x32_bf16 a[72:75], a[168:171], v[72:75], a[72:75]
    v_cvt_pk_bf16_f32 v77, v66, v67
    v_add_f32 v83, v83, v67
    v_mfma_f32_16x16x32_bf16 a[76:79], a[172:175], v[72:75], a[76:79]
    s_waitcnt lgkmcnt(5)
    v_exp_f32 v68, v68
    v_mfma_f32_16x16x32_bf16 v[64:67], a[128:131], v[128:131], v[88:91]
    s_waitcnt lgkmcnt(4)
    ds_read_b128 a[152:155], v120 offset:17536
    v_add_f32 v83, v83, v68
    v_mfma_f32_16x16x32_bf16 v[64:67], a[132:135], v[132:135], v[64:67]
    s_waitcnt lgkmcnt(4)
    v_exp_f32 v69, v69
    v_mfma_f32_16x16x32_bf16 v[64:67], a[136:139], v[136:139], v[64:67]
    s_waitcnt lgkmcnt(3)
    v_cvt_pk_bf16_f32 v78, v68, v69
    v_add_f32 v83, v83, v69
    v_mfma_f32_16x16x32_bf16 v[64:67], a[140:143], v[140:143], v[64:67]
    v_exp_f32 v70, v70
    v_mfma_f32_16x16x32_bf16 a[80:83], a[176:179], v[72:75], a[80:83]
    ds_read_b128 a[156:159], v120 offset:17600
    v_add_f32 v83, v83, v70
    v_mfma_f32_16x16x32_bf16 a[84:87], a[180:183], v[72:75], a[84:87]
    v_exp_f32 v71, v71
    v_mfma_f32_16x16x32_bf16 a[88:91], a[184:187], v[72:75], a[88:91]
    v_cvt_pk_bf16_f32 v79, v70, v71
    v_add_f32 v83, v83, v71
    v_mfma_f32_16x16x32_bf16 a[92:95], a[188:191], v[72:75], a[92:95]
    s_waitcnt lgkmcnt(3)
    v_exp_f32 v64, v64
    v_mfma_f32_16x16x32_bf16 v[68:71], a[144:147], v[128:131], v[88:91]
    s_waitcnt lgkmcnt(2)
    v_add_f32 v80, v80, v64
    v_mfma_f32_16x16x32_bf16 v[68:71], a[148:151], v[132:135], v[68:71]
    s_waitcnt lgkmcnt(1)
    v_exp_f32 v65, v65
    v_mfma_f32_16x16x32_bf16 v[68:71], a[152:155], v[136:139], v[68:71]
    s_waitcnt lgkmcnt(0)
    v_cvt_pk_bf16_f32 v72, v64, v65
    v_add_f32 v80, v80, v65
    v_mfma_f32_16x16x32_bf16 v[68:71], a[156:159], v[140:143], v[68:71]
    v_exp_f32 v66, v66
    v_mfma_f32_16x16x32_bf16 a[96:99], a[160:163], v[76:79], a[96:99]
    ds_read_b64_tr_b16 a[160:161], v121 offset:16896
    v_add_f32 v80, v80, v66
    v_mfma_f32_16x16x32_bf16 a[100:103], a[164:167], v[76:79], a[100:103]
    ds_read_b64_tr_b16 a[162:163], v121 offset:17408
    v_exp_f32 v67, v67
    v_mfma_f32_16x16x32_bf16 a[104:107], a[168:171], v[76:79], a[104:107]
    v_cvt_pk_bf16_f32 v73, v66, v67
    v_add_f32 v80, v80, v67
    v_mfma_f32_16x16x32_bf16 a[108:111], a[172:175], v[76:79], a[108:111]
    ds_read_b64_tr_b16 a[164:165], v121 offset:16928
    v_exp_f32 v68, v68
    v_mfma_f32_16x16x32_bf16 v[64:67], a[128:131], v[144:147], v[92:95]
    ds_read_b64_tr_b16 a[166:167], v121 offset:17440
    v_add_f32 v80, v80, v68
    v_mfma_f32_16x16x32_bf16 v[64:67], a[132:135], v[148:151], v[64:67]
    ds_read_b64_tr_b16 a[168:169], v121 offset:16960
    v_exp_f32 v69, v69
    v_mfma_f32_16x16x32_bf16 v[64:67], a[136:139], v[152:155], v[64:67]
    v_cvt_pk_bf16_f32 v74, v68, v69
    v_add_f32 v80, v80, v69
    v_mfma_f32_16x16x32_bf16 v[64:67], a[140:143], v[156:159], v[64:67]
    ds_read_b64_tr_b16 a[170:171], v121 offset:17472
    v_exp_f32 v70, v70
    v_mfma_f32_16x16x32_bf16 a[112:115], a[176:179], v[76:79], a[112:115]
    ds_read_b64_tr_b16 a[172:173], v121 offset:16992
    v_add_f32 v80, v80, v70
    v_mfma_f32_16x16x32_bf16 a[116:119], a[180:183], v[76:79], a[116:119]
    ds_read_b64_tr_b16 a[174:175], v121 offset:17504
    v_exp_f32 v71, v71
    v_mfma_f32_16x16x32_bf16 a[120:123], a[184:187], v[76:79], a[120:123]
    v_cvt_pk_bf16_f32 v75, v70, v71
    v_add_f32 v80, v80, v71
    v_mfma_f32_16x16x32_bf16 a[124:127], a[188:191], v[76:79], a[124:127]
    ds_read_b64_tr_b16 a[176:177], v121 offset:17024
    v_exp_f32 v64, v64
    v_mfma_f32_16x16x32_bf16 v[68:71], a[144:147], v[144:147], v[92:95]
    ds_read_b64_tr_b16 a[178:179], v121 offset:17536
    v_add_f32 v81, v81, v64
    v_mfma_f32_16x16x32_bf16 v[68:71], a[148:151], v[148:151], v[68:71]
    ds_read_b64_tr_b16 a[180:181], v121 offset:17056
    v_exp_f32 v65, v65
    v_mfma_f32_16x16x32_bf16 v[68:71], a[152:155], v[152:155], v[68:71]
    v_cvt_pk_bf16_f32 v76, v64, v65
    v_add_f32 v81, v81, v65
    v_mfma_f32_16x16x32_bf16 v[68:71], a[156:159], v[156:159], v[68:71]
    s_waitcnt lgkmcnt(9)
    ds_read_b64_tr_b16 a[182:183], v121 offset:17568
    v_exp_f32 v66, v66
    v_mfma_f32_16x16x32_bf16 a[0:3], a[160:163], v[72:75], a[0:3]
    s_waitcnt lgkmcnt(8)
    ds_read_b64_tr_b16 a[184:185], v121 offset:17088
    v_add_f32 v81, v81, v66
    v_mfma_f32_16x16x32_bf16 a[4:7], a[164:167], v[72:75], a[4:7]
    s_waitcnt lgkmcnt(7)
    ds_read_b64_tr_b16 a[186:187], v121 offset:17600
    v_exp_f32 v67, v67
    v_mfma_f32_16x16x32_bf16 a[8:11], a[168:171], v[72:75], a[8:11]
    s_waitcnt lgkmcnt(6)
    v_cvt_pk_bf16_f32 v77, v66, v67
    v_add_f32 v81, v81, v67
    v_mfma_f32_16x16x32_bf16 a[12:15], a[172:175], v[72:75], a[12:15]
    ds_read_b64_tr_b16 a[188:189], v121 offset:17120
    v_exp_f32 v68, v68
    v_mfma_f32_16x16x32_bf16 v[64:67], a[128:131], v[160:163], v[96:99]
    ds_read_b64_tr_b16 a[190:191], v121 offset:17632
    v_add_f32 v81, v81, v68
    v_mfma_f32_16x16x32_bf16 v[64:67], a[132:135], v[164:167], v[64:67]
    v_exp_f32 v69, v69
    v_mfma_f32_16x16x32_bf16 v[64:67], a[136:139], v[168:171], v[64:67]
    v_cvt_pk_bf16_f32 v78, v68, v69
    v_add_f32 v81, v81, v69
    v_mfma_f32_16x16x32_bf16 v[64:67], a[140:143], v[172:175], v[64:67]
    s_waitcnt lgkmcnt(6)
    v_exp_f32 v70, v70
    v_mfma_f32_16x16x32_bf16 a[16:19], a[176:179], v[72:75], a[16:19]
    s_waitcnt lgkmcnt(4)
    v_add_f32 v81, v81, v70
    v_mfma_f32_16x16x32_bf16 a[20:23], a[180:183], v[72:75], a[20:23]
    s_waitcnt lgkmcnt(2)
    v_exp_f32 v71, v71
    v_mfma_f32_16x16x32_bf16 a[24:27], a[184:187], v[72:75], a[24:27]
    s_waitcnt lgkmcnt(0)
    v_cvt_pk_bf16_f32 v79, v70, v71
    v_add_f32 v81, v81, v71
    v_mfma_f32_16x16x32_bf16 a[28:31], a[188:191], v[72:75], a[28:31]
    v_exp_f32 v64, v64
    v_mfma_f32_16x16x32_bf16 v[68:71], a[144:147], v[160:163], v[96:99]
    v_add_f32 v82, v82, v64
    v_mfma_f32_16x16x32_bf16 v[68:71], a[148:151], v[164:167], v[68:71]
    v_exp_f32 v65, v65
    v_mfma_f32_16x16x32_bf16 v[68:71], a[152:155], v[168:171], v[68:71]
    v_cvt_pk_bf16_f32 v72, v64, v65
    v_add_f32 v82, v82, v65
    v_mfma_f32_16x16x32_bf16 v[68:71], a[156:159], v[172:175], v[68:71]
    v_exp_f32 v66, v66
    v_mfma_f32_16x16x32_bf16 a[32:35], a[160:163], v[76:79], a[32:35]
    v_add_f32 v82, v82, v66
    v_mfma_f32_16x16x32_bf16 a[36:39], a[164:167], v[76:79], a[36:39]
    v_exp_f32 v67, v67
    v_mfma_f32_16x16x32_bf16 a[40:43], a[168:171], v[76:79], a[40:43]
    v_cvt_pk_bf16_f32 v73, v66, v67
    v_add_f32 v82, v82, v67
    v_mfma_f32_16x16x32_bf16 a[44:47], a[172:175], v[76:79], a[44:47]
    v_exp_f32 v68, v68
    v_mfma_f32_16x16x32_bf16 v[64:67], a[128:131], v[176:179], v[100:103]
    ds_read_b128 a[128:131], v120 offset:25344
    v_add_f32 v82, v82, v68
    v_mfma_f32_16x16x32_bf16 v[64:67], a[132:135], v[180:183], v[64:67]
    v_exp_f32 v69, v69
    v_mfma_f32_16x16x32_bf16 v[64:67], a[136:139], v[184:187], v[64:67]
    v_cvt_pk_bf16_f32 v74, v68, v69
    v_add_f32 v82, v82, v69
    v_mfma_f32_16x16x32_bf16 v[64:67], a[140:143], v[188:191], v[64:67]
    v_exp_f32 v70, v70
    v_mfma_f32_16x16x32_bf16 a[48:51], a[176:179], v[76:79], a[48:51]
    ds_read_b128 a[132:135], v120 offset:25408
    v_add_f32 v82, v82, v70
    v_mfma_f32_16x16x32_bf16 a[52:55], a[180:183], v[76:79], a[52:55]
    ds_read_b128 a[136:139], v120 offset:25472
    v_exp_f32 v71, v71
    v_mfma_f32_16x16x32_bf16 a[56:59], a[184:187], v[76:79], a[56:59]
    v_cvt_pk_bf16_f32 v75, v70, v71
    v_add_f32 v82, v82, v71
    v_mfma_f32_16x16x32_bf16 a[60:63], a[188:191], v[76:79], a[60:63]
    v_exp_f32 v64, v64
    v_mfma_f32_16x16x32_bf16 v[68:71], a[144:147], v[176:179], v[100:103]
    ds_read_b128 a[140:143], v120 offset:25536
    v_add_f32 v83, v83, v64
    v_mfma_f32_16x16x32_bf16 v[68:71], a[148:151], v[180:183], v[68:71]
    v_exp_f32 v65, v65
    v_mfma_f32_16x16x32_bf16 v[68:71], a[152:155], v[184:187], v[68:71]
    v_cvt_pk_bf16_f32 v76, v64, v65
    v_add_f32 v83, v83, v65
    v_mfma_f32_16x16x32_bf16 v[68:71], a[156:159], v[188:191], v[68:71]
    v_exp_f32 v66, v66
    v_mfma_f32_16x16x32_bf16 a[64:67], a[160:163], v[72:75], a[64:67]
    ds_read_b128 a[144:147], v120 offset:25856
    v_add_f32 v83, v83, v66
    v_mfma_f32_16x16x32_bf16 a[68:71], a[164:167], v[72:75], a[68:71]
    ds_read_b128 a[148:151], v120 offset:25920
    v_exp_f32 v67, v67
    v_mfma_f32_16x16x32_bf16 a[72:75], a[168:171], v[72:75], a[72:75]
    v_cvt_pk_bf16_f32 v77, v66, v67
    v_add_f32 v83, v83, v67
    v_mfma_f32_16x16x32_bf16 a[76:79], a[172:175], v[72:75], a[76:79]
    s_waitcnt lgkmcnt(5)
    v_exp_f32 v68, v68
    v_mfma_f32_16x16x32_bf16 v[64:67], a[128:131], v[128:131], v[88:91]
    s_waitcnt lgkmcnt(4)
    ds_read_b128 a[152:155], v120 offset:25984
    v_add_f32 v83, v83, v68
    v_mfma_f32_16x16x32_bf16 v[64:67], a[132:135], v[132:135], v[64:67]
    s_waitcnt lgkmcnt(4)
    v_exp_f32 v69, v69
    v_mfma_f32_16x16x32_bf16 v[64:67], a[136:139], v[136:139], v[64:67]
    s_waitcnt lgkmcnt(3)
    v_cvt_pk_bf16_f32 v78, v68, v69
    v_add_f32 v83, v83, v69
    v_mfma_f32_16x16x32_bf16 v[64:67], a[140:143], v[140:143], v[64:67]
    v_exp_f32 v70, v70
    v_mfma_f32_16x16x32_bf16 a[80:83], a[176:179], v[72:75], a[80:83]
    ds_read_b128 a[156:159], v120 offset:26048
    v_add_f32 v83, v83, v70
    v_mfma_f32_16x16x32_bf16 a[84:87], a[180:183], v[72:75], a[84:87]
    v_exp_f32 v71, v71
    v_mfma_f32_16x16x32_bf16 a[88:91], a[184:187], v[72:75], a[88:91]
    v_cvt_pk_bf16_f32 v79, v70, v71
    v_add_f32 v83, v83, v71
    v_mfma_f32_16x16x32_bf16 a[92:95], a[188:191], v[72:75], a[92:95]
    s_waitcnt lgkmcnt(3)
    v_exp_f32 v64, v64
    v_mfma_f32_16x16x32_bf16 v[68:71], a[144:147], v[128:131], v[88:91]
    s_waitcnt lgkmcnt(2)
    v_add_f32 v80, v80, v64
    v_mfma_f32_16x16x32_bf16 v[68:71], a[148:151], v[132:135], v[68:71]
    s_waitcnt lgkmcnt(1)
    v_exp_f32 v65, v65
    v_mfma_f32_16x16x32_bf16 v[68:71], a[152:155], v[136:139], v[68:71]
    s_waitcnt lgkmcnt(0)
    v_cvt_pk_bf16_f32 v72, v64, v65
    v_add_f32 v80, v80, v65
    v_mfma_f32_16x16x32_bf16 v[68:71], a[156:159], v[140:143], v[68:71]
    v_exp_f32 v66, v66
    v_mfma_f32_16x16x32_bf16 a[96:99], a[160:163], v[76:79], a[96:99]
    ds_read_b64_tr_b16 a[160:161], v121 offset:25344
    v_add_f32 v80, v80, v66
    v_mfma_f32_16x16x32_bf16 a[100:103], a[164:167], v[76:79], a[100:103]
    ds_read_b64_tr_b16 a[162:163], v121 offset:25856
    v_exp_f32 v67, v67
    v_mfma_f32_16x16x32_bf16 a[104:107], a[168:171], v[76:79], a[104:107]
    v_cvt_pk_bf16_f32 v73, v66, v67
    v_add_f32 v80, v80, v67
    v_mfma_f32_16x16x32_bf16 a[108:111], a[172:175], v[76:79], a[108:111]
    ds_read_b64_tr_b16 a[164:165], v121 offset:25376
    v_exp_f32 v68, v68
    v_mfma_f32_16x16x32_bf16 v[64:67], a[128:131], v[144:147], v[92:95]
    ds_read_b64_tr_b16 a[166:167], v121 offset:25888
    v_add_f32 v80, v80, v68
    v_mfma_f32_16x16x32_bf16 v[64:67], a[132:135], v[148:151], v[64:67]
    ds_read_b64_tr_b16 a[168:169], v121 offset:25408
    v_exp_f32 v69, v69
    v_mfma_f32_16x16x32_bf16 v[64:67], a[136:139], v[152:155], v[64:67]
    v_cvt_pk_bf16_f32 v74, v68, v69
    v_add_f32 v80, v80, v69
    v_mfma_f32_16x16x32_bf16 v[64:67], a[140:143], v[156:159], v[64:67]
    ds_read_b64_tr_b16 a[170:171], v121 offset:25920
    v_exp_f32 v70, v70
    v_mfma_f32_16x16x32_bf16 a[112:115], a[176:179], v[76:79], a[112:115]
    ds_read_b64_tr_b16 a[172:173], v121 offset:25440
    v_add_f32 v80, v80, v70
    v_mfma_f32_16x16x32_bf16 a[116:119], a[180:183], v[76:79], a[116:119]
    ds_read_b64_tr_b16 a[174:175], v121 offset:25952
    v_exp_f32 v71, v71
    v_mfma_f32_16x16x32_bf16 a[120:123], a[184:187], v[76:79], a[120:123]
    v_cvt_pk_bf16_f32 v75, v70, v71
    v_add_f32 v80, v80, v71
    v_mfma_f32_16x16x32_bf16 a[124:127], a[188:191], v[76:79], a[124:127]
    ds_read_b64_tr_b16 a[176:177], v121 offset:25472
    v_exp_f32 v64, v64
    v_mfma_f32_16x16x32_bf16 v[68:71], a[144:147], v[144:147], v[92:95]
    ds_read_b64_tr_b16 a[178:179], v121 offset:25984
    v_add_f32 v81, v81, v64
    v_mfma_f32_16x16x32_bf16 v[68:71], a[148:151], v[148:151], v[68:71]
    ds_read_b64_tr_b16 a[180:181], v121 offset:25504
    v_exp_f32 v65, v65
    v_mfma_f32_16x16x32_bf16 v[68:71], a[152:155], v[152:155], v[68:71]
    v_cvt_pk_bf16_f32 v76, v64, v65
    v_add_f32 v81, v81, v65
    v_mfma_f32_16x16x32_bf16 v[68:71], a[156:159], v[156:159], v[68:71]
    s_waitcnt lgkmcnt(9)
    ds_read_b64_tr_b16 a[182:183], v121 offset:26016
    v_exp_f32 v66, v66
    v_mfma_f32_16x16x32_bf16 a[0:3], a[160:163], v[72:75], a[0:3]
    s_waitcnt lgkmcnt(8)
    ds_read_b64_tr_b16 a[184:185], v121 offset:25536
    v_add_f32 v81, v81, v66
    v_mfma_f32_16x16x32_bf16 a[4:7], a[164:167], v[72:75], a[4:7]
    s_waitcnt lgkmcnt(7)
    ds_read_b64_tr_b16 a[186:187], v121 offset:26048
    v_exp_f32 v67, v67
    v_mfma_f32_16x16x32_bf16 a[8:11], a[168:171], v[72:75], a[8:11]
    s_waitcnt lgkmcnt(6)
    v_cvt_pk_bf16_f32 v77, v66, v67
    v_add_f32 v81, v81, v67
    v_mfma_f32_16x16x32_bf16 a[12:15], a[172:175], v[72:75], a[12:15]
    ds_read_b64_tr_b16 a[188:189], v121 offset:25568
    v_exp_f32 v68, v68
    v_mfma_f32_16x16x32_bf16 v[64:67], a[128:131], v[160:163], v[96:99]
    ds_read_b64_tr_b16 a[190:191], v121 offset:26080
    v_add_f32 v81, v81, v68
    v_mfma_f32_16x16x32_bf16 v[64:67], a[132:135], v[164:167], v[64:67]
    v_exp_f32 v69, v69
    v_mfma_f32_16x16x32_bf16 v[64:67], a[136:139], v[168:171], v[64:67]
    v_cvt_pk_bf16_f32 v78, v68, v69
    v_add_f32 v81, v81, v69
    v_mfma_f32_16x16x32_bf16 v[64:67], a[140:143], v[172:175], v[64:67]
    s_waitcnt lgkmcnt(6)
    v_exp_f32 v70, v70
    v_mfma_f32_16x16x32_bf16 a[16:19], a[176:179], v[72:75], a[16:19]
    s_waitcnt lgkmcnt(4)
    v_add_f32 v81, v81, v70
    v_mfma_f32_16x16x32_bf16 a[20:23], a[180:183], v[72:75], a[20:23]
    s_waitcnt lgkmcnt(2)
    v_exp_f32 v71, v71
    v_mfma_f32_16x16x32_bf16 a[24:27], a[184:187], v[72:75], a[24:27]
    s_waitcnt lgkmcnt(0)
    v_cvt_pk_bf16_f32 v79, v70, v71
    v_add_f32 v81, v81, v71
    v_mfma_f32_16x16x32_bf16 a[28:31], a[188:191], v[72:75], a[28:31]
    v_exp_f32 v64, v64
    v_mfma_f32_16x16x32_bf16 v[68:71], a[144:147], v[160:163], v[96:99]
    v_add_f32 v82, v82, v64
    v_mfma_f32_16x16x32_bf16 v[68:71], a[148:151], v[164:167], v[68:71]
    v_exp_f32 v65, v65
    v_mfma_f32_16x16x32_bf16 v[68:71], a[152:155], v[168:171], v[68:71]
    v_cvt_pk_bf16_f32 v72, v64, v65
    v_add_f32 v82, v82, v65
    v_mfma_f32_16x16x32_bf16 v[68:71], a[156:159], v[172:175], v[68:71]
    v_exp_f32 v66, v66
    v_mfma_f32_16x16x32_bf16 a[32:35], a[160:163], v[76:79], a[32:35]
    v_add_f32 v82, v82, v66
    v_mfma_f32_16x16x32_bf16 a[36:39], a[164:167], v[76:79], a[36:39]
    v_exp_f32 v67, v67
    v_mfma_f32_16x16x32_bf16 a[40:43], a[168:171], v[76:79], a[40:43]
    v_cvt_pk_bf16_f32 v73, v66, v67
    v_add_f32 v82, v82, v67
    v_mfma_f32_16x16x32_bf16 a[44:47], a[172:175], v[76:79], a[44:47]
    v_exp_f32 v68, v68
    v_mfma_f32_16x16x32_bf16 v[64:67], a[128:131], v[176:179], v[100:103]
    ds_read_b128 a[128:131], v120 offset:0
    v_add_f32 v82, v82, v68
    v_mfma_f32_16x16x32_bf16 v[64:67], a[132:135], v[180:183], v[64:67]
    v_exp_f32 v69, v69
    v_mfma_f32_16x16x32_bf16 v[64:67], a[136:139], v[184:187], v[64:67]
    v_cvt_pk_bf16_f32 v74, v68, v69
    v_add_f32 v82, v82, v69
    v_mfma_f32_16x16x32_bf16 v[64:67], a[140:143], v[188:191], v[64:67]
    v_exp_f32 v70, v70
    v_mfma_f32_16x16x32_bf16 a[48:51], a[176:179], v[76:79], a[48:51]
    ds_read_b128 a[132:135], v120 offset:64
    v_add_f32 v82, v82, v70
    v_mfma_f32_16x16x32_bf16 a[52:55], a[180:183], v[76:79], a[52:55]
    ds_read_b128 a[136:139], v120 offset:128
    v_exp_f32 v71, v71
    v_mfma_f32_16x16x32_bf16 a[56:59], a[184:187], v[76:79], a[56:59]
    v_cvt_pk_bf16_f32 v75, v70, v71
    v_add_f32 v82, v82, v71
    v_mfma_f32_16x16x32_bf16 a[60:63], a[188:191], v[76:79], a[60:63]
    v_exp_f32 v64, v64
    v_mfma_f32_16x16x32_bf16 v[68:71], a[144:147], v[176:179], v[100:103]
    ds_read_b128 a[140:143], v120 offset:192
    v_add_f32 v83, v83, v64
    v_mfma_f32_16x16x32_bf16 v[68:71], a[148:151], v[180:183], v[68:71]
    v_exp_f32 v65, v65
    v_mfma_f32_16x16x32_bf16 v[68:71], a[152:155], v[184:187], v[68:71]
    v_cvt_pk_bf16_f32 v76, v64, v65
    v_add_f32 v83, v83, v65
    v_mfma_f32_16x16x32_bf16 v[68:71], a[156:159], v[188:191], v[68:71]
    v_exp_f32 v66, v66
    v_mfma_f32_16x16x32_bf16 a[64:67], a[160:163], v[72:75], a[64:67]
    ds_read_b128 a[144:147], v120 offset:512
    v_add_f32 v83, v83, v66
    v_mfma_f32_16x16x32_bf16 a[68:71], a[164:167], v[72:75], a[68:71]
    ds_read_b128 a[148:151], v120 offset:576
    v_exp_f32 v67, v67
    v_mfma_f32_16x16x32_bf16 a[72:75], a[168:171], v[72:75], a[72:75]
    v_cvt_pk_bf16_f32 v77, v66, v67
    v_add_f32 v83, v83, v67
    v_mfma_f32_16x16x32_bf16 a[76:79], a[172:175], v[72:75], a[76:79]
    s_waitcnt lgkmcnt(5)
    v_exp_f32 v68, v68
    v_mfma_f32_16x16x32_bf16 v[64:67], a[128:131], v[192:195], v[104:107]
    s_waitcnt lgkmcnt(4)
    ds_read_b128 a[152:155], v120 offset:640
    v_add_f32 v83, v83, v68
    v_mfma_f32_16x16x32_bf16 v[64:67], a[132:135], v[196:199], v[64:67]
    s_waitcnt lgkmcnt(4)
    v_exp_f32 v69, v69
    v_mfma_f32_16x16x32_bf16 v[64:67], a[136:139], v[200:203], v[64:67]
    s_waitcnt lgkmcnt(3)
    v_cvt_pk_bf16_f32 v78, v68, v69
    v_add_f32 v83, v83, v69
    v_mfma_f32_16x16x32_bf16 v[64:67], a[140:143], v[204:207], v[64:67]
    v_exp_f32 v70, v70
    v_mfma_f32_16x16x32_bf16 a[80:83], a[176:179], v[72:75], a[80:83]
    ds_read_b128 a[156:159], v120 offset:704
    v_add_f32 v83, v83, v70
    v_mfma_f32_16x16x32_bf16 a[84:87], a[180:183], v[72:75], a[84:87]
    v_exp_f32 v71, v71
    v_mfma_f32_16x16x32_bf16 a[88:91], a[184:187], v[72:75], a[88:91]
    v_cvt_pk_bf16_f32 v79, v70, v71
    v_add_f32 v83, v83, v71
    v_mfma_f32_16x16x32_bf16 a[92:95], a[188:191], v[72:75], a[92:95]
    s_waitcnt lgkmcnt(3)
    v_exp_f32 v64, v64
    v_mfma_f32_16x16x32_bf16 v[68:71], a[144:147], v[192:195], v[104:107]
    s_waitcnt lgkmcnt(2)
    v_add_f32 v84, v84, v64
    v_permlane32_swap_b32 v80, v81
    v_mfma_f32_16x16x32_bf16 v[68:71], a[148:151], v[196:199], v[68:71]
    s_waitcnt lgkmcnt(1)
    v_exp_f32 v65, v65
    v_permlane32_swap_b32 v82, v83
    v_add_f32 v80, v80, v81
    v_add_f32 v82, v82, v83
    v_mfma_f32_16x16x32_bf16 v[68:71], a[152:155], v[200:203], v[68:71]
    s_waitcnt lgkmcnt(0)
    v_cvt_pk_bf16_f32 v72, v64, v65
    v_add_f32 v84, v84, v65
    v_permlane16_swap_b32 v80, v82
    v_add_f32 v80, v80, v82
    v_cmp_nge_f32 vcc, 0x53800000, v80
    v_mfma_f32_16x16x32_bf16 v[68:71], a[156:159], v[204:207], v[68:71]
    v_exp_f32 v66, v66
    v_rcp_f32 v80, v80
    v_mfma_f32_16x16x32_bf16 a[96:99], a[160:163], v[76:79], a[96:99]
    s_or_b64 s[48:49], s[48:49], vcc
    ds_read_b64_tr_b16 a[160:161], v121 offset:0
    v_add_f32 v84, v84, v66
    v_mov_b32 v82, v80
    v_mfma_f32_16x16x32_bf16 a[100:103], a[164:167], v[76:79], a[100:103]
    ds_read_b64_tr_b16 a[162:163], v121 offset:512
    v_exp_f32 v67, v67
    v_permlane16_swap_b32 v80, v82
    v_mov_b32 v81, v80
    v_mov_b32 v83, v82
    v_mfma_f32_16x16x32_bf16 a[104:107], a[168:171], v[76:79], a[104:107]
    v_cvt_pk_bf16_f32 v73, v66, v67
    v_add_f32 v84, v84, v67
    v_permlane32_swap_b32 v80, v81
    v_mfma_f32_16x16x32_bf16 a[108:111], a[172:175], v[76:79], a[108:111]
    ds_read_b64_tr_b16 a[164:165], v121 offset:32
    v_exp_f32 v68, v68
    v_permlane32_swap_b32 v82, v83
    v_accvgpr_read_b32 v88, a0
    v_accvgpr_read_b32 v89, a1
    v_mfma_f32_16x16x32_bf16 v[64:67], a[128:131], v[208:211], v[108:111]
    ds_read_b64_tr_b16 a[166:167], v121 offset:544
    v_add_f32 v84, v84, v68
    v_accvgpr_read_b32 v90, a2
    v_accvgpr_read_b32 v91, a3
    v_accvgpr_read_b32 v92, a4
    v_mfma_f32_16x16x32_bf16 v[64:67], a[132:135], v[212:215], v[64:67]
    ds_read_b64_tr_b16 a[168:169], v121 offset:64
    v_exp_f32 v69, v69
    v_accvgpr_read_b32 v93, a5
    v_accvgpr_read_b32 v94, a6
    v_accvgpr_read_b32 v95, a7
    v_mfma_f32_16x16x32_bf16 v[64:67], a[136:139], v[216:219], v[64:67]
    v_cvt_pk_bf16_f32 v74, v68, v69
    v_add_f32 v84, v84, v69
    v_mul_f32 v88, v88, v80
    v_mul_f32 v89, v89, v80
    v_mul_f32 v90, v90, v80
    v_mfma_f32_16x16x32_bf16 v[64:67], a[140:143], v[220:223], v[64:67]
    ds_read_b64_tr_b16 a[170:171], v121 offset:576
    v_exp_f32 v70, v70
    v_mul_f32 v91, v91, v80
    v_mul_f32 v92, v92, v80
    v_mul_f32 v93, v93, v80
    v_mfma_f32_16x16x32_bf16 a[112:115], a[176:179], v[76:79], a[112:115]
    ds_read_b64_tr_b16 a[172:173], v121 offset:96
    v_add_f32 v84, v84, v70
    v_mul_f32 v94, v94, v80
    v_mul_f32 v95, v95, v80
    v_cvt_pk_bf16_f32 v96, v88, v89
    v_mfma_f32_16x16x32_bf16 a[116:119], a[180:183], v[76:79], a[116:119]
    ds_read_b64_tr_b16 a[174:175], v121 offset:608
    v_exp_f32 v71, v71
    v_cvt_pk_bf16_f32 v97, v90, v91
    v_cvt_pk_bf16_f32 v98, v92, v93
    v_cvt_pk_bf16_f32 v99, v94, v95
    v_mfma_f32_16x16x32_bf16 a[120:123], a[184:187], v[76:79], a[120:123]
    ds_write_b64 v123, v[96:97] offset:0
    v_cvt_pk_bf16_f32 v75, v70, v71
    v_add_f32 v84, v84, v71
    v_mfma_f32_16x16x32_bf16 a[124:127], a[188:191], v[76:79], a[124:127]
    ds_read_b64_tr_b16 a[176:177], v121 offset:128
    ds_write_b64 v123, v[98:99] offset:32
    v_exp_f32 v64, v64
    v_accvgpr_read_b32 v88, a8
    v_accvgpr_read_b32 v89, a9
    v_mfma_f32_16x16x32_bf16 v[68:71], a[144:147], v[208:211], v[108:111]
    ds_read_b64_tr_b16 a[178:179], v121 offset:640
    v_add_f32 v85, v85, v64
    v_accvgpr_read_b32 v90, a10
    v_accvgpr_read_b32 v91, a11
    v_accvgpr_read_b32 v92, a12
    v_mfma_f32_16x16x32_bf16 v[68:71], a[148:151], v[212:215], v[68:71]
    ds_read_b64_tr_b16 a[180:181], v121 offset:160
    v_exp_f32 v65, v65
    v_accvgpr_read_b32 v93, a13
    v_accvgpr_read_b32 v94, a14
    v_accvgpr_read_b32 v95, a15
    v_mfma_f32_16x16x32_bf16 v[68:71], a[152:155], v[216:219], v[68:71]
    v_cvt_pk_bf16_f32 v76, v64, v65
    v_add_f32 v85, v85, v65
    v_mul_f32 v88, v88, v80
    v_mul_f32 v89, v89, v80
    v_mul_f32 v90, v90, v80
    v_mfma_f32_16x16x32_bf16 v[68:71], a[156:159], v[220:223], v[68:71]
    s_waitcnt lgkmcnt(11)
    ds_read_b64_tr_b16 a[182:183], v121 offset:672
    v_exp_f32 v66, v66
    v_mul_f32 v91, v91, v80
    v_mul_f32 v92, v92, v80
    v_mul_f32 v93, v93, v80
    v_mfma_f32_16x16x32_bf16 v[0:3], a[160:163], v[72:75], v[0:3]
    s_waitcnt lgkmcnt(10)
    ds_read_b64_tr_b16 a[184:185], v121 offset:192
    v_add_f32 v85, v85, v66
    v_mul_f32 v94, v94, v80
    v_mul_f32 v95, v95, v80
    v_cvt_pk_bf16_f32 v96, v88, v89
    v_mfma_f32_16x16x32_bf16 v[4:7], a[164:167], v[72:75], v[4:7]
    s_waitcnt lgkmcnt(9)
    ds_read_b64_tr_b16 a[186:187], v121 offset:704
    v_exp_f32 v67, v67
    v_cvt_pk_bf16_f32 v97, v90, v91
    v_cvt_pk_bf16_f32 v98, v92, v93
    v_cvt_pk_bf16_f32 v99, v94, v95
    v_mfma_f32_16x16x32_bf16 v[8:11], a[168:171], v[72:75], v[8:11]
    s_waitcnt lgkmcnt(8)
    ds_write_b64 v123, v[96:97] offset:64
    v_cvt_pk_bf16_f32 v77, v66, v67
    v_add_f32 v85, v85, v67
    v_mfma_f32_16x16x32_bf16 v[12:15], a[172:175], v[72:75], v[12:15]
    ds_read_b64_tr_b16 a[188:189], v121 offset:224
    ds_write_b64 v123, v[98:99] offset:96
    v_exp_f32 v68, v68
    v_accvgpr_read_b32 v88, a16
    v_accvgpr_read_b32 v89, a17
    v_mfma_f32_16x16x32_bf16 v[64:67], a[128:131], v[224:227], v[112:115]
    ds_read_b64_tr_b16 a[190:191], v121 offset:736
    v_add_f32 v85, v85, v68
    v_accvgpr_read_b32 v90, a18
    v_accvgpr_read_b32 v91, a19
    v_accvgpr_read_b32 v92, a20
    v_mfma_f32_16x16x32_bf16 v[64:67], a[132:135], v[228:231], v[64:67]
    v_exp_f32 v69, v69
    v_accvgpr_read_b32 v93, a21
    v_accvgpr_read_b32 v94, a22
    v_accvgpr_read_b32 v95, a23
    v_mfma_f32_16x16x32_bf16 v[64:67], a[136:139], v[232:235], v[64:67]
    v_cvt_pk_bf16_f32 v78, v68, v69
    v_add_f32 v85, v85, v69
    v_mul_f32 v88, v88, v80
    v_mul_f32 v89, v89, v80
    v_mul_f32 v90, v90, v80
    v_mfma_f32_16x16x32_bf16 v[64:67], a[140:143], v[236:239], v[64:67]
    s_waitcnt lgkmcnt(8)
    v_exp_f32 v70, v70
    v_mul_f32 v91, v91, v80
    v_mul_f32 v92, v92, v80
    v_mul_f32 v93, v93, v80
    v_mfma_f32_16x16x32_bf16 v[16:19], a[176:179], v[72:75], v[16:19]
    s_waitcnt lgkmcnt(6)
    v_add_f32 v85, v85, v70
    v_mul_f32 v94, v94, v80
    v_mul_f32 v95, v95, v80
    v_cvt_pk_bf16_f32 v96, v88, v89
    v_mfma_f32_16x16x32_bf16 v[20:23], a[180:183], v[72:75], v[20:23]
    s_waitcnt lgkmcnt(4)
    v_exp_f32 v71, v71
    v_cvt_pk_bf16_f32 v97, v90, v91
    v_cvt_pk_bf16_f32 v98, v92, v93
    v_cvt_pk_bf16_f32 v99, v94, v95
    v_mfma_f32_16x16x32_bf16 v[24:27], a[184:187], v[72:75], v[24:27]
    s_waitcnt lgkmcnt(0)
    ds_write_b64 v123, v[96:97] offset:128
    v_cvt_pk_bf16_f32 v79, v70, v71
    v_add_f32 v85, v85, v71
    v_mfma_f32_16x16x32_bf16 v[28:31], a[188:191], v[72:75], v[28:31]
    ds_write_b64 v123, v[98:99] offset:160
    v_exp_f32 v64, v64
    v_accvgpr_read_b32 v88, a24
    v_accvgpr_read_b32 v89, a25
    v_mfma_f32_16x16x32_bf16 v[68:71], a[144:147], v[224:227], v[112:115]
    v_add_f32 v86, v86, v64
    v_accvgpr_read_b32 v90, a26
    v_accvgpr_read_b32 v91, a27
    v_accvgpr_read_b32 v92, a28
    v_mfma_f32_16x16x32_bf16 v[68:71], a[148:151], v[228:231], v[68:71]
    v_exp_f32 v65, v65
    v_accvgpr_read_b32 v93, a29
    v_accvgpr_read_b32 v94, a30
    v_accvgpr_read_b32 v95, a31
    v_mfma_f32_16x16x32_bf16 v[68:71], a[152:155], v[232:235], v[68:71]
    v_cvt_pk_bf16_f32 v72, v64, v65
    v_add_f32 v86, v86, v65
    v_mul_f32 v88, v88, v80
    v_mul_f32 v89, v89, v80
    v_mul_f32 v90, v90, v80
    v_mfma_f32_16x16x32_bf16 v[68:71], a[156:159], v[236:239], v[68:71]
    v_exp_f32 v66, v66
    v_mul_f32 v91, v91, v80
    v_mul_f32 v92, v92, v80
    v_mul_f32 v93, v93, v80
    v_mfma_f32_16x16x32_bf16 v[32:35], a[160:163], v[76:79], v[32:35]
    v_add_f32 v86, v86, v66
    v_mul_f32 v94, v94, v80
    v_mul_f32 v95, v95, v80
    v_cvt_pk_bf16_f32 v96, v88, v89
    v_mfma_f32_16x16x32_bf16 v[36:39], a[164:167], v[76:79], v[36:39]
    v_exp_f32 v67, v67
    v_cvt_pk_bf16_f32 v97, v90, v91
    v_cvt_pk_bf16_f32 v98, v92, v93
    v_cvt_pk_bf16_f32 v99, v94, v95
    v_mfma_f32_16x16x32_bf16 v[40:43], a[168:171], v[76:79], v[40:43]
    ds_write_b64 v123, v[96:97] offset:192
    v_cvt_pk_bf16_f32 v73, v66, v67
    v_add_f32 v86, v86, v67
    v_mfma_f32_16x16x32_bf16 v[44:47], a[172:175], v[76:79], v[44:47]
    ds_write_b64 v123, v[98:99] offset:224
    v_exp_f32 v68, v68
    v_mfma_f32_16x16x32_bf16 v[64:67], a[128:131], v[240:243], v[116:119]
    ds_read_b128 a[128:131], v120 offset:8448
    ds_read_b128 v[100:103], v124 offset:0
    v_add_f32 v86, v86, v68
    v_accvgpr_read_b32 v88, a32
    v_accvgpr_read_b32 v89, a33
    v_mfma_f32_16x16x32_bf16 v[64:67], a[132:135], v[244:247], v[64:67]
    v_exp_f32 v69, v69
    v_accvgpr_read_b32 v90, a34
    v_accvgpr_read_b32 v91, a35
    v_accvgpr_read_b32 v92, a36
    v_mfma_f32_16x16x32_bf16 v[64:67], a[136:139], v[248:251], v[64:67]
    v_cvt_pk_bf16_f32 v74, v68, v69
    v_add_f32 v86, v86, v69
    v_accvgpr_read_b32 v93, a37
    v_accvgpr_read_b32 v94, a38
    v_accvgpr_read_b32 v95, a39
    v_mfma_f32_16x16x32_bf16 v[64:67], a[140:143], v[252:255], v[64:67]
    v_exp_f32 v70, v70
    v_mul_f32 v88, v88, v81
    v_mul_f32 v89, v89, v81
    v_mul_f32 v90, v90, v81
    v_mfma_f32_16x16x32_bf16 v[48:51], a[176:179], v[76:79], v[48:51]
    ds_read_b128 a[132:135], v120 offset:8512
    v_add_f32 v86, v86, v70
    v_mul_f32 v91, v91, v81
    v_mul_f32 v92, v92, v81
    v_mul_f32 v93, v93, v81
    v_mfma_f32_16x16x32_bf16 v[52:55], a[180:183], v[76:79], v[52:55]
    ds_read_b128 a[136:139], v120 offset:8576
    v_exp_f32 v71, v71
    v_mul_f32 v94, v94, v81
    v_mul_f32 v95, v95, v81
    v_cvt_pk_bf16_f32 v96, v88, v89
    v_mfma_f32_16x16x32_bf16 v[56:59], a[184:187], v[76:79], v[56:59]
    v_cvt_pk_bf16_f32 v75, v70, v71
    v_add_f32 v86, v86, v71
    v_cvt_pk_bf16_f32 v97, v90, v91
    v_cvt_pk_bf16_f32 v98, v92, v93
    v_cvt_pk_bf16_f32 v99, v94, v95
    v_mfma_f32_16x16x32_bf16 v[60:63], a[188:191], v[76:79], v[60:63]
    ds_write_b64 v123, v[96:97] offset:4352
    v_exp_f32 v64, v64
    v_mfma_f32_16x16x32_bf16 v[68:71], a[144:147], v[240:243], v[116:119]
    ds_read_b128 a[140:143], v120 offset:8640
    ds_write_b64 v123, v[98:99] offset:4384
    v_add_f32 v87, v87, v64
    v_mfma_f32_16x16x32_bf16 v[68:71], a[148:151], v[244:247], v[68:71]
    s_waitcnt lgkmcnt(5)
    buffer_store_dwordx4 v[100:103], v122, s[24:27], s39 offen offset:0 sc1 nt
    v_exp_f32 v65, v65
    v_mfma_f32_16x16x32_bf16 v[68:71], a[152:155], v[248:251], v[68:71]
    ds_read_b128 v[100:103], v124 offset:1088
    v_cvt_pk_bf16_f32 v76, v64, v65
    v_add_f32 v87, v87, v65
    v_accvgpr_read_b32 v88, a40
    v_accvgpr_read_b32 v89, a41
    v_mfma_f32_16x16x32_bf16 v[68:71], a[156:159], v[252:255], v[68:71]
    v_exp_f32 v66, v66
    v_accvgpr_read_b32 v90, a42
    v_accvgpr_read_b32 v91, a43
    v_accvgpr_read_b32 v92, a44
    v_mfma_f32_16x16x32_bf16 a[192:195], a[160:163], v[72:75], a[192:195]
    ds_read_b128 a[144:147], v120 offset:8960
    v_add_f32 v87, v87, v66
    v_accvgpr_read_b32 v93, a45
    v_accvgpr_read_b32 v94, a46
    v_accvgpr_read_b32 v95, a47
    v_mfma_f32_16x16x32_bf16 a[196:199], a[164:167], v[72:75], a[196:199]
    ds_read_b128 a[148:151], v120 offset:9024
    v_exp_f32 v67, v67
    v_mul_f32 v88, v88, v81
    v_mul_f32 v89, v89, v81
    v_mul_f32 v90, v90, v81
    v_mfma_f32_16x16x32_bf16 a[200:203], a[168:171], v[72:75], a[200:203]
    v_cvt_pk_bf16_f32 v77, v66, v67
    v_add_f32 v87, v87, v67
    v_mul_f32 v91, v91, v81
    v_mul_f32 v92, v92, v81
    v_mul_f32 v93, v93, v81
    v_mfma_f32_16x16x32_bf16 a[204:207], a[172:175], v[72:75], a[204:207]
    s_waitcnt lgkmcnt(9)
    v_exp_f32 v68, v68
    v_mul_f32 v94, v94, v81
    v_mul_f32 v95, v95, v81
    v_cvt_pk_bf16_f32 v96, v88, v89
    v_mfma_f32_16x16x32_bf16 v[64:67], a[128:131], v[192:195], v[104:107]
    s_waitcnt lgkmcnt(7)
    ds_read_b128 a[152:155], v120 offset:9088
    v_add_f32 v87, v87, v68
    v_cvt_pk_bf16_f32 v97, v90, v91
    v_cvt_pk_bf16_f32 v98, v92, v93
    v_cvt_pk_bf16_f32 v99, v94, v95
    v_mfma_f32_16x16x32_bf16 v[64:67], a[132:135], v[196:199], v[64:67]
    s_waitcnt lgkmcnt(7)
    ds_write_b64 v123, v[96:97] offset:4416
    v_exp_f32 v69, v69
    v_mfma_f32_16x16x32_bf16 v[64:67], a[136:139], v[200:203], v[64:67]
    s_waitcnt lgkmcnt(6)
    ds_write_b64 v123, v[98:99] offset:4448
    v_cvt_pk_bf16_f32 v78, v68, v69
    v_add_f32 v87, v87, v69
    v_mfma_f32_16x16x32_bf16 v[64:67], a[140:143], v[204:207], v[64:67]
    s_waitcnt lgkmcnt(5)
    buffer_store_dwordx4 v[100:103], v122, s[24:27], s39 offen offset:1024 sc1 nt
    v_exp_f32 v70, v70
    v_mfma_f32_16x16x32_bf16 a[208:211], a[176:179], v[72:75], a[208:211]
    ds_read_b128 a[156:159], v120 offset:9152
    ds_read_b128 v[100:103], v124 offset:2176
    v_add_f32 v87, v87, v70
    v_accvgpr_read_b32 v88, a48
    v_accvgpr_read_b32 v89, a49
    v_mfma_f32_16x16x32_bf16 a[212:215], a[180:183], v[72:75], a[212:215]
    v_exp_f32 v71, v71
    v_accvgpr_read_b32 v90, a50
    v_accvgpr_read_b32 v91, a51
    v_accvgpr_read_b32 v92, a52
    v_mfma_f32_16x16x32_bf16 a[216:219], a[184:187], v[72:75], a[216:219]
    v_cvt_pk_bf16_f32 v79, v70, v71
    v_add_f32 v87, v87, v71
    v_accvgpr_read_b32 v93, a53
    v_accvgpr_read_b32 v94, a54
    v_accvgpr_read_b32 v95, a55
    v_mfma_f32_16x16x32_bf16 a[220:223], a[188:191], v[72:75], a[220:223]
    s_waitcnt lgkmcnt(6)
    v_exp_f32 v64, v64
    v_mul_f32 v88, v88, v81
    v_mul_f32 v89, v89, v81
    v_mul_f32 v90, v90, v81
    v_mfma_f32_16x16x32_bf16 v[68:71], a[144:147], v[192:195], v[104:107]
    s_waitcnt lgkmcnt(5)
    v_add_f32 v84, v84, v64
    v_mul_f32 v91, v91, v81
    v_mul_f32 v92, v92, v81
    v_mul_f32 v93, v93, v81
    v_mfma_f32_16x16x32_bf16 v[68:71], a[148:151], v[196:199], v[68:71]
    s_waitcnt lgkmcnt(4)
    v_exp_f32 v65, v65
    v_mul_f32 v94, v94, v81
    v_mul_f32 v95, v95, v81
    v_cvt_pk_bf16_f32 v96, v88, v89
    v_mfma_f32_16x16x32_bf16 v[68:71], a[152:155], v[200:203], v[68:71]
    s_waitcnt lgkmcnt(1)
    v_cvt_pk_bf16_f32 v72, v64, v65
    v_add_f32 v84, v84, v65
    v_cvt_pk_bf16_f32 v97, v90, v91
    v_cvt_pk_bf16_f32 v98, v92, v93
    v_cvt_pk_bf16_f32 v99, v94, v95
    v_mfma_f32_16x16x32_bf16 v[68:71], a[156:159], v[204:207], v[68:71]
    ds_write_b64 v123, v[96:97] offset:4480
    v_exp_f32 v66, v66
    v_mfma_f32_16x16x32_bf16 a[224:227], a[160:163], v[76:79], a[224:227]
    ds_read_b64_tr_b16 a[160:161], v121 offset:8448
    ds_write_b64 v123, v[98:99] offset:4512
    v_add_f32 v84, v84, v66
    v_mfma_f32_16x16x32_bf16 a[228:231], a[164:167], v[76:79], a[228:231]
    s_waitcnt lgkmcnt(3)
    ds_read_b64_tr_b16 a[162:163], v121 offset:8960
    buffer_store_dwordx4 v[100:103], v122, s[24:27], s39 offen offset:2048 sc1 nt
    v_exp_f32 v67, v67
    v_mfma_f32_16x16x32_bf16 a[232:235], a[168:171], v[76:79], a[232:235]
    ds_read_b128 v[100:103], v124 offset:3264
    v_cvt_pk_bf16_f32 v73, v66, v67
    v_add_f32 v84, v84, v67
    v_accvgpr_read_b32 v88, a56
    v_accvgpr_read_b32 v89, a57
    v_mfma_f32_16x16x32_bf16 a[236:239], a[172:175], v[76:79], a[236:239]
    ds_read_b64_tr_b16 a[164:165], v121 offset:8480
    v_exp_f32 v68, v68
    v_accvgpr_read_b32 v90, a58
    v_accvgpr_read_b32 v91, a59
    v_accvgpr_read_b32 v92, a60
    v_mfma_f32_16x16x32_bf16 v[64:67], a[128:131], v[208:211], v[108:111]
    ds_read_b64_tr_b16 a[166:167], v121 offset:8992
    v_add_f32 v84, v84, v68
    v_accvgpr_read_b32 v93, a61
    v_accvgpr_read_b32 v94, a62
    v_accvgpr_read_b32 v95, a63
    v_mfma_f32_16x16x32_bf16 v[64:67], a[132:135], v[212:215], v[64:67]
    ds_read_b64_tr_b16 a[168:169], v121 offset:8512
    v_exp_f32 v69, v69
    v_mul_f32 v88, v88, v81
    v_mul_f32 v89, v89, v81
    v_mul_f32 v90, v90, v81
    v_mfma_f32_16x16x32_bf16 v[64:67], a[136:139], v[216:219], v[64:67]
    v_cvt_pk_bf16_f32 v74, v68, v69
    v_add_f32 v84, v84, v69
    v_mul_f32 v91, v91, v81
    v_mul_f32 v92, v92, v81
    v_mul_f32 v93, v93, v81
    v_mfma_f32_16x16x32_bf16 v[64:67], a[140:143], v[220:223], v[64:67]
    ds_read_b64_tr_b16 a[170:171], v121 offset:9024
    v_exp_f32 v70, v70
    v_mul_f32 v94, v94, v81
    v_mul_f32 v95, v95, v81
    v_cvt_pk_bf16_f32 v96, v88, v89
    v_mfma_f32_16x16x32_bf16 a[240:243], a[176:179], v[76:79], a[240:243]
    ds_read_b64_tr_b16 a[172:173], v121 offset:8544
    v_add_f32 v84, v84, v70
    v_cvt_pk_bf16_f32 v97, v90, v91
    v_cvt_pk_bf16_f32 v98, v92, v93
    v_cvt_pk_bf16_f32 v99, v94, v95
    v_mfma_f32_16x16x32_bf16 a[244:247], a[180:183], v[76:79], a[244:247]
    ds_read_b64_tr_b16 a[174:175], v121 offset:9056
    ds_write_b64 v123, v[96:97] offset:4544
    v_exp_f32 v71, v71
    v_mfma_f32_16x16x32_bf16 a[248:251], a[184:187], v[76:79], a[248:251]
    ds_write_b64 v123, v[98:99] offset:4576
    v_cvt_pk_bf16_f32 v75, v70, v71
    v_add_f32 v84, v84, v71
    v_mfma_f32_16x16x32_bf16 a[252:255], a[188:191], v[76:79], a[252:255]
    s_waitcnt lgkmcnt(8)
    ds_read_b64_tr_b16 a[176:177], v121 offset:8576
    buffer_store_dwordx4 v[100:103], v122, s[24:27], s39 offen offset:3072 sc1 nt
    v_exp_f32 v64, v64
    v_mfma_f32_16x16x32_bf16 v[68:71], a[144:147], v[208:211], v[108:111]
    s_add_u32 s39, s39, 4096
    ds_read_b64_tr_b16 a[178:179], v121 offset:9088
    ds_read_b128 v[100:103], v124 offset:4352
    v_add_f32 v85, v85, v64
    v_accvgpr_read_b32 v88, a64
    v_accvgpr_read_b32 v89, a65
    v_mfma_f32_16x16x32_bf16 v[68:71], a[148:151], v[212:215], v[68:71]
    ds_read_b64_tr_b16 a[180:181], v121 offset:8608
    v_exp_f32 v65, v65
    v_accvgpr_read_b32 v90, a66
    v_accvgpr_read_b32 v91, a67
    v_accvgpr_read_b32 v92, a68
    v_mfma_f32_16x16x32_bf16 v[68:71], a[152:155], v[216:219], v[68:71]
    v_cvt_pk_bf16_f32 v76, v64, v65
    v_add_f32 v85, v85, v65
    v_accvgpr_read_b32 v93, a69
    v_accvgpr_read_b32 v94, a70
    v_accvgpr_read_b32 v95, a71
    v_mfma_f32_16x16x32_bf16 v[68:71], a[156:159], v[220:223], v[68:71]
    s_waitcnt lgkmcnt(13)
    ds_read_b64_tr_b16 a[182:183], v121 offset:9120
    v_exp_f32 v66, v66
    v_mul_f32 v88, v88, v82
    v_mul_f32 v89, v89, v82
    v_mul_f32 v90, v90, v82
    v_mfma_f32_16x16x32_bf16 v[0:3], a[160:163], v[72:75], v[0:3]
    s_waitcnt lgkmcnt(11)
    ds_read_b64_tr_b16 a[184:185], v121 offset:8640
    v_add_f32 v85, v85, v66
    v_mul_f32 v91, v91, v82
    v_mul_f32 v92, v92, v82
    v_mul_f32 v93, v93, v82
    v_mfma_f32_16x16x32_bf16 v[4:7], a[164:167], v[72:75], v[4:7]
    s_waitcnt lgkmcnt(10)
    ds_read_b64_tr_b16 a[186:187], v121 offset:9152
    v_exp_f32 v67, v67
    v_mul_f32 v94, v94, v82
    v_mul_f32 v95, v95, v82
    v_cvt_pk_bf16_f32 v96, v88, v89
    v_mfma_f32_16x16x32_bf16 v[8:11], a[168:171], v[72:75], v[8:11]
    s_waitcnt lgkmcnt(9)
    v_cvt_pk_bf16_f32 v77, v66, v67
    v_add_f32 v85, v85, v67
    v_cvt_pk_bf16_f32 v97, v90, v91
    v_cvt_pk_bf16_f32 v98, v92, v93
    v_cvt_pk_bf16_f32 v99, v94, v95
    v_mfma_f32_16x16x32_bf16 v[12:15], a[172:175], v[72:75], v[12:15]
    ds_read_b64_tr_b16 a[188:189], v121 offset:8672
    ds_write_b64 v123, v[96:97] offset:0
    v_exp_f32 v68, v68
    v_mfma_f32_16x16x32_bf16 v[64:67], a[128:131], v[224:227], v[112:115]
    ds_read_b64_tr_b16 a[190:191], v121 offset:9184
    ds_write_b64 v123, v[98:99] offset:32
    v_add_f32 v85, v85, v68
    v_mfma_f32_16x16x32_bf16 v[64:67], a[132:135], v[228:231], v[64:67]
    s_waitcnt lgkmcnt(8)
    buffer_store_dwordx4 v[100:103], v122, s[24:27], s39 offen offset:0 sc1 nt
    v_exp_f32 v69, v69
    v_mfma_f32_16x16x32_bf16 v[64:67], a[136:139], v[232:235], v[64:67]
    ds_read_b128 v[100:103], v124 offset:5440
    v_cvt_pk_bf16_f32 v78, v68, v69
    v_add_f32 v85, v85, v69
    v_accvgpr_read_b32 v88, a72
    v_accvgpr_read_b32 v89, a73
    v_mfma_f32_16x16x32_bf16 v[64:67], a[140:143], v[236:239], v[64:67]
    s_waitcnt lgkmcnt(10)
    v_exp_f32 v70, v70
    v_accvgpr_read_b32 v90, a74
    v_accvgpr_read_b32 v91, a75
    v_accvgpr_read_b32 v92, a76
    v_mfma_f32_16x16x32_bf16 v[16:19], a[176:179], v[72:75], v[16:19]
    s_waitcnt lgkmcnt(7)
    v_add_f32 v85, v85, v70
    v_accvgpr_read_b32 v93, a77
    v_accvgpr_read_b32 v94, a78
    v_accvgpr_read_b32 v95, a79
    v_mfma_f32_16x16x32_bf16 v[20:23], a[180:183], v[72:75], v[20:23]
    s_waitcnt lgkmcnt(5)
    v_exp_f32 v71, v71
    v_mul_f32 v88, v88, v82
    v_mul_f32 v89, v89, v82
    v_mul_f32 v90, v90, v82
    v_mfma_f32_16x16x32_bf16 v[24:27], a[184:187], v[72:75], v[24:27]
    s_waitcnt lgkmcnt(2)
    v_cvt_pk_bf16_f32 v79, v70, v71
    v_add_f32 v85, v85, v71
    v_mul_f32 v91, v91, v82
    v_mul_f32 v92, v92, v82
    v_mul_f32 v93, v93, v82
    v_mfma_f32_16x16x32_bf16 v[28:31], a[188:191], v[72:75], v[28:31]
    v_exp_f32 v64, v64
    v_mul_f32 v94, v94, v82
    v_mul_f32 v95, v95, v82
    v_cvt_pk_bf16_f32 v96, v88, v89
    v_mfma_f32_16x16x32_bf16 v[68:71], a[144:147], v[224:227], v[112:115]
    v_add_f32 v86, v86, v64
    v_cvt_pk_bf16_f32 v97, v90, v91
    v_cvt_pk_bf16_f32 v98, v92, v93
    v_cvt_pk_bf16_f32 v99, v94, v95
    v_mfma_f32_16x16x32_bf16 v[68:71], a[148:151], v[228:231], v[68:71]
    ds_write_b64 v123, v[96:97] offset:64
    v_exp_f32 v65, v65
    v_mfma_f32_16x16x32_bf16 v[68:71], a[152:155], v[232:235], v[68:71]
    ds_write_b64 v123, v[98:99] offset:96
    v_cvt_pk_bf16_f32 v72, v64, v65
    v_add_f32 v86, v86, v65
    v_mfma_f32_16x16x32_bf16 v[68:71], a[156:159], v[236:239], v[68:71]
    s_waitcnt lgkmcnt(2)
    buffer_store_dwordx4 v[100:103], v122, s[24:27], s39 offen offset:1024 sc1 nt
    v_exp_f32 v66, v66
    v_mfma_f32_16x16x32_bf16 v[32:35], a[160:163], v[76:79], v[32:35]
    ds_read_b128 v[100:103], v124 offset:6528
    v_add_f32 v86, v86, v66
    v_accvgpr_read_b32 v88, a80
    v_accvgpr_read_b32 v89, a81
    v_mfma_f32_16x16x32_bf16 v[36:39], a[164:167], v[76:79], v[36:39]
    v_exp_f32 v67, v67
    v_accvgpr_read_b32 v90, a82
    v_accvgpr_read_b32 v91, a83
    v_accvgpr_read_b32 v92, a84
    v_mfma_f32_16x16x32_bf16 v[40:43], a[168:171], v[76:79], v[40:43]
    v_cvt_pk_bf16_f32 v73, v66, v67
    v_add_f32 v86, v86, v67
    v_accvgpr_read_b32 v93, a85
    v_accvgpr_read_b32 v94, a86
    v_accvgpr_read_b32 v95, a87
    v_mfma_f32_16x16x32_bf16 v[44:47], a[172:175], v[76:79], v[44:47]
    v_exp_f32 v68, v68
    v_mul_f32 v88, v88, v82
    v_mul_f32 v89, v89, v82
    v_mul_f32 v90, v90, v82
    v_mfma_f32_16x16x32_bf16 v[64:67], a[128:131], v[240:243], v[116:119]
    ds_read_b128 a[128:131], v120 offset:16896
    v_add_f32 v86, v86, v68
    v_mul_f32 v91, v91, v82
    v_mul_f32 v92, v92, v82
    v_mul_f32 v93, v93, v82
    v_mfma_f32_16x16x32_bf16 v[64:67], a[132:135], v[244:247], v[64:67]
    v_exp_f32 v69, v69
    v_mul_f32 v94, v94, v82
    v_mul_f32 v95, v95, v82
    v_cvt_pk_bf16_f32 v96, v88, v89
    v_mfma_f32_16x16x32_bf16 v[64:67], a[136:139], v[248:251], v[64:67]
    v_cvt_pk_bf16_f32 v74, v68, v69
    v_add_f32 v86, v86, v69
    v_cvt_pk_bf16_f32 v97, v90, v91
    v_cvt_pk_bf16_f32 v98, v92, v93
    v_cvt_pk_bf16_f32 v99, v94, v95
    v_mfma_f32_16x16x32_bf16 v[64:67], a[140:143], v[252:255], v[64:67]
    ds_write_b64 v123, v[96:97] offset:128
    v_exp_f32 v70, v70
    v_mfma_f32_16x16x32_bf16 v[48:51], a[176:179], v[76:79], v[48:51]
    ds_read_b128 a[132:135], v120 offset:16960
    ds_write_b64 v123, v[98:99] offset:160
    v_add_f32 v86, v86, v70
    v_mfma_f32_16x16x32_bf16 v[52:55], a[180:183], v[76:79], v[52:55]
    s_waitcnt lgkmcnt(4)
    ds_read_b128 a[136:139], v120 offset:17024
    buffer_store_dwordx4 v[100:103], v122, s[24:27], s39 offen offset:2048 sc1 nt
    v_exp_f32 v71, v71
    v_mfma_f32_16x16x32_bf16 v[56:59], a[184:187], v[76:79], v[56:59]
    ds_read_b128 v[100:103], v124 offset:7616
    v_cvt_pk_bf16_f32 v75, v70, v71
    v_add_f32 v86, v86, v71
    v_accvgpr_read_b32 v88, a88
    v_accvgpr_read_b32 v89, a89
    v_mfma_f32_16x16x32_bf16 v[60:63], a[188:191], v[76:79], v[60:63]
    v_exp_f32 v64, v64
    v_accvgpr_read_b32 v90, a90
    v_accvgpr_read_b32 v91, a91
    v_accvgpr_read_b32 v92, a92
    v_mfma_f32_16x16x32_bf16 v[68:71], a[144:147], v[240:243], v[116:119]
    ds_read_b128 a[140:143], v120 offset:17088
    v_add_f32 v87, v87, v64
    v_accvgpr_read_b32 v93, a93
    v_accvgpr_read_b32 v94, a94
    v_accvgpr_read_b32 v95, a95
    v_mfma_f32_16x16x32_bf16 v[68:71], a[148:151], v[244:247], v[68:71]
    v_exp_f32 v65, v65
    v_mul_f32 v88, v88, v82
    v_mul_f32 v89, v89, v82
    v_mul_f32 v90, v90, v82
    v_mfma_f32_16x16x32_bf16 v[68:71], a[152:155], v[248:251], v[68:71]
    v_cvt_pk_bf16_f32 v76, v64, v65
    v_add_f32 v87, v87, v65
    v_mul_f32 v91, v91, v82
    v_mul_f32 v92, v92, v82
    v_mul_f32 v93, v93, v82
    v_mfma_f32_16x16x32_bf16 v[68:71], a[156:159], v[252:255], v[68:71]
    v_exp_f32 v66, v66
    v_mul_f32 v94, v94, v82
    v_mul_f32 v95, v95, v82
    v_cvt_pk_bf16_f32 v96, v88, v89
    v_mfma_f32_16x16x32_bf16 a[192:195], a[160:163], v[72:75], a[192:195]
    ds_read_b128 a[144:147], v120 offset:17408
    v_add_f32 v87, v87, v66
    v_cvt_pk_bf16_f32 v97, v90, v91
    v_cvt_pk_bf16_f32 v98, v92, v93
    v_cvt_pk_bf16_f32 v99, v94, v95
    v_mfma_f32_16x16x32_bf16 a[196:199], a[164:167], v[72:75], a[196:199]
    ds_read_b128 a[148:151], v120 offset:17472
    ds_write_b64 v123, v[96:97] offset:192
    v_exp_f32 v67, v67
    v_mfma_f32_16x16x32_bf16 a[200:203], a[168:171], v[72:75], a[200:203]
    ds_write_b64 v123, v[98:99] offset:224
    v_cvt_pk_bf16_f32 v77, v66, v67
    v_add_f32 v87, v87, v67
    v_mfma_f32_16x16x32_bf16 a[204:207], a[172:175], v[72:75], a[204:207]
    s_waitcnt lgkmcnt(15)
    s_waitcnt lgkmcnt(5)
    buffer_store_dwordx4 v[100:103], v122, s[24:27], s39 offen offset:3072 sc1 nt
    v_exp_f32 v68, v68
    v_mfma_f32_16x16x32_bf16 v[64:67], a[128:131], v[192:195], v[104:107]
    s_waitcnt lgkmcnt(8)
    s_add_u32 s39, s39, 4096
    ds_read_b128 a[152:155], v120 offset:17536
    ds_read_b128 v[100:103], v124 offset:0
    v_add_f32 v87, v87, v68
    v_accvgpr_read_b32 v88, a96
    v_accvgpr_read_b32 v89, a97
    v_mfma_f32_16x16x32_bf16 v[64:67], a[132:135], v[196:199], v[64:67]
    s_waitcnt lgkmcnt(8)
    v_exp_f32 v69, v69
    v_accvgpr_read_b32 v90, a98
    v_accvgpr_read_b32 v91, a99
    v_accvgpr_read_b32 v92, a100
    v_mfma_f32_16x16x32_bf16 v[64:67], a[136:139], v[200:203], v[64:67]
    s_waitcnt lgkmcnt(6)
    v_cvt_pk_bf16_f32 v78, v68, v69
    v_add_f32 v87, v87, v69
    v_accvgpr_read_b32 v93, a101
    v_accvgpr_read_b32 v94, a102
    v_accvgpr_read_b32 v95, a103
    v_mfma_f32_16x16x32_bf16 v[64:67], a[140:143], v[204:207], v[64:67]
    v_exp_f32 v70, v70
    v_mul_f32 v88, v88, v83
    v_mul_f32 v89, v89, v83
    v_mul_f32 v90, v90, v83
    v_mfma_f32_16x16x32_bf16 a[208:211], a[176:179], v[72:75], a[208:211]
    ds_read_b128 a[156:159], v120 offset:17600
    v_add_f32 v87, v87, v70
    v_mul_f32 v91, v91, v83
    v_mul_f32 v92, v92, v83
    v_mul_f32 v93, v93, v83
    v_mfma_f32_16x16x32_bf16 a[212:215], a[180:183], v[72:75], a[212:215]
    v_exp_f32 v71, v71
    v_mul_f32 v94, v94, v83
    v_mul_f32 v95, v95, v83
    v_cvt_pk_bf16_f32 v96, v88, v89
    v_mfma_f32_16x16x32_bf16 a[216:219], a[184:187], v[72:75], a[216:219]
    v_cvt_pk_bf16_f32 v79, v70, v71
    v_add_f32 v87, v87, v71
    v_cvt_pk_bf16_f32 v97, v90, v91
    v_cvt_pk_bf16_f32 v98, v92, v93
    v_cvt_pk_bf16_f32 v99, v94, v95
    v_mfma_f32_16x16x32_bf16 a[220:223], a[188:191], v[72:75], a[220:223]
    s_waitcnt lgkmcnt(6)
    ds_write_b64 v123, v[96:97] offset:4352
    v_exp_f32 v64, v64
    v_mfma_f32_16x16x32_bf16 v[68:71], a[144:147], v[192:195], v[104:107]
    s_waitcnt lgkmcnt(6)
    ds_write_b64 v123, v[98:99] offset:4384
    v_add_f32 v84, v84, v64
    v_mfma_f32_16x16x32_bf16 v[68:71], a[148:151], v[196:199], v[68:71]
    s_waitcnt lgkmcnt(15)
    s_waitcnt lgkmcnt(3)
    buffer_store_dwordx4 v[100:103], v122, s[24:27], s39 offen offset:0 sc1 nt
    v_exp_f32 v65, v65
    v_mfma_f32_16x16x32_bf16 v[68:71], a[152:155], v[200:203], v[68:71]
    s_waitcnt lgkmcnt(2)
    ds_read_b128 v[100:103], v124 offset:1088
    v_cvt_pk_bf16_f32 v72, v64, v65
    v_add_f32 v84, v84, v65
    v_accvgpr_read_b32 v88, a104
    v_accvgpr_read_b32 v89, a105
    v_mfma_f32_16x16x32_bf16 v[68:71], a[156:159], v[204:207], v[68:71]
    v_exp_f32 v66, v66
    v_accvgpr_read_b32 v90, a106
    v_accvgpr_read_b32 v91, a107
    v_accvgpr_read_b32 v92, a108
    v_mfma_f32_16x16x32_bf16 a[224:227], a[160:163], v[76:79], a[224:227]
    ds_read_b64_tr_b16 a[160:161], v121 offset:16896
    v_add_f32 v84, v84, v66
    v_accvgpr_read_b32 v93, a109
    v_accvgpr_read_b32 v94, a110
    v_accvgpr_read_b32 v95, a111
    v_mfma_f32_16x16x32_bf16 a[228:231], a[164:167], v[76:79], a[228:231]
    ds_read_b64_tr_b16 a[162:163], v121 offset:17408
    v_exp_f32 v67, v67
    v_mul_f32 v88, v88, v83
    v_mul_f32 v89, v89, v83
    v_mul_f32 v90, v90, v83
    v_mfma_f32_16x16x32_bf16 a[232:235], a[168:171], v[76:79], a[232:235]
    v_cvt_pk_bf16_f32 v73, v66, v67
    v_add_f32 v84, v84, v67
    v_mul_f32 v91, v91, v83
    v_mul_f32 v92, v92, v83
    v_mul_f32 v93, v93, v83
    v_mfma_f32_16x16x32_bf16 a[236:239], a[172:175], v[76:79], a[236:239]
    ds_read_b64_tr_b16 a[164:165], v121 offset:16928
    v_exp_f32 v68, v68
    v_mul_f32 v94, v94, v83
    v_mul_f32 v95, v95, v83
    v_cvt_pk_bf16_f32 v96, v88, v89
    v_mfma_f32_16x16x32_bf16 v[64:67], a[128:131], v[208:211], v[108:111]
    ds_read_b64_tr_b16 a[166:167], v121 offset:17440
    v_add_f32 v84, v84, v68
    v_cvt_pk_bf16_f32 v97, v90, v91
    v_cvt_pk_bf16_f32 v98, v92, v93
    v_cvt_pk_bf16_f32 v99, v94, v95
    v_mfma_f32_16x16x32_bf16 v[64:67], a[132:135], v[212:215], v[64:67]
    ds_read_b64_tr_b16 a[168:169], v121 offset:16960
    ds_write_b64 v123, v[96:97] offset:4416
    v_exp_f32 v69, v69
    v_mfma_f32_16x16x32_bf16 v[64:67], a[136:139], v[216:219], v[64:67]
    ds_write_b64 v123, v[98:99] offset:4448
    v_cvt_pk_bf16_f32 v74, v68, v69
    v_add_f32 v84, v84, v69
    v_mfma_f32_16x16x32_bf16 v[64:67], a[140:143], v[220:223], v[64:67]
    s_waitcnt lgkmcnt(7)
    ds_read_b64_tr_b16 a[170:171], v121 offset:17472
    buffer_store_dwordx4 v[100:103], v122, s[24:27], s39 offen offset:1024 sc1 nt
    v_exp_f32 v70, v70
    v_mfma_f32_16x16x32_bf16 a[240:243], a[176:179], v[76:79], a[240:243]
    ds_read_b64_tr_b16 a[172:173], v121 offset:16992
    ds_read_b128 v[100:103], v124 offset:2176
    v_add_f32 v84, v84, v70
    v_accvgpr_read_b32 v88, a112
    v_accvgpr_read_b32 v89, a113
    v_mfma_f32_16x16x32_bf16 a[244:247], a[180:183], v[76:79], a[244:247]
    ds_read_b64_tr_b16 a[174:175], v121 offset:17504
    v_exp_f32 v71, v71
    v_accvgpr_read_b32 v90, a114
    v_accvgpr_read_b32 v91, a115
    v_accvgpr_read_b32 v92, a116
    v_mfma_f32_16x16x32_bf16 a[248:251], a[184:187], v[76:79], a[248:251]
    v_cvt_pk_bf16_f32 v75, v70, v71
    v_add_f32 v84, v84, v71
    v_accvgpr_read_b32 v93, a117
    v_accvgpr_read_b32 v94, a118
    v_accvgpr_read_b32 v95, a119
    v_mfma_f32_16x16x32_bf16 a[252:255], a[188:191], v[76:79], a[252:255]
    ds_read_b64_tr_b16 a[176:177], v121 offset:17024
    v_exp_f32 v64, v64
    v_mul_f32 v88, v88, v83
    v_mul_f32 v89, v89, v83
    v_mul_f32 v90, v90, v83
    v_mfma_f32_16x16x32_bf16 v[68:71], a[144:147], v[208:211], v[108:111]
    ds_read_b64_tr_b16 a[178:179], v121 offset:17536
    v_add_f32 v85, v85, v64
    v_mul_f32 v91, v91, v83
    v_mul_f32 v92, v92, v83
    v_mul_f32 v93, v93, v83
    v_mfma_f32_16x16x32_bf16 v[68:71], a[148:151], v[212:215], v[68:71]
    ds_read_b64_tr_b16 a[180:181], v121 offset:17056
    v_exp_f32 v65, v65
    v_mul_f32 v94, v94, v83
    v_mul_f32 v95, v95, v83
    v_cvt_pk_bf16_f32 v96, v88, v89
    v_mfma_f32_16x16x32_bf16 v[68:71], a[152:155], v[216:219], v[68:71]
    v_cvt_pk_bf16_f32 v76, v64, v65
    v_add_f32 v85, v85, v65
    v_cvt_pk_bf16_f32 v97, v90, v91
    v_cvt_pk_bf16_f32 v98, v92, v93
    v_cvt_pk_bf16_f32 v99, v94, v95
    v_mfma_f32_16x16x32_bf16 v[68:71], a[156:159], v[220:223], v[68:71]
    s_waitcnt lgkmcnt(12)
    ds_read_b64_tr_b16 a[182:183], v121 offset:17568
    ds_write_b64 v123, v[96:97] offset:4480
    v_exp_f32 v66, v66
    v_mfma_f32_16x16x32_bf16 v[0:3], a[160:163], v[72:75], v[0:3]
    s_waitcnt lgkmcnt(12)
    ds_read_b64_tr_b16 a[184:185], v121 offset:17088
    ds_write_b64 v123, v[98:99] offset:4512
    v_add_f32 v85, v85, v66
    v_mfma_f32_16x16x32_bf16 v[4:7], a[164:167], v[72:75], v[4:7]
    s_waitcnt lgkmcnt(15)
    s_waitcnt lgkmcnt(8)
    ds_read_b64_tr_b16 a[186:187], v121 offset:17600
    buffer_store_dwordx4 v[100:103], v122, s[24:27], s39 offen offset:2048 sc1 nt
    v_exp_f32 v67, v67
    v_mfma_f32_16x16x32_bf16 v[8:11], a[168:171], v[72:75], v[8:11]
    s_waitcnt lgkmcnt(8)
    ds_read_b128 v[100:103], v124 offset:3264
    v_cvt_pk_bf16_f32 v77, v66, v67
    v_add_f32 v85, v85, v67
    v_accvgpr_read_b32 v88, a120
    v_accvgpr_read_b32 v89, a121
    v_mfma_f32_16x16x32_bf16 v[12:15], a[172:175], v[72:75], v[12:15]
    ds_read_b64_tr_b16 a[188:189], v121 offset:17120
    v_exp_f32 v68, v68
    v_accvgpr_read_b32 v90, a122
    v_accvgpr_read_b32 v91, a123
    v_accvgpr_read_b32 v92, a124
    v_mfma_f32_16x16x32_bf16 v[64:67], a[128:131], v[224:227], v[112:115]
    ds_read_b64_tr_b16 a[190:191], v121 offset:17632
    v_add_f32 v85, v85, v68
    v_accvgpr_read_b32 v93, a125
    v_accvgpr_read_b32 v94, a126
    v_accvgpr_read_b32 v95, a127
    v_mfma_f32_16x16x32_bf16 v[64:67], a[132:135], v[228:231], v[64:67]
    v_exp_f32 v69, v69
    v_mul_f32 v88, v88, v83
    v_mul_f32 v89, v89, v83
    v_mul_f32 v90, v90, v83
    v_mfma_f32_16x16x32_bf16 v[64:67], a[136:139], v[232:235], v[64:67]
    v_cvt_pk_bf16_f32 v78, v68, v69
    v_add_f32 v85, v85, v69
    v_mul_f32 v91, v91, v83
    v_mul_f32 v92, v92, v83
    v_mul_f32 v93, v93, v83
    v_mfma_f32_16x16x32_bf16 v[64:67], a[140:143], v[236:239], v[64:67]
    s_waitcnt lgkmcnt(9)
    v_exp_f32 v70, v70
    v_mul_f32 v94, v94, v83
    v_mul_f32 v95, v95, v83
    v_cvt_pk_bf16_f32 v96, v88, v89
    v_mfma_f32_16x16x32_bf16 v[16:19], a[176:179], v[72:75], v[16:19]
    s_waitcnt lgkmcnt(7)
    v_add_f32 v85, v85, v70
    v_cvt_pk_bf16_f32 v97, v90, v91
    v_cvt_pk_bf16_f32 v98, v92, v93
    v_cvt_pk_bf16_f32 v99, v94, v95
    v_mfma_f32_16x16x32_bf16 v[20:23], a[180:183], v[72:75], v[20:23]
    s_waitcnt lgkmcnt(3)
    ds_write_b64 v123, v[96:97] offset:4544
    v_exp_f32 v71, v71
    v_mfma_f32_16x16x32_bf16 v[24:27], a[184:187], v[72:75], v[24:27]
    s_waitcnt lgkmcnt(1)
    ds_write_b64 v123, v[98:99] offset:4576
    v_cvt_pk_bf16_f32 v79, v70, v71
    v_add_f32 v85, v85, v71
    v_mfma_f32_16x16x32_bf16 v[28:31], a[188:191], v[72:75], v[28:31]
    s_waitcnt lgkmcnt(4)
    buffer_store_dwordx4 v[100:103], v122, s[24:27], s39 offen offset:3072 sc1 nt
    v_exp_f32 v64, v64
    v_mfma_f32_16x16x32_bf16 v[68:71], a[144:147], v[224:227], v[112:115]
    s_add_u32 s39, s39, 4096
    ds_read_b128 v[100:103], v124 offset:4352
    v_add_f32 v86, v86, v64
    v_mfma_f32_16x16x32_bf16 v[68:71], a[148:151], v[228:231], v[68:71]
    v_exp_f32 v65, v65
    v_mfma_f32_16x16x32_bf16 v[68:71], a[152:155], v[232:235], v[68:71]
    v_cvt_pk_bf16_f32 v72, v64, v65
    v_add_f32 v86, v86, v65
    v_mfma_f32_16x16x32_bf16 v[68:71], a[156:159], v[236:239], v[68:71]
    v_exp_f32 v66, v66
    v_mfma_f32_16x16x32_bf16 v[32:35], a[160:163], v[76:79], v[32:35]
    v_add_f32 v86, v86, v66
    v_mfma_f32_16x16x32_bf16 v[36:39], a[164:167], v[76:79], v[36:39]
    s_waitcnt lgkmcnt(0)
    buffer_store_dwordx4 v[100:103], v122, s[24:27], s39 offen offset:0 sc1 nt
    v_exp_f32 v67, v67
    v_mfma_f32_16x16x32_bf16 v[40:43], a[168:171], v[76:79], v[40:43]
    v_cvt_pk_bf16_f32 v73, v66, v67
    v_add_f32 v86, v86, v67
    v_mfma_f32_16x16x32_bf16 v[44:47], a[172:175], v[76:79], v[44:47]
    v_exp_f32 v68, v68
    v_mfma_f32_16x16x32_bf16 v[64:67], a[128:131], v[240:243], v[116:119]
    ds_read_b128 a[128:131], v120 offset:25344
    v_add_f32 v86, v86, v68
    v_mfma_f32_16x16x32_bf16 v[64:67], a[132:135], v[244:247], v[64:67]
    v_exp_f32 v69, v69
    v_mfma_f32_16x16x32_bf16 v[64:67], a[136:139], v[248:251], v[64:67]
    v_cvt_pk_bf16_f32 v74, v68, v69
    v_add_f32 v86, v86, v69
    v_mfma_f32_16x16x32_bf16 v[64:67], a[140:143], v[252:255], v[64:67]
    v_exp_f32 v70, v70
    v_mfma_f32_16x16x32_bf16 v[48:51], a[176:179], v[76:79], v[48:51]
    ds_read_b128 a[132:135], v120 offset:25408
    v_add_f32 v86, v86, v70
    v_mfma_f32_16x16x32_bf16 v[52:55], a[180:183], v[76:79], v[52:55]
    ds_read_b128 a[136:139], v120 offset:25472
    v_exp_f32 v71, v71
    v_mfma_f32_16x16x32_bf16 v[56:59], a[184:187], v[76:79], v[56:59]
    ds_read_b128 v[100:103], v124 offset:5440
    v_cvt_pk_bf16_f32 v75, v70, v71
    v_add_f32 v86, v86, v71
    v_mfma_f32_16x16x32_bf16 v[60:63], a[188:191], v[76:79], v[60:63]
    v_exp_f32 v64, v64
    v_mfma_f32_16x16x32_bf16 v[68:71], a[144:147], v[240:243], v[116:119]
    ds_read_b128 a[140:143], v120 offset:25536
    v_add_f32 v87, v87, v64
    v_mfma_f32_16x16x32_bf16 v[68:71], a[148:151], v[244:247], v[68:71]
    v_exp_f32 v65, v65
    v_mfma_f32_16x16x32_bf16 v[68:71], a[152:155], v[248:251], v[68:71]
    v_cvt_pk_bf16_f32 v76, v64, v65
    v_add_f32 v87, v87, v65
    v_mfma_f32_16x16x32_bf16 v[68:71], a[156:159], v[252:255], v[68:71]
    s_waitcnt lgkmcnt(1)
    buffer_store_dwordx4 v[100:103], v122, s[24:27], s39 offen offset:1024 sc1 nt
    v_exp_f32 v66, v66
    v_mfma_f32_16x16x32_bf16 a[192:195], a[160:163], v[72:75], a[192:195]
    ds_read_b128 a[144:147], v120 offset:25856
    v_add_f32 v87, v87, v66
    v_mfma_f32_16x16x32_bf16 a[196:199], a[164:167], v[72:75], a[196:199]
    ds_read_b128 a[148:151], v120 offset:25920
    v_exp_f32 v67, v67
    v_mfma_f32_16x16x32_bf16 a[200:203], a[168:171], v[72:75], a[200:203]
    v_cvt_pk_bf16_f32 v77, v66, v67
    v_add_f32 v87, v87, v67
    v_mfma_f32_16x16x32_bf16 a[204:207], a[172:175], v[72:75], a[204:207]
    s_waitcnt lgkmcnt(6)
    v_exp_f32 v68, v68
    v_mfma_f32_16x16x32_bf16 v[64:67], a[128:131], v[192:195], v[104:107]
    s_waitcnt lgkmcnt(5)
    ds_read_b128 a[152:155], v120 offset:25984
    v_add_f32 v87, v87, v68
    v_mfma_f32_16x16x32_bf16 v[64:67], a[132:135], v[196:199], v[64:67]
    s_waitcnt lgkmcnt(5)
    v_exp_f32 v69, v69
    v_mfma_f32_16x16x32_bf16 v[64:67], a[136:139], v[200:203], v[64:67]
    s_waitcnt lgkmcnt(3)
    v_cvt_pk_bf16_f32 v78, v68, v69
    v_add_f32 v87, v87, v69
    v_mfma_f32_16x16x32_bf16 v[64:67], a[140:143], v[204:207], v[64:67]
    v_exp_f32 v70, v70
    v_mfma_f32_16x16x32_bf16 a[208:211], a[176:179], v[72:75], a[208:211]
    ds_read_b128 a[156:159], v120 offset:26048
    ds_read_b128 v[100:103], v124 offset:6528
    v_add_f32 v87, v87, v70
    v_mfma_f32_16x16x32_bf16 a[212:215], a[180:183], v[72:75], a[212:215]
    v_exp_f32 v71, v71
    v_mfma_f32_16x16x32_bf16 a[216:219], a[184:187], v[72:75], a[216:219]
    v_cvt_pk_bf16_f32 v79, v70, v71
    v_add_f32 v87, v87, v71
    v_mfma_f32_16x16x32_bf16 a[220:223], a[188:191], v[72:75], a[220:223]
    s_waitcnt lgkmcnt(4)
    v_exp_f32 v64, v64
    v_mfma_f32_16x16x32_bf16 v[68:71], a[144:147], v[192:195], v[104:107]
    s_waitcnt lgkmcnt(3)
    v_add_f32 v84, v84, v64
    v_mfma_f32_16x16x32_bf16 v[68:71], a[148:151], v[196:199], v[68:71]
    s_waitcnt lgkmcnt(15)
    s_waitcnt lgkmcnt(0)
    buffer_store_dwordx4 v[100:103], v122, s[24:27], s39 offen offset:2048 sc1 nt
    v_exp_f32 v65, v65
    v_mfma_f32_16x16x32_bf16 v[68:71], a[152:155], v[200:203], v[68:71]
    s_waitcnt lgkmcnt(1)
    v_cvt_pk_bf16_f32 v72, v64, v65
    v_add_f32 v84, v84, v65
    v_mfma_f32_16x16x32_bf16 v[68:71], a[156:159], v[204:207], v[68:71]
    v_exp_f32 v66, v66
    v_mfma_f32_16x16x32_bf16 a[224:227], a[160:163], v[76:79], a[224:227]
    ds_read_b64_tr_b16 a[160:161], v121 offset:25344
    v_add_f32 v84, v84, v66
    v_mfma_f32_16x16x32_bf16 a[228:231], a[164:167], v[76:79], a[228:231]
    ds_read_b64_tr_b16 a[162:163], v121 offset:25856
    v_exp_f32 v67, v67
    v_mfma_f32_16x16x32_bf16 a[232:235], a[168:171], v[76:79], a[232:235]
    v_cvt_pk_bf16_f32 v73, v66, v67
    v_add_f32 v84, v84, v67
    v_mfma_f32_16x16x32_bf16 a[236:239], a[172:175], v[76:79], a[236:239]
    ds_read_b64_tr_b16 a[164:165], v121 offset:25376
    v_exp_f32 v68, v68
    v_mfma_f32_16x16x32_bf16 v[64:67], a[128:131], v[208:211], v[108:111]
    ds_read_b64_tr_b16 a[166:167], v121 offset:25888
    v_add_f32 v84, v84, v68
    v_mfma_f32_16x16x32_bf16 v[64:67], a[132:135], v[212:215], v[64:67]
    ds_read_b64_tr_b16 a[168:169], v121 offset:25408
    v_exp_f32 v69, v69
    v_mfma_f32_16x16x32_bf16 v[64:67], a[136:139], v[216:219], v[64:67]
    ds_read_b128 v[100:103], v124 offset:7616
    v_cvt_pk_bf16_f32 v74, v68, v69
    v_add_f32 v84, v84, v69
    v_mfma_f32_16x16x32_bf16 v[64:67], a[140:143], v[220:223], v[64:67]
    ds_read_b64_tr_b16 a[170:171], v121 offset:25920
    v_exp_f32 v70, v70
    v_mfma_f32_16x16x32_bf16 a[240:243], a[176:179], v[76:79], a[240:243]
    ds_read_b64_tr_b16 a[172:173], v121 offset:25440
    v_add_f32 v84, v84, v70
    v_mfma_f32_16x16x32_bf16 a[244:247], a[180:183], v[76:79], a[244:247]
    ds_read_b64_tr_b16 a[174:175], v121 offset:25952
    v_exp_f32 v71, v71
    v_mfma_f32_16x16x32_bf16 a[248:251], a[184:187], v[76:79], a[248:251]
    v_cvt_pk_bf16_f32 v75, v70, v71
    v_add_f32 v84, v84, v71
    v_mfma_f32_16x16x32_bf16 a[252:255], a[188:191], v[76:79], a[252:255]
    s_waitcnt lgkmcnt(3)
    ds_read_b64_tr_b16 a[176:177], v121 offset:25472
    buffer_store_dwordx4 v[100:103], v122, s[24:27], s39 offen offset:3072 sc1 nt
    v_exp_f32 v64, v64
    v_mfma_f32_16x16x32_bf16 v[68:71], a[144:147], v[208:211], v[108:111]
    s_add_u32 s39, s39, 4096
    ds_read_b64_tr_b16 a[178:179], v121 offset:25984
    v_add_f32 v85, v85, v64
    v_mfma_f32_16x16x32_bf16 v[68:71], a[148:151], v[212:215], v[68:71]
    ds_read_b64_tr_b16 a[180:181], v121 offset:25504
    v_exp_f32 v65, v65
    v_mfma_f32_16x16x32_bf16 v[68:71], a[152:155], v[216:219], v[68:71]
    v_cvt_pk_bf16_f32 v76, v64, v65
    v_add_f32 v85, v85, v65
    v_mfma_f32_16x16x32_bf16 v[68:71], a[156:159], v[220:223], v[68:71]
    s_waitcnt lgkmcnt(10)
    ds_read_b64_tr_b16 a[182:183], v121 offset:26016
    v_exp_f32 v66, v66
    v_mfma_f32_16x16x32_bf16 v[0:3], a[160:163], v[72:75], v[0:3]
    s_waitcnt lgkmcnt(9)
    ds_read_b64_tr_b16 a[184:185], v121 offset:25536
    v_add_f32 v85, v85, v66
    v_mfma_f32_16x16x32_bf16 v[4:7], a[164:167], v[72:75], v[4:7]
    s_waitcnt lgkmcnt(7)
    ds_read_b64_tr_b16 a[186:187], v121 offset:26048
    v_exp_f32 v67, v67
    v_mfma_f32_16x16x32_bf16 v[8:11], a[168:171], v[72:75], v[8:11]
    s_waitcnt lgkmcnt(6)
    v_cvt_pk_bf16_f32 v77, v66, v67
    v_add_f32 v85, v85, v67
    v_mfma_f32_16x16x32_bf16 v[12:15], a[172:175], v[72:75], v[12:15]
    ds_read_b64_tr_b16 a[188:189], v121 offset:25568
    v_exp_f32 v68, v68
    v_mfma_f32_16x16x32_bf16 v[64:67], a[128:131], v[224:227], v[112:115]
    ds_read_b64_tr_b16 a[190:191], v121 offset:26080
    v_add_f32 v85, v85, v68
    v_mfma_f32_16x16x32_bf16 v[64:67], a[132:135], v[228:231], v[64:67]
    v_exp_f32 v69, v69
    v_mfma_f32_16x16x32_bf16 v[64:67], a[136:139], v[232:235], v[64:67]
    v_cvt_pk_bf16_f32 v78, v68, v69
    v_add_f32 v85, v85, v69
    v_mfma_f32_16x16x32_bf16 v[64:67], a[140:143], v[236:239], v[64:67]
    s_waitcnt lgkmcnt(6)
    v_exp_f32 v70, v70
    v_mfma_f32_16x16x32_bf16 v[16:19], a[176:179], v[72:75], v[16:19]
    s_waitcnt lgkmcnt(4)
    v_add_f32 v85, v85, v70
    v_mfma_f32_16x16x32_bf16 v[20:23], a[180:183], v[72:75], v[20:23]
    s_waitcnt lgkmcnt(2)
    v_exp_f32 v71, v71
    v_mfma_f32_16x16x32_bf16 v[24:27], a[184:187], v[72:75], v[24:27]
    s_waitcnt lgkmcnt(0)
    v_cvt_pk_bf16_f32 v79, v70, v71
    v_add_f32 v85, v85, v71
    v_mfma_f32_16x16x32_bf16 v[28:31], a[188:191], v[72:75], v[28:31]
    v_exp_f32 v64, v64
    v_mfma_f32_16x16x32_bf16 v[68:71], a[144:147], v[224:227], v[112:115]
    v_add_f32 v86, v86, v64
    v_mfma_f32_16x16x32_bf16 v[68:71], a[148:151], v[228:231], v[68:71]
    v_exp_f32 v65, v65
    v_mfma_f32_16x16x32_bf16 v[68:71], a[152:155], v[232:235], v[68:71]
    v_cvt_pk_bf16_f32 v72, v64, v65
    v_add_f32 v86, v86, v65
    v_mfma_f32_16x16x32_bf16 v[68:71], a[156:159], v[236:239], v[68:71]
    v_exp_f32 v66, v66
    v_mfma_f32_16x16x32_bf16 v[32:35], a[160:163], v[76:79], v[32:35]
    v_add_f32 v86, v86, v66
    v_mfma_f32_16x16x32_bf16 v[36:39], a[164:167], v[76:79], v[36:39]
    v_exp_f32 v67, v67
    v_mfma_f32_16x16x32_bf16 v[40:43], a[168:171], v[76:79], v[40:43]
    v_cvt_pk_bf16_f32 v73, v66, v67
    v_add_f32 v86, v86, v67
    v_mfma_f32_16x16x32_bf16 v[44:47], a[172:175], v[76:79], v[44:47]
    v_exp_f32 v68, v68
    v_mfma_f32_16x16x32_bf16 v[64:67], a[128:131], v[240:243], v[116:119]
    v_add_f32 v86, v86, v68
    v_mfma_f32_16x16x32_bf16 v[64:67], a[132:135], v[244:247], v[64:67]
    v_exp_f32 v69, v69
    v_mfma_f32_16x16x32_bf16 v[64:67], a[136:139], v[248:251], v[64:67]
    v_cvt_pk_bf16_f32 v74, v68, v69
    v_add_f32 v86, v86, v69
    v_mfma_f32_16x16x32_bf16 v[64:67], a[140:143], v[252:255], v[64:67]
    v_exp_f32 v70, v70
    v_mfma_f32_16x16x32_bf16 v[48:51], a[176:179], v[76:79], v[48:51]
    v_add_f32 v86, v86, v70
    v_mfma_f32_16x16x32_bf16 v[52:55], a[180:183], v[76:79], v[52:55]
    v_exp_f32 v71, v71
    v_mfma_f32_16x16x32_bf16 v[56:59], a[184:187], v[76:79], v[56:59]
    v_cvt_pk_bf16_f32 v75, v70, v71
    v_add_f32 v86, v86, v71
    v_mfma_f32_16x16x32_bf16 v[60:63], a[188:191], v[76:79], v[60:63]
    v_exp_f32 v64, v64
    v_mfma_f32_16x16x32_bf16 v[68:71], a[144:147], v[240:243], v[116:119]
    v_add_f32 v87, v87, v64
    v_mfma_f32_16x16x32_bf16 v[68:71], a[148:151], v[244:247], v[68:71]
    v_exp_f32 v65, v65
    v_mfma_f32_16x16x32_bf16 v[68:71], a[152:155], v[248:251], v[68:71]
    v_cvt_pk_bf16_f32 v76, v64, v65
    v_add_f32 v87, v87, v65
    v_mfma_f32_16x16x32_bf16 v[68:71], a[156:159], v[252:255], v[68:71]
    v_exp_f32 v66, v66
    v_mfma_f32_16x16x32_bf16 a[192:195], a[160:163], v[72:75], a[192:195]
    v_add_f32 v87, v87, v66
    v_mfma_f32_16x16x32_bf16 a[196:199], a[164:167], v[72:75], a[196:199]
    v_exp_f32 v67, v67
    v_mfma_f32_16x16x32_bf16 a[200:203], a[168:171], v[72:75], a[200:203]
    v_cvt_pk_bf16_f32 v77, v66, v67
    v_add_f32 v87, v87, v67
    v_mfma_f32_16x16x32_bf16 a[204:207], a[172:175], v[72:75], a[204:207]
    v_exp_f32 v68, v68
    s_nop 0
    v_add_f32 v87, v87, v68
    v_exp_f32 v69, v69
    s_nop 0
    v_cvt_pk_bf16_f32 v78, v68, v69
    v_add_f32 v87, v87, v69
    v_exp_f32 v70, v70
    v_mfma_f32_16x16x32_bf16 a[208:211], a[176:179], v[72:75], a[208:211]
    v_add_f32 v87, v87, v70
    v_mfma_f32_16x16x32_bf16 a[212:215], a[180:183], v[72:75], a[212:215]
    v_exp_f32 v71, v71
    v_mfma_f32_16x16x32_bf16 a[216:219], a[184:187], v[72:75], a[216:219]
    v_cvt_pk_bf16_f32 v79, v70, v71
    v_add_f32 v87, v87, v71
    v_mfma_f32_16x16x32_bf16 a[220:223], a[188:191], v[72:75], a[220:223]
    v_mfma_f32_16x16x32_bf16 a[224:227], a[160:163], v[76:79], a[224:227]
    v_mfma_f32_16x16x32_bf16 a[228:231], a[164:167], v[76:79], a[228:231]
    v_mfma_f32_16x16x32_bf16 a[232:235], a[168:171], v[76:79], a[232:235]
    v_mfma_f32_16x16x32_bf16 a[236:239], a[172:175], v[76:79], a[236:239]
    v_mfma_f32_16x16x32_bf16 a[240:243], a[176:179], v[76:79], a[240:243]
    v_mfma_f32_16x16x32_bf16 a[244:247], a[180:183], v[76:79], a[244:247]
    v_mfma_f32_16x16x32_bf16 a[248:251], a[184:187], v[76:79], a[248:251]
    v_mfma_f32_16x16x32_bf16 a[252:255], a[188:191], v[76:79], a[252:255]
    v_permlane32_swap_b32 v84, v85
    v_permlane32_swap_b32 v86, v87
    v_add_f32 v84, v84, v85
    v_add_f32 v86, v86, v87
    s_nop 1
    v_permlane16_swap_b32 v84, v86
    v_add_f32 v84, v84, v86
    v_cmp_nge_f32 vcc, 0x53800000, v84
    v_rcp_f32 v84, v84
    s_or_b64 s[48:49], s[48:49], vcc
    v_mov_b32 v86, v84
    s_nop 1
    v_permlane16_swap_b32 v84, v86
    v_mov_b32 v85, v84
    v_mov_b32 v87, v86
    s_nop 0
    v_permlane32_swap_b32 v84, v85
    v_permlane32_swap_b32 v86, v87
    v_pk_mul_f32 v[0:1], v[0:1], v[84:85] op_sel:[0,0] op_sel_hi:[1,0]
    v_pk_mul_f32 v[2:3], v[2:3], v[84:85] op_sel:[0,0] op_sel_hi:[1,0]
    v_pk_mul_f32 v[4:5], v[4:5], v[84:85] op_sel:[0,0] op_sel_hi:[1,0]
    v_pk_mul_f32 v[6:7], v[6:7], v[84:85] op_sel:[0,0] op_sel_hi:[1,0]
    v_cvt_pk_bf16_f32 v96, v0, v1
    v_cvt_pk_bf16_f32 v97, v2, v3
    v_cvt_pk_bf16_f32 v98, v4, v5
    v_cvt_pk_bf16_f32 v99, v6, v7
    v_pk_mul_f32 v[8:9], v[8:9], v[84:85] op_sel:[0,0] op_sel_hi:[1,0]
    v_pk_mul_f32 v[10:11], v[10:11], v[84:85] op_sel:[0,0] op_sel_hi:[1,0]
    v_pk_mul_f32 v[12:13], v[12:13], v[84:85] op_sel:[0,0] op_sel_hi:[1,0]
    v_pk_mul_f32 v[14:15], v[14:15], v[84:85] op_sel:[0,0] op_sel_hi:[1,0]
    ds_write_b64 v123, v[96:97] offset:0
    ds_write_b64 v123, v[98:99] offset:32
    v_cvt_pk_bf16_f32 v112, v8, v9
    v_cvt_pk_bf16_f32 v113, v10, v11
    v_cvt_pk_bf16_f32 v114, v12, v13
    v_cvt_pk_bf16_f32 v115, v14, v15
    v_pk_mul_f32 v[16:17], v[16:17], v[84:85] op_sel:[0,0] op_sel_hi:[1,0]
    v_pk_mul_f32 v[18:19], v[18:19], v[84:85] op_sel:[0,0] op_sel_hi:[1,0]
    v_pk_mul_f32 v[20:21], v[20:21], v[84:85] op_sel:[0,0] op_sel_hi:[1,0]
    v_pk_mul_f32 v[22:23], v[22:23], v[84:85] op_sel:[0,0] op_sel_hi:[1,0]
    ds_write_b64 v123, v[112:113] offset:64
    ds_write_b64 v123, v[114:115] offset:96
    v_cvt_pk_bf16_f32 v96, v16, v17
    v_cvt_pk_bf16_f32 v97, v18, v19
    v_cvt_pk_bf16_f32 v98, v20, v21
    v_cvt_pk_bf16_f32 v99, v22, v23
    v_pk_mul_f32 v[24:25], v[24:25], v[84:85] op_sel:[0,0] op_sel_hi:[1,0]
    v_pk_mul_f32 v[26:27], v[26:27], v[84:85] op_sel:[0,0] op_sel_hi:[1,0]
    v_pk_mul_f32 v[28:29], v[28:29], v[84:85] op_sel:[0,0] op_sel_hi:[1,0]
    v_pk_mul_f32 v[30:31], v[30:31], v[84:85] op_sel:[0,0] op_sel_hi:[1,0]
    ds_write_b64 v123, v[96:97] offset:128
    ds_write_b64 v123, v[98:99] offset:160
    v_cvt_pk_bf16_f32 v112, v24, v25
    v_cvt_pk_bf16_f32 v113, v26, v27
    v_cvt_pk_bf16_f32 v114, v28, v29
    v_cvt_pk_bf16_f32 v115, v30, v31
    ds_write_b64 v123, v[112:113] offset:192
    ds_write_b64 v123, v[114:115] offset:224
    ds_read_b128 v[64:67], v124 offset:0
    ds_read_b128 v[68:71], v124 offset:1088
    ds_read_b128 v[72:75], v124 offset:2176
    ds_read_b128 v[76:79], v124 offset:3264
    v_pk_mul_f32 v[32:33], v[32:33], v[84:85] op_sel:[0,1] op_sel_hi:[1,1]
    v_pk_mul_f32 v[34:35], v[34:35], v[84:85] op_sel:[0,1] op_sel_hi:[1,1]
    v_pk_mul_f32 v[36:37], v[36:37], v[84:85] op_sel:[0,1] op_sel_hi:[1,1]
    v_pk_mul_f32 v[38:39], v[38:39], v[84:85] op_sel:[0,1] op_sel_hi:[1,1]
    v_cvt_pk_bf16_f32 v96, v32, v33
    v_cvt_pk_bf16_f32 v97, v34, v35
    v_cvt_pk_bf16_f32 v98, v36, v37
    v_cvt_pk_bf16_f32 v99, v38, v39
    v_pk_mul_f32 v[40:41], v[40:41], v[84:85] op_sel:[0,1] op_sel_hi:[1,1]
    v_pk_mul_f32 v[42:43], v[42:43], v[84:85] op_sel:[0,1] op_sel_hi:[1,1]
    v_pk_mul_f32 v[44:45], v[44:45], v[84:85] op_sel:[0,1] op_sel_hi:[1,1]
    v_pk_mul_f32 v[46:47], v[46:47], v[84:85] op_sel:[0,1] op_sel_hi:[1,1]
    s_waitcnt lgkmcnt(0)
    buffer_store_dwordx4 v[64:67], v122, s[24:27], s39 offen offset:0 sc1 nt
    buffer_store_dwordx4 v[68:71], v122, s[24:27], s39 offen offset:1024 sc1 nt
    buffer_store_dwordx4 v[72:75], v122, s[24:27], s39 offen offset:2048 sc1 nt
    buffer_store_dwordx4 v[76:79], v122, s[24:27], s39 offen offset:3072 sc1 nt
    s_add_u32 s39, s39, 4096
    ds_write_b64 v123, v[96:97] offset:4352
    ds_write_b64 v123, v[98:99] offset:4384
    v_cvt_pk_bf16_f32 v112, v40, v41
    v_cvt_pk_bf16_f32 v113, v42, v43
    v_cvt_pk_bf16_f32 v114, v44, v45
    v_cvt_pk_bf16_f32 v115, v46, v47
    v_pk_mul_f32 v[48:49], v[48:49], v[84:85] op_sel:[0,1] op_sel_hi:[1,1]
    v_pk_mul_f32 v[50:51], v[50:51], v[84:85] op_sel:[0,1] op_sel_hi:[1,1]
    v_pk_mul_f32 v[52:53], v[52:53], v[84:85] op_sel:[0,1] op_sel_hi:[1,1]
    v_pk_mul_f32 v[54:55], v[54:55], v[84:85] op_sel:[0,1] op_sel_hi:[1,1]
    ds_write_b64 v123, v[112:113] offset:4416
    ds_write_b64 v123, v[114:115] offset:4448
    v_cvt_pk_bf16_f32 v96, v48, v49
    v_cvt_pk_bf16_f32 v97, v50, v51
    v_cvt_pk_bf16_f32 v98, v52, v53
    v_cvt_pk_bf16_f32 v99, v54, v55
    v_pk_mul_f32 v[56:57], v[56:57], v[84:85] op_sel:[0,1] op_sel_hi:[1,1]
    v_pk_mul_f32 v[58:59], v[58:59], v[84:85] op_sel:[0,1] op_sel_hi:[1,1]
    v_pk_mul_f32 v[60:61], v[60:61], v[84:85] op_sel:[0,1] op_sel_hi:[1,1]
    v_pk_mul_f32 v[62:63], v[62:63], v[84:85] op_sel:[0,1] op_sel_hi:[1,1]
    ds_write_b64 v123, v[96:97] offset:4480
    ds_write_b64 v123, v[98:99] offset:4512
    v_cvt_pk_bf16_f32 v112, v56, v57
    v_cvt_pk_bf16_f32 v113, v58, v59
    v_cvt_pk_bf16_f32 v114, v60, v61
    v_cvt_pk_bf16_f32 v115, v62, v63
    ds_write_b64 v123, v[112:113] offset:4544
    ds_write_b64 v123, v[114:115] offset:4576
    ds_read_b128 v[0:3], v124 offset:4352
    ds_read_b128 v[4:7], v124 offset:5440
    ds_read_b128 v[8:11], v124 offset:6528
    ds_read_b128 v[12:15], v124 offset:7616
    v_accvgpr_read_b32 v88, a192
    v_accvgpr_read_b32 v89, a193
    v_accvgpr_read_b32 v90, a194
    v_accvgpr_read_b32 v91, a195
    v_accvgpr_read_b32 v92, a196
    v_accvgpr_read_b32 v93, a197
    v_accvgpr_read_b32 v94, a198
    v_accvgpr_read_b32 v95, a199
    v_pk_mul_f32 v[88:89], v[88:89], v[86:87] op_sel:[0,0] op_sel_hi:[1,0]
    v_pk_mul_f32 v[90:91], v[90:91], v[86:87] op_sel:[0,0] op_sel_hi:[1,0]
    v_pk_mul_f32 v[92:93], v[92:93], v[86:87] op_sel:[0,0] op_sel_hi:[1,0]
    v_pk_mul_f32 v[94:95], v[94:95], v[86:87] op_sel:[0,0] op_sel_hi:[1,0]
    v_cvt_pk_bf16_f32 v96, v88, v89
    v_cvt_pk_bf16_f32 v97, v90, v91
    v_cvt_pk_bf16_f32 v98, v92, v93
    v_cvt_pk_bf16_f32 v99, v94, v95
    v_accvgpr_read_b32 v104, a200
    v_accvgpr_read_b32 v105, a201
    v_accvgpr_read_b32 v106, a202
    v_accvgpr_read_b32 v107, a203
    v_accvgpr_read_b32 v108, a204
    v_accvgpr_read_b32 v109, a205
    v_accvgpr_read_b32 v110, a206
    v_accvgpr_read_b32 v111, a207
    s_waitcnt lgkmcnt(0)
    buffer_store_dwordx4 v[0:3], v122, s[24:27], s39 offen offset:0 sc1 nt
    buffer_store_dwordx4 v[4:7], v122, s[24:27], s39 offen offset:1024 sc1 nt
    buffer_store_dwordx4 v[8:11], v122, s[24:27], s39 offen offset:2048 sc1 nt
    buffer_store_dwordx4 v[12:15], v122, s[24:27], s39 offen offset:3072 sc1 nt
    s_add_u32 s39, s39, 4096
    v_pk_mul_f32 v[104:105], v[104:105], v[86:87] op_sel:[0,0] op_sel_hi:[1,0]
    v_pk_mul_f32 v[106:107], v[106:107], v[86:87] op_sel:[0,0] op_sel_hi:[1,0]
    v_pk_mul_f32 v[108:109], v[108:109], v[86:87] op_sel:[0,0] op_sel_hi:[1,0]
    v_pk_mul_f32 v[110:111], v[110:111], v[86:87] op_sel:[0,0] op_sel_hi:[1,0]
    ds_write_b64 v123, v[96:97] offset:0
    ds_write_b64 v123, v[98:99] offset:32
    v_cvt_pk_bf16_f32 v112, v104, v105
    v_cvt_pk_bf16_f32 v113, v106, v107
    v_cvt_pk_bf16_f32 v114, v108, v109
    v_cvt_pk_bf16_f32 v115, v110, v111
    v_accvgpr_read_b32 v88, a208
    v_accvgpr_read_b32 v89, a209
    v_accvgpr_read_b32 v90, a210
    v_accvgpr_read_b32 v91, a211
    v_accvgpr_read_b32 v92, a212
    v_accvgpr_read_b32 v93, a213
    v_accvgpr_read_b32 v94, a214
    v_accvgpr_read_b32 v95, a215
    v_pk_mul_f32 v[88:89], v[88:89], v[86:87] op_sel:[0,0] op_sel_hi:[1,0]
    v_pk_mul_f32 v[90:91], v[90:91], v[86:87] op_sel:[0,0] op_sel_hi:[1,0]
    v_pk_mul_f32 v[92:93], v[92:93], v[86:87] op_sel:[0,0] op_sel_hi:[1,0]
    v_pk_mul_f32 v[94:95], v[94:95], v[86:87] op_sel:[0,0] op_sel_hi:[1,0]
    ds_write_b64 v123, v[112:113] offset:64
    ds_write_b64 v123, v[114:115] offset:96
    v_cvt_pk_bf16_f32 v96, v88, v89
    v_cvt_pk_bf16_f32 v97, v90, v91
    v_cvt_pk_bf16_f32 v98, v92, v93
    v_cvt_pk_bf16_f32 v99, v94, v95
    v_accvgpr_read_b32 v104, a216
    v_accvgpr_read_b32 v105, a217
    v_accvgpr_read_b32 v106, a218
    v_accvgpr_read_b32 v107, a219
    v_accvgpr_read_b32 v108, a220
    v_accvgpr_read_b32 v109, a221
    v_accvgpr_read_b32 v110, a222
    v_accvgpr_read_b32 v111, a223
    v_pk_mul_f32 v[104:105], v[104:105], v[86:87] op_sel:[0,0] op_sel_hi:[1,0]
    v_pk_mul_f32 v[106:107], v[106:107], v[86:87] op_sel:[0,0] op_sel_hi:[1,0]
    v_pk_mul_f32 v[108:109], v[108:109], v[86:87] op_sel:[0,0] op_sel_hi:[1,0]
    v_pk_mul_f32 v[110:111], v[110:111], v[86:87] op_sel:[0,0] op_sel_hi:[1,0]
    ds_write_b64 v123, v[96:97] offset:128
    ds_write_b64 v123, v[98:99] offset:160
    v_cvt_pk_bf16_f32 v112, v104, v105
    v_cvt_pk_bf16_f32 v113, v106, v107
    v_cvt_pk_bf16_f32 v114, v108, v109
    v_cvt_pk_bf16_f32 v115, v110, v111
    ds_write_b64 v123, v[112:113] offset:192
    ds_write_b64 v123, v[114:115] offset:224
    ds_read_b128 v[16:19], v124 offset:0
    ds_read_b128 v[20:23], v124 offset:1088
    ds_read_b128 v[24:27], v124 offset:2176
    ds_read_b128 v[28:31], v124 offset:3264
    v_accvgpr_read_b32 v88, a224
    v_accvgpr_read_b32 v89, a225
    v_accvgpr_read_b32 v90, a226
    v_accvgpr_read_b32 v91, a227
    v_accvgpr_read_b32 v92, a228
    v_accvgpr_read_b32 v93, a229
    v_accvgpr_read_b32 v94, a230
    v_accvgpr_read_b32 v95, a231
    v_pk_mul_f32 v[88:89], v[88:89], v[86:87] op_sel:[0,1] op_sel_hi:[1,1]
    v_pk_mul_f32 v[90:91], v[90:91], v[86:87] op_sel:[0,1] op_sel_hi:[1,1]
    v_pk_mul_f32 v[92:93], v[92:93], v[86:87] op_sel:[0,1] op_sel_hi:[1,1]
    v_pk_mul_f32 v[94:95], v[94:95], v[86:87] op_sel:[0,1] op_sel_hi:[1,1]
    v_cvt_pk_bf16_f32 v96, v88, v89
    v_cvt_pk_bf16_f32 v97, v90, v91
    v_cvt_pk_bf16_f32 v98, v92, v93
    v_cvt_pk_bf16_f32 v99, v94, v95
    v_accvgpr_read_b32 v104, a232
    v_accvgpr_read_b32 v105, a233
    v_accvgpr_read_b32 v106, a234
    v_accvgpr_read_b32 v107, a235
    v_accvgpr_read_b32 v108, a236
    v_accvgpr_read_b32 v109, a237
    v_accvgpr_read_b32 v110, a238
    v_accvgpr_read_b32 v111, a239
    s_waitcnt lgkmcnt(0)
    buffer_store_dwordx4 v[16:19], v122, s[24:27], s39 offen offset:0 sc1 nt
    buffer_store_dwordx4 v[20:23], v122, s[24:27], s39 offen offset:1024 sc1 nt
    buffer_store_dwordx4 v[24:27], v122, s[24:27], s39 offen offset:2048 sc1 nt
    buffer_store_dwordx4 v[28:31], v122, s[24:27], s39 offen offset:3072 sc1 nt
    s_add_u32 s39, s39, 4096
    v_pk_mul_f32 v[104:105], v[104:105], v[86:87] op_sel:[0,1] op_sel_hi:[1,1]
    v_pk_mul_f32 v[106:107], v[106:107], v[86:87] op_sel:[0,1] op_sel_hi:[1,1]
    v_pk_mul_f32 v[108:109], v[108:109], v[86:87] op_sel:[0,1] op_sel_hi:[1,1]
    v_pk_mul_f32 v[110:111], v[110:111], v[86:87] op_sel:[0,1] op_sel_hi:[1,1]
    ds_write_b64 v123, v[96:97] offset:4352
    ds_write_b64 v123, v[98:99] offset:4384
    v_cvt_pk_bf16_f32 v112, v104, v105
    v_cvt_pk_bf16_f32 v113, v106, v107
    v_cvt_pk_bf16_f32 v114, v108, v109
    v_cvt_pk_bf16_f32 v115, v110, v111
    v_accvgpr_read_b32 v88, a240
    v_accvgpr_read_b32 v89, a241
    v_accvgpr_read_b32 v90, a242
    v_accvgpr_read_b32 v91, a243
    v_accvgpr_read_b32 v92, a244
    v_accvgpr_read_b32 v93, a245
    v_accvgpr_read_b32 v94, a246
    v_accvgpr_read_b32 v95, a247
    v_pk_mul_f32 v[88:89], v[88:89], v[86:87] op_sel:[0,1] op_sel_hi:[1,1]
    v_pk_mul_f32 v[90:91], v[90:91], v[86:87] op_sel:[0,1] op_sel_hi:[1,1]
    v_pk_mul_f32 v[92:93], v[92:93], v[86:87] op_sel:[0,1] op_sel_hi:[1,1]
    v_pk_mul_f32 v[94:95], v[94:95], v[86:87] op_sel:[0,1] op_sel_hi:[1,1]
    ds_write_b64 v123, v[112:113] offset:4416
    ds_write_b64 v123, v[114:115] offset:4448
    v_cvt_pk_bf16_f32 v96, v88, v89
    v_cvt_pk_bf16_f32 v97, v90, v91
    v_cvt_pk_bf16_f32 v98, v92, v93
    v_cvt_pk_bf16_f32 v99, v94, v95
    v_accvgpr_read_b32 v104, a248
    v_accvgpr_read_b32 v105, a249
    v_accvgpr_read_b32 v106, a250
    v_accvgpr_read_b32 v107, a251
    v_accvgpr_read_b32 v108, a252
    v_accvgpr_read_b32 v109, a253
    v_accvgpr_read_b32 v110, a254
    v_accvgpr_read_b32 v111, a255
    v_pk_mul_f32 v[104:105], v[104:105], v[86:87] op_sel:[0,1] op_sel_hi:[1,1]
    v_pk_mul_f32 v[106:107], v[106:107], v[86:87] op_sel:[0,1] op_sel_hi:[1,1]
    v_pk_mul_f32 v[108:109], v[108:109], v[86:87] op_sel:[0,1] op_sel_hi:[1,1]
    v_pk_mul_f32 v[110:111], v[110:111], v[86:87] op_sel:[0,1] op_sel_hi:[1,1]
    ds_write_b64 v123, v[96:97] offset:4480
    ds_write_b64 v123, v[98:99] offset:4512
    v_cvt_pk_bf16_f32 v112, v104, v105
    v_cvt_pk_bf16_f32 v113, v106, v107
    v_cvt_pk_bf16_f32 v114, v108, v109
    v_cvt_pk_bf16_f32 v115, v110, v111
    ds_write_b64 v123, v[112:113] offset:4544
    ds_write_b64 v123, v[114:115] offset:4576
    ds_read_b128 v[32:35], v124 offset:4352
    ds_read_b128 v[36:39], v124 offset:5440
    ds_read_b128 v[40:43], v124 offset:6528
    ds_read_b128 v[44:47], v124 offset:7616
    s_waitcnt lgkmcnt(0)
    buffer_store_dwordx4 v[32:35], v122, s[24:27], s39 offen offset:0 sc1 nt
    buffer_store_dwordx4 v[36:39], v122, s[24:27], s39 offen offset:1024 sc1 nt
    buffer_store_dwordx4 v[40:43], v122, s[24:27], s39 offen offset:2048 sc1 nt
    buffer_store_dwordx4 v[44:47], v122, s[24:27], s39 offen offset:3072 sc1 nt
    s_add_u32 s39, s39, 4096
    s_branch L_fin
L_headb:
    v_mfma_f32_16x16x32_bf16 v[64:67], a[128:131], v[128:131], v[88:91]
    s_waitcnt lgkmcnt(15)
    ds_read_b128 a[152:155], v120 offset:640
    v_mfma_f32_16x16x32_bf16 v[64:67], a[132:135], v[132:135], v[64:67]
    s_waitcnt lgkmcnt(15)
    v_mfma_f32_16x16x32_bf16 v[64:67], a[136:139], v[136:139], v[64:67]
    s_waitcnt lgkmcnt(15)
    v_mfma_f32_16x16x32_bf16 v[64:67], a[140:143], v[140:143], v[64:67]
    s_add_u32 m0, s42, 10848
    ds_read_b128 a[156:159], v120 offset:704
    buffer_load_dwordx4 v119, s[12:15], 0 offen offset:768 nt lds
    s_waitcnt lgkmcnt(15)
    s_nop 3
    v_exp_f32 v64, v64
    v_mfma_f32_16x16x32_bf16 v[68:71], a[144:147], v[128:131], v[88:91]
    s_waitcnt lgkmcnt(15)
    v_add_f32 v80, v80, v64
    v_mfma_f32_16x16x32_bf16 v[68:71], a[148:151], v[132:135], v[68:71]
    s_waitcnt lgkmcnt(1)
    v_exp_f32 v65, v65
    v_mfma_f32_16x16x32_bf16 v[68:71], a[152:155], v[136:139], v[68:71]
    s_waitcnt lgkmcnt(0)
    v_cvt_pk_bf16_f32 v72, v64, v65
    v_add_f32 v80, v80, v65
    v_mfma_f32_16x16x32_bf16 v[68:71], a[156:159], v[140:143], v[68:71]
    s_add_u32 m0, s42, 11648
    v_exp_f32 v66, v66
    ds_read_b64_tr_b16 a[160:161], v121 offset:0
    buffer_load_dwordx4 v119, s[12:15], 0 offen offset:1024 nt lds
    v_add_f32 v80, v80, v66
    ds_read_b64_tr_b16 a[162:163], v121 offset:512
    v_exp_f32 v67, v67
    s_nop 0
    v_cvt_pk_bf16_f32 v73, v66, v67
    v_add_f32 v80, v80, v67
    ds_read_b64_tr_b16 a[164:165], v121 offset:32
    v_exp_f32 v68, v68
    v_mfma_f32_16x16x32_bf16 v[64:67], a[128:131], v[144:147], v[92:95]
    ds_read_b64_tr_b16 a[166:167], v121 offset:544
    v_add_f32 v80, v80, v68
    v_mfma_f32_16x16x32_bf16 v[64:67], a[132:135], v[148:151], v[64:67]
    ds_read_b64_tr_b16 a[168:169], v121 offset:64
    v_exp_f32 v69, v69
    v_mfma_f32_16x16x32_bf16 v[64:67], a[136:139], v[152:155], v[64:67]
    v_cvt_pk_bf16_f32 v74, v68, v69
    v_add_f32 v80, v80, v69
    v_mfma_f32_16x16x32_bf16 v[64:67], a[140:143], v[156:159], v[64:67]
    ds_read_b64_tr_b16 a[170:171], v121 offset:576
    v_exp_f32 v70, v70
    ds_read_b64_tr_b16 a[172:173], v121 offset:96
    v_add_f32 v80, v80, v70
    ds_read_b64_tr_b16 a[174:175], v121 offset:608
    v_exp_f32 v71, v71
    s_nop 0
    v_cvt_pk_bf16_f32 v75, v70, v71
    v_add_f32 v80, v80, v71
    s_add_u32 m0, s42, 12448
    ds_read_b64_tr_b16 a[176:177], v121 offset:128
    v_exp_f32 v64, v64
    v_mfma_f32_16x16x32_bf16 v[68:71], a[144:147], v[144:147], v[92:95]
    ds_read_b64_tr_b16 a[178:179], v121 offset:640
    buffer_load_dwordx4 v119, s[12:15], 0 offen offset:1280 nt lds
    v_add_f32 v81, v81, v64
    v_mfma_f32_16x16x32_bf16 v[68:71], a[148:151], v[148:151], v[68:71]
    ds_read_b64_tr_b16 a[180:181], v121 offset:160
    v_exp_f32 v65, v65
    v_mfma_f32_16x16x32_bf16 v[68:71], a[152:155], v[152:155], v[68:71]
    v_cvt_pk_bf16_f32 v76, v64, v65
    v_add_f32 v81, v81, v65
    v_mfma_f32_16x16x32_bf16 v[68:71], a[156:159], v[156:159], v[68:71]
    s_waitcnt lgkmcnt(9)
    ds_read_b64_tr_b16 a[182:183], v121 offset:672
    v_exp_f32 v66, v66
    v_mfma_f32_16x16x32_bf16 a[0:3], a[160:163], v[72:75], 0
    s_waitcnt lgkmcnt(8)
    ds_read_b64_tr_b16 a[184:185], v121 offset:192
    v_add_f32 v81, v81, v66
    v_mfma_f32_16x16x32_bf16 a[4:7], a[164:167], v[72:75], 0
    s_waitcnt lgkmcnt(7)
    ds_read_b64_tr_b16 a[186:187], v121 offset:704
    v_exp_f32 v67, v67
    v_mfma_f32_16x16x32_bf16 a[8:11], a[168:171], v[72:75], 0
    s_waitcnt lgkmcnt(6)
    v_cvt_pk_bf16_f32 v77, v66, v67
    v_add_f32 v81, v81, v67
    v_mfma_f32_16x16x32_bf16 a[12:15], a[172:175], v[72:75], 0
    ds_read_b64_tr_b16 a[188:189], v121 offset:224
    v_exp_f32 v68, v68
    v_mfma_f32_16x16x32_bf16 v[64:67], a[128:131], v[160:163], v[96:99]
    ds_read_b64_tr_b16 a[190:191], v121 offset:736
    v_add_f32 v81, v81, v68
    v_mfma_f32_16x16x32_bf16 v[64:67], a[132:135], v[164:167], v[64:67]
    v_exp_f32 v69, v69
    v_mfma_f32_16x16x32_bf16 v[64:67], a[136:139], v[168:171], v[64:67]
    v_cvt_pk_bf16_f32 v78, v68, v69
    v_add_f32 v81, v81, v69
    v_mfma_f32_16x16x32_bf16 v[64:67], a[140:143], v[172:175], v[64:67]
    s_waitcnt lgkmcnt(6)
    s_add_u32 m0, s42, 13248
    v_exp_f32 v70, v70
    v_mfma_f32_16x16x32_bf16 a[16:19], a[176:179], v[72:75], 0
    s_waitcnt lgkmcnt(4)
    buffer_load_dwordx4 v119, s[12:15], 0 offen offset:1536 nt lds
    v_add_f32 v81, v81, v70
    v_mfma_f32_16x16x32_bf16 a[20:23], a[180:183], v[72:75], 0
    s_waitcnt lgkmcnt(2)
    v_exp_f32 v71, v71
    v_mfma_f32_16x16x32_bf16 a[24:27], a[184:187], v[72:75], 0
    s_waitcnt lgkmcnt(0)
    v_cvt_pk_bf16_f32 v79, v70, v71
    v_add_f32 v81, v81, v71
    v_mfma_f32_16x16x32_bf16 a[28:31], a[188:191], v[72:75], 0
    v_exp_f32 v64, v64
    v_mfma_f32_16x16x32_bf16 v[68:71], a[144:147], v[160:163], v[96:99]
    v_add_f32 v82, v82, v64
    v_mfma_f32_16x16x32_bf16 v[68:71], a[148:151], v[164:167], v[68:71]
    v_exp_f32 v65, v65
    v_mfma_f32_16x16x32_bf16 v[68:71], a[152:155], v[168:171], v[68:71]
    v_cvt_pk_bf16_f32 v72, v64, v65
    v_add_f32 v82, v82, v65
    v_mfma_f32_16x16x32_bf16 v[68:71], a[156:159], v[172:175], v[68:71]
    v_exp_f32 v66, v66
    v_mfma_f32_16x16x32_bf16 a[32:35], a[160:163], v[76:79], 0
    v_add_f32 v82, v82, v66
    v_mfma_f32_16x16x32_bf16 a[36:39], a[164:167], v[76:79], 0
    v_exp_f32 v67, v67
    v_mfma_f32_16x16x32_bf16 a[40:43], a[168:171], v[76:79], 0
    v_cvt_pk_bf16_f32 v73, v66, v67
    v_add_f32 v82, v82, v67
    v_mfma_f32_16x16x32_bf16 a[44:47], a[172:175], v[76:79], 0
    s_add_u32 m0, s42, 14048
    v_exp_f32 v68, v68
    v_mfma_f32_16x16x32_bf16 v[64:67], a[128:131], v[176:179], v[100:103]
    buffer_load_dwordx4 v119, s[12:15], 0 offen offset:1792 nt lds
    v_add_f32 v82, v82, v68
    v_mfma_f32_16x16x32_bf16 v[64:67], a[132:135], v[180:183], v[64:67]
    v_exp_f32 v69, v69
    v_mfma_f32_16x16x32_bf16 v[64:67], a[136:139], v[184:187], v[64:67]
    v_cvt_pk_bf16_f32 v74, v68, v69
    v_add_f32 v82, v82, v69
    v_mfma_f32_16x16x32_bf16 v[64:67], a[140:143], v[188:191], v[64:67]
    v_exp_f32 v70, v70
    v_mfma_f32_16x16x32_bf16 a[48:51], a[176:179], v[76:79], 0
    v_add_f32 v82, v82, v70
    v_mfma_f32_16x16x32_bf16 a[52:55], a[180:183], v[76:79], 0
    v_exp_f32 v71, v71
    v_mfma_f32_16x16x32_bf16 a[56:59], a[184:187], v[76:79], 0
    v_cvt_pk_bf16_f32 v75, v70, v71
    v_add_f32 v82, v82, v71
    v_mfma_f32_16x16x32_bf16 a[60:63], a[188:191], v[76:79], 0
    v_exp_f32 v64, v64
    v_mfma_f32_16x16x32_bf16 v[68:71], a[144:147], v[176:179], v[100:103]
    v_add_f32 v83, v83, v64
    v_mfma_f32_16x16x32_bf16 v[68:71], a[148:151], v[180:183], v[68:71]
    v_exp_f32 v65, v65
    v_mfma_f32_16x16x32_bf16 v[68:71], a[152:155], v[184:187], v[68:71]
    v_cvt_pk_bf16_f32 v76, v64, v65
    v_add_f32 v83, v83, v65
    v_mfma_f32_16x16x32_bf16 v[68:71], a[156:159], v[188:191], v[68:71]
    v_exp_f32 v66, v66
    v_mfma_f32_16x16x32_bf16 a[64:67], a[160:163], v[72:75], 0
    v_add_f32 v83, v83, v66
    v_mfma_f32_16x16x32_bf16 a[68:71], a[164:167], v[72:75], 0
    v_exp_f32 v67, v67
    v_mfma_f32_16x16x32_bf16 a[72:75], a[168:171], v[72:75], 0
    v_cvt_pk_bf16_f32 v77, v66, v67
    v_add_f32 v83, v83, v67
    v_mfma_f32_16x16x32_bf16 a[76:79], a[172:175], v[72:75], 0
    v_exp_f32 v68, v68
    s_waitcnt vmcnt(8)
    v_add_u32 v64, s42, v120
    ds_read_b128 v[192:195], v64 offset:0
    ds_read_b128 v[196:199], v64 offset:64
    ds_read_b128 v[200:203], v64 offset:128
    ds_read_b128 v[204:207], v64 offset:192
    ds_read_b128 v[208:211], v64 offset:512
    ds_read_b128 v[212:215], v64 offset:576
    ds_read_b128 v[216:219], v64 offset:640
    ds_read_b128 v[220:223], v64 offset:704
    s_waitcnt lgkmcnt(0)
    s_add_u32 m0, s45, 8448
    v_lshlrev_b32 v104, 16, v192
    buffer_load_dwordx4 v122, s[16:19], s55 offen offset:0 nt lds
    v_and_b32 v105, 0xffff0000, v192
    v_lshlrev_b32 v106, 16, v193
    v_and_b32 v107, 0xffff0000, v193
    v_lshlrev_b32 v108, 16, v194
    v_and_b32 v109, 0xffff0000, v194
    v_lshlrev_b32 v110, 16, v195
    v_and_b32 v111, 0xffff0000, v195
    v_pk_mul_f32 v[104:105], v[104:105], s[34:35]
    v_pk_mul_f32 v[106:107], v[106:107], s[34:35]
    v_pk_mul_f32 v[108:109], v[108:109], s[34:35]
    v_pk_mul_f32 v[110:111], v[110:111], s[34:35]
    v_cvt_pk_bf16_f32 v192, v104, v105
    v_cvt_pk_bf16_f32 v193, v106, v107
    v_cvt_pk_bf16_f32 v194, v108, v109
    v_cvt_pk_bf16_f32 v195, v110, v111
    v_lshlrev_b32 v104, 16, v196
    v_and_b32 v105, 0xffff0000, v196
    v_lshlrev_b32 v106, 16, v197
    v_and_b32 v107, 0xffff0000, v197
    v_lshlrev_b32 v108, 16, v198
    v_and_b32 v109, 0xffff0000, v198
    v_lshlrev_b32 v110, 16, v199
    v_and_b32 v111, 0xffff0000, v199
    v_pk_mul_f32 v[104:105], v[104:105], s[34:35]
    v_pk_mul_f32 v[106:107], v[106:107], s[34:35]
    v_pk_mul_f32 v[108:109], v[108:109], s[34:35]
    v_pk_mul_f32 v[110:111], v[110:111], s[34:35]
    v_cvt_pk_bf16_f32 v196, v104, v105
    v_cvt_pk_bf16_f32 v197, v106, v107
    v_cvt_pk_bf16_f32 v198, v108, v109
    v_cvt_pk_bf16_f32 v199, v110, v111
    s_add_u32 m0, s45, 8480
    v_lshlrev_b32 v104, 16, v200
    buffer_load_dwordx4 v122, s[16:19], s55 offen offset:1024 nt lds
    v_and_b32 v105, 0xffff0000, v200
    v_lshlrev_b32 v106, 16, v201
    v_and_b32 v107, 0xffff0000, v201
    v_lshlrev_b32 v108, 16, v202
    v_and_b32 v109, 0xffff0000, v202
    v_lshlrev_b32 v110, 16, v203
    v_and_b32 v111, 0xffff0000, v203
    v_pk_mul_f32 v[104:105], v[104:105], s[34:35]
    v_pk_mul_f32 v[106:107], v[106:107], s[34:35]
    v_pk_mul_f32 v[108:109], v[108:109], s[34:35]
    v_pk_mul_f32 v[110:111], v[110:111], s[34:35]
    v_cvt_pk_bf16_f32 v200, v104, v105
    v_cvt_pk_bf16_f32 v201, v106, v107
    v_cvt_pk_bf16_f32 v202, v108, v109
    v_cvt_pk_bf16_f32 v203, v110, v111
    v_lshlrev_b32 v104, 16, v204
    v_and_b32 v105, 0xffff0000, v204
    v_lshlrev_b32 v106, 16, v205
    v_and_b32 v107, 0xffff0000, v205
    v_lshlrev_b32 v108, 16, v206
    v_and_b32 v109, 0xffff0000, v206
    v_lshlrev_b32 v110, 16, v207
    v_and_b32 v111, 0xffff0000, v207
    v_pk_mul_f32 v[104:105], v[104:105], s[34:35]
    v_pk_mul_f32 v[106:107], v[106:107], s[34:35]
    v_pk_mul_f32 v[108:109], v[108:109], s[34:35]
    v_pk_mul_f32 v[110:111], v[110:111], s[34:35]
    v_cvt_pk_bf16_f32 v204, v104, v105
    v_cvt_pk_bf16_f32 v205, v106, v107
    v_cvt_pk_bf16_f32 v206, v108, v109
    v_cvt_pk_bf16_f32 v207, v110, v111
    s_add_u32 m0, s45, 76032
    v_lshlrev_b32 v104, 16, v208
    buffer_load_dwordx4 v122, s[20:23], s55 offen offset:0 nt lds
    v_and_b32 v105, 0xffff0000, v208
    v_lshlrev_b32 v106, 16, v209
    v_and_b32 v107, 0xffff0000, v209
    v_lshlrev_b32 v108, 16, v210
    v_and_b32 v109, 0xffff0000, v210
    v_lshlrev_b32 v110, 16, v211
    v_and_b32 v111, 0xffff0000, v211
    v_pk_mul_f32 v[104:105], v[104:105], s[34:35]
    v_pk_mul_f32 v[106:107], v[106:107], s[34:35]
    v_pk_mul_f32 v[108:109], v[108:109], s[34:35]
    v_pk_mul_f32 v[110:111], v[110:111], s[34:35]
    v_cvt_pk_bf16_f32 v208, v104, v105
    v_cvt_pk_bf16_f32 v209, v106, v107
    v_cvt_pk_bf16_f32 v210, v108, v109
    v_cvt_pk_bf16_f32 v211, v110, v111
    v_lshlrev_b32 v104, 16, v212
    v_and_b32 v105, 0xffff0000, v212
    v_lshlrev_b32 v106, 16, v213
    v_and_b32 v107, 0xffff0000, v213
    v_lshlrev_b32 v108, 16, v214
    v_and_b32 v109, 0xffff0000, v214
    v_lshlrev_b32 v110, 16, v215
    v_and_b32 v111, 0xffff0000, v215
    v_pk_mul_f32 v[104:105], v[104:105], s[34:35]
    v_pk_mul_f32 v[106:107], v[106:107], s[34:35]
    v_pk_mul_f32 v[108:109], v[108:109], s[34:35]
    v_pk_mul_f32 v[110:111], v[110:111], s[34:35]
    v_cvt_pk_bf16_f32 v212, v104, v105
    v_cvt_pk_bf16_f32 v213, v106, v107
    v_cvt_pk_bf16_f32 v214, v108, v109
    v_cvt_pk_bf16_f32 v215, v110, v111
    s_add_u32 m0, s45, 76064
    v_lshlrev_b32 v104, 16, v216
    buffer_load_dwordx4 v122, s[20:23], s55 offen offset:1024 nt lds
    v_and_b32 v105, 0xffff0000, v216
    v_lshlrev_b32 v106, 16, v217
    v_and_b32 v107, 0xffff0000, v217
    v_lshlrev_b32 v108, 16, v218
    v_and_b32 v109, 0xffff0000, v218
    v_lshlrev_b32 v110, 16, v219
    v_and_b32 v111, 0xffff0000, v219
    v_pk_mul_f32 v[104:105], v[104:105], s[34:35]
    v_pk_mul_f32 v[106:107], v[106:107], s[34:35]
    v_pk_mul_f32 v[108:109], v[108:109], s[34:35]
    v_pk_mul_f32 v[110:111], v[110:111], s[34:35]
    v_cvt_pk_bf16_f32 v216, v104, v105
    v_cvt_pk_bf16_f32 v217, v106, v107
    v_cvt_pk_bf16_f32 v218, v108, v109
    v_cvt_pk_bf16_f32 v219, v110, v111
    v_lshlrev_b32 v104, 16, v220
    v_and_b32 v105, 0xffff0000, v220
    v_lshlrev_b32 v106, 16, v221
    v_and_b32 v107, 0xffff0000, v221
    v_lshlrev_b32 v108, 16, v222
    v_and_b32 v109, 0xffff0000, v222
    v_lshlrev_b32 v110, 16, v223
    v_and_b32 v111, 0xffff0000, v223
    v_pk_mul_f32 v[104:105], v[104:105], s[34:35]
    v_pk_mul_f32 v[106:107], v[106:107], s[34:35]
    v_pk_mul_f32 v[108:109], v[108:109], s[34:35]
    v_pk_mul_f32 v[110:111], v[110:111], s[34:35]
    v_cvt_pk_bf16_f32 v220, v104, v105
    v_cvt_pk_bf16_f32 v221, v106, v107
    v_cvt_pk_bf16_f32 v222, v108, v109
    v_cvt_pk_bf16_f32 v223, v110, v111
    v_mfma_f32_16x16x32_bf16 v[64:67], a[128:131], v[192:195], 0
    v_mfma_f32_16x16x32_bf16 v[64:67], a[132:135], v[196:199], v[64:67]
    v_mfma_f32_16x16x32_bf16 v[64:67], a[136:139], v[200:203], v[64:67]
    v_mfma_f32_16x16x32_bf16 v[64:67], a[140:143], v[204:207], v[64:67]
    v_mfma_f32_16x16x32_bf16 v[108:111], a[128:131], v[208:211], 0
    v_mfma_f32_16x16x32_bf16 v[108:111], a[132:135], v[212:215], v[108:111]
    v_mfma_f32_16x16x32_bf16 v[108:111], a[136:139], v[216:219], v[108:111]
    v_mfma_f32_16x16x32_bf16 v[108:111], a[140:143], v[220:223], v[108:111]
    s_nop 3
    v_max3_f32 v84, v64, v65, v66
    v_max_f32 v84, v84, v67
    s_nop 1
    v_max3_f32 v85, v108, v109, v110
    v_max_f32 v85, v85, v111
    s_nop 1
    v_permlane32_swap_b32 v84, v85
    v_max_f32 v84, v84, v85
    v_mov_b32 v85, v84
    s_nop 1
    v_permlane16_swap_b32 v84, v85
    v_max_f32 v84, v84, v85
    v_mov_b32 v85, v84
    s_nop 1
    v_permlane32_swap_b32 v84, v85
    v_sub_f32 v104, 0, v84
    v_sub_f32 v108, 0, v85
    v_sub_f32 v105, 0, v84
    v_sub_f32 v109, 0, v85
    v_sub_f32 v106, 0, v84
    v_sub_f32 v110, 0, v85
    v_sub_f32 v107, 0, v84
    v_sub_f32 v111, 0, v85
    v_mov_b32 v84, 0
    v_mov_b32 v85, 0
    s_cmp_eq_u32 s40, 0
    s_cbranch_scc1 L_ov4
    v_lshrrev_b32 v64, 2, v122
    s_lshl_b32 s36, s28, 11
    v_add_u32 v64, s36, v64
    v_add_u32 v64, 135168, v64
    ds_read_b32 v104, v64 offset:1024
    ds_read_b32 v108, v64 offset:1280
    s_waitcnt lgkmcnt(0)
    v_mov_b32 v105, v104
    v_mov_b32 v106, v104
    v_mov_b32 v107, v104
    v_mov_b32 v109, v108
    v_mov_b32 v110, v108
    v_mov_b32 v111, v108
L_ov4:
    v_mfma_f32_16x16x32_bf16 v[64:67], a[128:131], v[192:195], v[104:107]
    v_add_f32 v83, v83, v68
    v_mfma_f32_16x16x32_bf16 v[64:67], a[132:135], v[196:199], v[64:67]
    v_exp_f32 v69, v69
    v_mfma_f32_16x16x32_bf16 v[64:67], a[136:139], v[200:203], v[64:67]
    v_cvt_pk_bf16_f32 v78, v68, v69
    v_add_f32 v83, v83, v69
    v_mfma_f32_16x16x32_bf16 v[64:67], a[140:143], v[204:207], v[64:67]
    s_add_u32 m0, s31, 0
    v_exp_f32 v70, v70
    v_mfma_f32_16x16x32_bf16 a[80:83], a[176:179], v[72:75], 0
    buffer_load_dwordx4 v122, s[16:19], s30 offen offset:0 nt lds
    v_add_f32 v83, v83, v70
    v_mfma_f32_16x16x32_bf16 a[84:87], a[180:183], v[72:75], 0
    v_exp_f32 v71, v71
    v_mfma_f32_16x16x32_bf16 a[88:91], a[184:187], v[72:75], 0
    v_cvt_pk_bf16_f32 v79, v70, v71
    v_add_f32 v83, v83, v71
    v_mfma_f32_16x16x32_bf16 a[92:95], a[188:191], v[72:75], 0
    v_exp_f32 v64, v64
    v_mfma_f32_16x16x32_bf16 v[68:71], a[144:147], v[192:195], v[104:107]
    v_add_f32 v84, v84, v64
    v_mfma_f32_16x16x32_bf16 v[68:71], a[148:151], v[196:199], v[68:71]
    v_exp_f32 v65, v65
    v_mfma_f32_16x16x32_bf16 v[68:71], a[152:155], v[200:203], v[68:71]
    v_cvt_pk_bf16_f32 v72, v64, v65
    v_add_f32 v84, v84, v65
    v_mfma_f32_16x16x32_bf16 v[68:71], a[156:159], v[204:207], v[68:71]
    s_add_u32 m0, s31, 32
    v_exp_f32 v66, v66
    v_mfma_f32_16x16x32_bf16 a[96:99], a[160:163], v[76:79], 0
    buffer_load_dwordx4 v122, s[16:19], s30 offen offset:1024 nt lds
    v_add_f32 v84, v84, v66
    v_mfma_f32_16x16x32_bf16 a[100:103], a[164:167], v[76:79], 0
    v_exp_f32 v67, v67
    v_mfma_f32_16x16x32_bf16 a[104:107], a[168:171], v[76:79], 0
    v_cvt_pk_bf16_f32 v73, v66, v67
    v_add_f32 v84, v84, v67
    v_mfma_f32_16x16x32_bf16 a[108:111], a[172:175], v[76:79], 0
    v_exp_f32 v68, v68
    v_mfma_f32_16x16x32_bf16 v[64:67], a[128:131], v[208:211], v[108:111]
    v_add_f32 v84, v84, v68
    v_mfma_f32_16x16x32_bf16 v[64:67], a[132:135], v[212:215], v[64:67]
    v_exp_f32 v69, v69
    v_mfma_f32_16x16x32_bf16 v[64:67], a[136:139], v[216:219], v[64:67]
    v_cvt_pk_bf16_f32 v74, v68, v69
    v_add_f32 v84, v84, v69
    v_mfma_f32_16x16x32_bf16 v[64:67], a[140:143], v[220:223], v[64:67]
    s_add_u32 m0, s31, 64
    v_exp_f32 v70, v70
    v_mfma_f32_16x16x32_bf16 a[112:115], a[176:179], v[76:79], 0
    buffer_load_dwordx4 v122, s[16:19], s30 offen offset:2048 nt lds
    v_add_f32 v84, v84, v70
    v_mfma_f32_16x16x32_bf16 a[116:119], a[180:183], v[76:79], 0
    v_exp_f32 v71, v71
    v_mfma_f32_16x16x32_bf16 a[120:123], a[184:187], v[76:79], 0
    v_cvt_pk_bf16_f32 v75, v70, v71
    v_add_f32 v84, v84, v71
    v_mfma_f32_16x16x32_bf16 a[124:127], a[188:191], v[76:79], 0
    v_exp_f32 v64, v64
    v_mfma_f32_16x16x32_bf16 v[68:71], a[144:147], v[208:211], v[108:111]
    v_add_f32 v85, v85, v64
    v_mfma_f32_16x16x32_bf16 v[68:71], a[148:151], v[212:215], v[68:71]
    v_exp_f32 v65, v65
    v_mfma_f32_16x16x32_bf16 v[68:71], a[152:155], v[216:219], v[68:71]
    v_cvt_pk_bf16_f32 v76, v64, v65
    v_add_f32 v85, v85, v65
    v_mfma_f32_16x16x32_bf16 v[68:71], a[156:159], v[220:223], v[68:71]
    v_exp_f32 v66, v66
    v_mfma_f32_16x16x32_bf16 v[0:3], a[160:163], v[72:75], 0
    v_add_f32 v85, v85, v66
    v_mfma_f32_16x16x32_bf16 v[4:7], a[164:167], v[72:75], 0
    v_exp_f32 v67, v67
    v_mfma_f32_16x16x32_bf16 v[8:11], a[168:171], v[72:75], 0
    v_cvt_pk_bf16_f32 v77, v66, v67
    v_add_f32 v85, v85, v67
    v_mfma_f32_16x16x32_bf16 v[12:15], a[172:175], v[72:75], 0
    v_exp_f32 v68, v68
    s_waitcnt vmcnt(7)
    v_add_u32 v64, s42, v120
    ds_read_b128 v[224:227], v64 offset:8448
    ds_read_b128 v[228:231], v64 offset:8512
    ds_read_b128 v[232:235], v64 offset:8576
    ds_read_b128 v[236:239], v64 offset:8640
    ds_read_b128 v[240:243], v64 offset:8960
    ds_read_b128 v[244:247], v64 offset:9024
    ds_read_b128 v[248:251], v64 offset:9088
    ds_read_b128 v[252:255], v64 offset:9152
    s_waitcnt lgkmcnt(0)
    s_add_u32 m0, s31, 96
    v_lshlrev_b32 v112, 16, v224
    buffer_load_dwordx4 v122, s[16:19], s30 offen offset:3072 nt lds
    v_and_b32 v113, 0xffff0000, v224
    v_lshlrev_b32 v114, 16, v225
    v_and_b32 v115, 0xffff0000, v225
    v_lshlrev_b32 v116, 16, v226
    v_and_b32 v117, 0xffff0000, v226
    v_lshlrev_b32 v118, 16, v227
    v_and_b32 v119, 0xffff0000, v227
    v_pk_mul_f32 v[112:113], v[112:113], s[34:35]
    v_pk_mul_f32 v[114:115], v[114:115], s[34:35]
    v_pk_mul_f32 v[116:117], v[116:117], s[34:35]
    v_pk_mul_f32 v[118:119], v[118:119], s[34:35]
    v_cvt_pk_bf16_f32 v224, v112, v113
    v_cvt_pk_bf16_f32 v225, v114, v115
    v_cvt_pk_bf16_f32 v226, v116, v117
    v_cvt_pk_bf16_f32 v227, v118, v119
    v_lshlrev_b32 v112, 16, v228
    v_and_b32 v113, 0xffff0000, v228
    v_lshlrev_b32 v114, 16, v229
    v_and_b32 v115, 0xffff0000, v229
    v_lshlrev_b32 v116, 16, v230
    v_and_b32 v117, 0xffff0000, v230
    v_lshlrev_b32 v118, 16, v231
    v_and_b32 v119, 0xffff0000, v231
    v_pk_mul_f32 v[112:113], v[112:113], s[34:35]
    v_pk_mul_f32 v[114:115], v[114:115], s[34:35]
    v_pk_mul_f32 v[116:117], v[116:117], s[34:35]
    v_pk_mul_f32 v[118:119], v[118:119], s[34:35]
    v_cvt_pk_bf16_f32 v228, v112, v113
    v_cvt_pk_bf16_f32 v229, v114, v115
    v_cvt_pk_bf16_f32 v230, v116, v117
    v_cvt_pk_bf16_f32 v231, v118, v119
    v_lshlrev_b32 v112, 16, v232
    v_and_b32 v113, 0xffff0000, v232
    v_lshlrev_b32 v114, 16, v233
    v_and_b32 v115, 0xffff0000, v233
    v_lshlrev_b32 v116, 16, v234
    v_and_b32 v117, 0xffff0000, v234
    v_lshlrev_b32 v118, 16, v235
    v_and_b32 v119, 0xffff0000, v235
    v_pk_mul_f32 v[112:113], v[112:113], s[34:35]
    v_pk_mul_f32 v[114:115], v[114:115], s[34:35]
    s_add_u32 m0, s32, 0
    v_pk_mul_f32 v[116:117], v[116:117], s[34:35]
    buffer_load_dwordx4 v122, s[20:23], s30 offen offset:0 nt lds
    v_pk_mul_f32 v[118:119], v[118:119], s[34:35]
    v_cvt_pk_bf16_f32 v232, v112, v113
    v_cvt_pk_bf16_f32 v233, v114, v115
    v_cvt_pk_bf16_f32 v234, v116, v117
    v_cvt_pk_bf16_f32 v235, v118, v119
    v_lshlrev_b32 v112, 16, v236
    v_and_b32 v113, 0xffff0000, v236
    v_lshlrev_b32 v114, 16, v237
    v_and_b32 v115, 0xffff0000, v237
    v_lshlrev_b32 v116, 16, v238
    v_and_b32 v117, 0xffff0000, v238
    v_lshlrev_b32 v118, 16, v239
    v_and_b32 v119, 0xffff0000, v239
    v_pk_mul_f32 v[112:113], v[112:113], s[34:35]
    v_pk_mul_f32 v[114:115], v[114:115], s[34:35]
    v_pk_mul_f32 v[116:117], v[116:117], s[34:35]
    v_pk_mul_f32 v[118:119], v[118:119], s[34:35]
    v_cvt_pk_bf16_f32 v236, v112, v113
    v_cvt_pk_bf16_f32 v237, v114, v115
    v_cvt_pk_bf16_f32 v238, v116, v117
    v_cvt_pk_bf16_f32 v239, v118, v119
    v_lshlrev_b32 v112, 16, v240
    v_and_b32 v113, 0xffff0000, v240
    v_lshlrev_b32 v114, 16, v241
    v_and_b32 v115, 0xffff0000, v241
    v_lshlrev_b32 v116, 16, v242
    v_and_b32 v117, 0xffff0000, v242
    v_lshlrev_b32 v118, 16, v243
    v_and_b32 v119, 0xffff0000, v243
    v_pk_mul_f32 v[112:113], v[112:113], s[34:35]
    v_pk_mul_f32 v[114:115], v[114:115], s[34:35]
    v_pk_mul_f32 v[116:117], v[116:117], s[34:35]
    v_pk_mul_f32 v[118:119], v[118:119], s[34:35]
    v_cvt_pk_bf16_f32 v240, v112, v113
    v_cvt_pk_bf16_f32 v241, v114, v115
    v_cvt_pk_bf16_f32 v242, v116, v117
    v_cvt_pk_bf16_f32 v243, v118, v119
    v_lshlrev_b32 v112, 16, v244
    v_and_b32 v113, 0xffff0000, v244
    v_lshlrev_b32 v114, 16, v245
    v_and_b32 v115, 0xffff0000, v245
    s_add_u32 m0, s32, 32
    v_lshlrev_b32 v116, 16, v246
    buffer_load_dwordx4 v122, s[20:23], s30 offen offset:1024 nt lds
    v_and_b32 v117, 0xffff0000, v246
    v_lshlrev_b32 v118, 16, v247
    v_and_b32 v119, 0xffff0000, v247
    v_pk_mul_f32 v[112:113], v[112:113], s[34:35]
    v_pk_mul_f32 v[114:115], v[114:115], s[34:35]
    v_pk_mul_f32 v[116:117], v[116:117], s[34:35]
    v_pk_mul_f32 v[118:119], v[118:119], s[34:35]
    v_cvt_pk_bf16_f32 v244, v112, v113
    v_cvt_pk_bf16_f32 v245, v114, v115
    v_cvt_pk_bf16_f32 v246, v116, v117
    v_cvt_pk_bf16_f32 v247, v118, v119
    v_lshlrev_b32 v112, 16, v248
    v_and_b32 v113, 0xffff0000, v248
    v_lshlrev_b32 v114, 16, v249
    v_and_b32 v115, 0xffff0000, v249
    v_lshlrev_b32 v116, 16, v250
    v_and_b32 v117, 0xffff0000, v250
    v_lshlrev_b32 v118, 16, v251
    v_and_b32 v119, 0xffff0000, v251
    v_pk_mul_f32 v[112:113], v[112:113], s[34:35]
    v_pk_mul_f32 v[114:115], v[114:115], s[34:35]
    v_pk_mul_f32 v[116:117], v[116:117], s[34:35]
    v_pk_mul_f32 v[118:119], v[118:119], s[34:35]
    v_cvt_pk_bf16_f32 v248, v112, v113
    v_cvt_pk_bf16_f32 v249, v114, v115
    v_cvt_pk_bf16_f32 v250, v116, v117
    v_cvt_pk_bf16_f32 v251, v118, v119
    v_lshlrev_b32 v112, 16, v252
    v_and_b32 v113, 0xffff0000, v252
    v_lshlrev_b32 v114, 16, v253
    v_and_b32 v115, 0xffff0000, v253
    v_lshlrev_b32 v116, 16, v254
    v_and_b32 v117, 0xffff0000, v254
    v_lshlrev_b32 v118, 16, v255
    v_and_b32 v119, 0xffff0000, v255
    v_pk_mul_f32 v[112:113], v[112:113], s[34:35]
    v_pk_mul_f32 v[114:115], v[114:115], s[34:35]
    v_pk_mul_f32 v[116:117], v[116:117], s[34:35]
    v_pk_mul_f32 v[118:119], v[118:119], s[34:35]
    v_cvt_pk_bf16_f32 v252, v112, v113
    v_cvt_pk_bf16_f32 v253, v114, v115
    v_cvt_pk_bf16_f32 v254, v116, v117
    v_cvt_pk_bf16_f32 v255, v118, v119
    v_mfma_f32_16x16x32_bf16 v[64:67], a[128:131], v[224:227], 0
    v_mfma_f32_16x16x32_bf16 v[64:67], a[132:135], v[228:231], v[64:67]
    v_mfma_f32_16x16x32_bf16 v[64:67], a[136:139], v[232:235], v[64:67]
    v_mfma_f32_16x16x32_bf16 v[64:67], a[140:143], v[236:239], v[64:67]
    v_mfma_f32_16x16x32_bf16 v[116:119], a[128:131], v[240:243], 0
    v_mfma_f32_16x16x32_bf16 v[116:119], a[132:135], v[244:247], v[116:119]
    v_mfma_f32_16x16x32_bf16 v[116:119], a[136:139], v[248:251], v[116:119]
    v_mfma_f32_16x16x32_bf16 v[116:119], a[140:143], v[252:255], v[116:119]
    s_nop 3
    v_max3_f32 v86, v64, v65, v66
    v_max_f32 v86, v86, v67
    s_nop 1
    v_max3_f32 v87, v116, v117, v118
    v_max_f32 v87, v87, v119
    s_nop 1
    v_permlane32_swap_b32 v86, v87
    v_max_f32 v86, v86, v87
    v_mov_b32 v87, v86
    s_nop 1
    v_permlane16_swap_b32 v86, v87
    v_max_f32 v86, v86, v87
    v_mov_b32 v87, v86
    s_nop 1
    v_permlane32_swap_b32 v86, v87
    v_sub_f32 v112, 0, v86
    v_sub_f32 v116, 0, v87
    v_sub_f32 v113, 0, v86
    v_sub_f32 v117, 0, v87
    v_sub_f32 v114, 0, v86
    v_sub_f32 v118, 0, v87
    v_sub_f32 v115, 0, v86
    v_sub_f32 v119, 0, v87
    v_mov_b32 v86, 0
    v_mov_b32 v87, 0
    s_cmp_eq_u32 s40, 0
    s_cbranch_scc1 L_ov5
    v_lshrrev_b32 v64, 2, v122
    s_lshl_b32 s36, s28, 11
    v_add_u32 v64, s36, v64
    v_add_u32 v64, 135168, v64
    ds_read_b32 v112, v64 offset:1536
    ds_read_b32 v116, v64 offset:1792
    s_waitcnt lgkmcnt(0)
    v_mov_b32 v113, v112
    v_mov_b32 v114, v112
    v_mov_b32 v115, v112
    v_mov_b32 v117, v116
    v_mov_b32 v118, v116
    v_mov_b32 v119, v116
L_ov5:
    s_waitcnt vmcnt(6)
    s_barrier
    v_mfma_f32_16x16x32_bf16 v[64:67], a[128:131], v[224:227], v[112:115]
    ds_read_b128 a[128:131], v120 offset:8448
    v_add_f32 v85, v85, v68
    v_mfma_f32_16x16x32_bf16 v[64:67], a[132:135], v[228:231], v[64:67]
    v_exp_f32 v69, v69
    v_mfma_f32_16x16x32_bf16 v[64:67], a[136:139], v[232:235], v[64:67]
    v_cvt_pk_bf16_f32 v78, v68, v69
    v_add_f32 v85, v85, v69
    v_mfma_f32_16x16x32_bf16 v[64:67], a[140:143], v[236:239], v[64:67]
    s_add_u32 m0, s32, 64
    v_exp_f32 v70, v70
    v_mfma_f32_16x16x32_bf16 v[16:19], a[176:179], v[72:75], 0
    ds_read_b128 a[132:135], v120 offset:8512
    buffer_load_dwordx4 v122, s[20:23], s30 offen offset:2048 nt lds
    v_add_f32 v85, v85, v70
    v_mfma_f32_16x16x32_bf16 v[20:23], a[180:183], v[72:75], 0
    ds_read_b128 a[136:139], v120 offset:8576
    v_exp_f32 v71, v71
    v_mfma_f32_16x16x32_bf16 v[24:27], a[184:187], v[72:75], 0
    v_cvt_pk_bf16_f32 v79, v70, v71
    v_add_f32 v85, v85, v71
    v_mfma_f32_16x16x32_bf16 v[28:31], a[188:191], v[72:75], 0
    v_exp_f32 v64, v64
    v_mfma_f32_16x16x32_bf16 v[68:71], a[144:147], v[224:227], v[112:115]
    ds_read_b128 a[140:143], v120 offset:8640
    v_add_f32 v86, v86, v64
    v_mfma_f32_16x16x32_bf16 v[68:71], a[148:151], v[228:231], v[68:71]
    v_exp_f32 v65, v65
    v_mfma_f32_16x16x32_bf16 v[68:71], a[152:155], v[232:235], v[68:71]
    v_cvt_pk_bf16_f32 v72, v64, v65
    v_add_f32 v86, v86, v65
    v_mfma_f32_16x16x32_bf16 v[68:71], a[156:159], v[236:239], v[68:71]
    s_add_u32 m0, s32, 96
    v_exp_f32 v66, v66
    v_mfma_f32_16x16x32_bf16 v[32:35], a[160:163], v[76:79], 0
    ds_read_b128 a[144:147], v120 offset:8960
    buffer_load_dwordx4 v122, s[20:23], s30 offen offset:3072 nt lds
    v_add_f32 v86, v86, v66
    v_mfma_f32_16x16x32_bf16 v[36:39], a[164:167], v[76:79], 0
    ds_read_b128 a[148:151], v120 offset:9024
    v_exp_f32 v67, v67
    v_mfma_f32_16x16x32_bf16 v[40:43], a[168:171], v[76:79], 0
    v_cvt_pk_bf16_f32 v73, v66, v67
    v_add_f32 v86, v86, v67
    v_mfma_f32_16x16x32_bf16 v[44:47], a[172:175], v[76:79], 0
    s_waitcnt lgkmcnt(5)
    v_exp_f32 v68, v68
    v_mfma_f32_16x16x32_bf16 v[64:67], a[128:131], v[128:131], v[88:91]
    s_waitcnt lgkmcnt(4)
    ds_read_b128 a[152:155], v120 offset:9088
    v_add_f32 v86, v86, v68
    v_mfma_f32_16x16x32_bf16 v[64:67], a[132:135], v[132:135], v[64:67]
    s_waitcnt lgkmcnt(4)
    s_lshl_b32 s30, s28, 12
    v_exp_f32 v69, v69
    v_mfma_f32_16x16x32_bf16 v[64:67], a[136:139], v[136:139], v[64:67]
    s_waitcnt lgkmcnt(3)
    s_add_u32 s30, s30, 32768
    v_cvt_pk_bf16_f32 v74, v68, v69
    v_add_f32 v86, v86, v69
    v_mfma_f32_16x16x32_bf16 v[64:67], a[140:143], v[140:143], v[64:67]
    s_mul_i32 s31, s28, 4224
    v_exp_f32 v70, v70
    v_mfma_f32_16x16x32_bf16 v[48:51], a[176:179], v[76:79], 0
    s_add_u32 s32, s31, 101376
    ds_read_b128 a[156:159], v120 offset:9152
    v_add_f32 v86, v86, v70
    v_mfma_f32_16x16x32_bf16 v[52:55], a[180:183], v[76:79], 0
    s_add_u32 s31, s31, 33792
    v_exp_f32 v71, v71
    v_mfma_f32_16x16x32_bf16 v[56:59], a[184:187], v[76:79], 0
    v_cvt_pk_bf16_f32 v75, v70, v71
    v_add_f32 v86, v86, v71
    v_mfma_f32_16x16x32_bf16 v[60:63], a[188:191], v[76:79], 0
    s_waitcnt lgkmcnt(3)
    s_add_u32 m0, s31, 0
    v_exp_f32 v64, v64
    v_mfma_f32_16x16x32_bf16 v[68:71], a[144:147], v[128:131], v[88:91]
    s_waitcnt lgkmcnt(2)
    buffer_load_dwordx4 v122, s[16:19], s30 offen offset:0 nt lds
    v_add_f32 v80, v80, v64
    v_mfma_f32_16x16x32_bf16 v[68:71], a[148:151], v[132:135], v[68:71]
    s_waitcnt lgkmcnt(1)
    v_exp_f32 v65, v65
    v_mfma_f32_16x16x32_bf16 v[68:71], a[152:155], v[136:139], v[68:71]
    s_waitcnt lgkmcnt(0)
    v_cvt_pk_bf16_f32 v76, v64, v65
    v_add_f32 v80, v80, v65
    v_mfma_f32_16x16x32_bf16 v[68:71], a[156:159], v[140:143], v[68:71]
    v_exp_f32 v66, v66
    v_mfma_f32_16x16x32_bf16 a[192:195], a[160:163], v[72:75], 0
    ds_read_b64_tr_b16 a[160:161], v121 offset:8448
    v_add_f32 v80, v80, v66
    v_mfma_f32_16x16x32_bf16 a[196:199], a[164:167], v[72:75], 0
    ds_read_b64_tr_b16 a[162:163], v121 offset:8960
    v_exp_f32 v67, v67
    v_mfma_f32_16x16x32_bf16 a[200:203], a[168:171], v[72:75], 0
    v_cvt_pk_bf16_f32 v77, v66, v67
    v_add_f32 v80, v80, v67
    v_mfma_f32_16x16x32_bf16 a[204:207], a[172:175], v[72:75], 0
    s_add_u32 m0, s31, 32
    ds_read_b64_tr_b16 a[164:165], v121 offset:8480
    v_exp_f32 v68, v68
    v_mfma_f32_16x16x32_bf16 v[64:67], a[128:131], v[144:147], v[92:95]
    ds_read_b64_tr_b16 a[166:167], v121 offset:8992
    buffer_load_dwordx4 v122, s[16:19], s30 offen offset:1024 nt lds
    v_add_f32 v80, v80, v68
    v_mfma_f32_16x16x32_bf16 v[64:67], a[132:135], v[148:151], v[64:67]
    ds_read_b64_tr_b16 a[168:169], v121 offset:8512
    v_exp_f32 v69, v69
    v_mfma_f32_16x16x32_bf16 v[64:67], a[136:139], v[152:155], v[64:67]
    v_cvt_pk_bf16_f32 v78, v68, v69
    v_add_f32 v80, v80, v69
    v_mfma_f32_16x16x32_bf16 v[64:67], a[140:143], v[156:159], v[64:67]
    ds_read_b64_tr_b16 a[170:171], v121 offset:9024
    v_exp_f32 v70, v70
    v_mfma_f32_16x16x32_bf16 a[208:211], a[176:179], v[72:75], 0
    ds_read_b64_tr_b16 a[172:173], v121 offset:8544
    v_add_f32 v80, v80, v70
    v_mfma_f32_16x16x32_bf16 a[212:215], a[180:183], v[72:75], 0
    ds_read_b64_tr_b16 a[174:175], v121 offset:9056
    v_exp_f32 v71, v71
    v_mfma_f32_16x16x32_bf16 a[216:219], a[184:187], v[72:75], 0
    v_cvt_pk_bf16_f32 v79, v70, v71
    v_add_f32 v80, v80, v71
    v_mfma_f32_16x16x32_bf16 a[220:223], a[188:191], v[72:75], 0
    s_add_u32 m0, s31, 64
    ds_read_b64_tr_b16 a[176:177], v121 offset:8576
    v_exp_f32 v64, v64
    v_mfma_f32_16x16x32_bf16 v[68:71], a[144:147], v[144:147], v[92:95]
    ds_read_b64_tr_b16 a[178:179], v121 offset:9088
    buffer_load_dwordx4 v122, s[16:19], s30 offen offset:2048 nt lds
    v_add_f32 v81, v81, v64
    v_mfma_f32_16x16x32_bf16 v[68:71], a[148:151], v[148:151], v[68:71]
    ds_read_b64_tr_b16 a[180:181], v121 offset:8608
    v_exp_f32 v65, v65
    v_mfma_f32_16x16x32_bf16 v[68:71], a[152:155], v[152:155], v[68:71]
    v_cvt_pk_bf16_f32 v72, v64, v65
    v_add_f32 v81, v81, v65
    v_mfma_f32_16x16x32_bf16 v[68:71], a[156:159], v[156:159], v[68:71]
    s_waitcnt lgkmcnt(9)
    ds_read_b64_tr_b16 a[182:183], v121 offset:9120
    v_exp_f32 v66, v66
    v_mfma_f32_16x16x32_bf16 a[0:3], a[160:163], v[76:79], a[0:3]
    s_waitcnt lgkmcnt(8)
    ds_read_b64_tr_b16 a[184:185], v121 offset:8640
    v_add_f32 v81, v81, v66
    v_mfma_f32_16x16x32_bf16 a[4:7], a[164:167], v[76:79], a[4:7]
    s_waitcnt lgkmcnt(7)
    ds_read_b64_tr_b16 a[186:187], v121 offset:9152
    v_exp_f32 v67, v67
    v_mfma_f32_16x16x32_bf16 a[8:11], a[168:171], v[76:79], a[8:11]
    s_waitcnt lgkmcnt(6)
    v_cvt_pk_bf16_f32 v73, v66, v67
    v_add_f32 v81, v81, v67
    v_mfma_f32_16x16x32_bf16 a[12:15], a[172:175], v[76:79], a[12:15]
    s_add_u32 m0, s31, 96
    ds_read_b64_tr_b16 a[188:189], v121 offset:8672
    v_exp_f32 v68, v68
    v_mfma_f32_16x16x32_bf16 v[64:67], a[128:131], v[160:163], v[96:99]
    ds_read_b64_tr_b16 a[190:191], v121 offset:9184
    buffer_load_dwordx4 v122, s[16:19], s30 offen offset:3072 nt lds
    v_add_f32 v81, v81, v68
    v_mfma_f32_16x16x32_bf16 v[64:67], a[132:135], v[164:167], v[64:67]
    v_exp_f32 v69, v69
    v_mfma_f32_16x16x32_bf16 v[64:67], a[136:139], v[168:171], v[64:67]
    v_cvt_pk_bf16_f32 v74, v68, v69
    v_add_f32 v81, v81, v69
    v_mfma_f32_16x16x32_bf16 v[64:67], a[140:143], v[172:175], v[64:67]
    s_waitcnt lgkmcnt(6)
    v_exp_f32 v70, v70
    v_mfma_f32_16x16x32_bf16 a[16:19], a[176:179], v[76:79], a[16:19]
    s_waitcnt lgkmcnt(4)
    v_add_f32 v81, v81, v70
    v_mfma_f32_16x16x32_bf16 a[20:23], a[180:183], v[76:79], a[20:23]
    s_waitcnt lgkmcnt(2)
    v_exp_f32 v71, v71
    v_mfma_f32_16x16x32_bf16 a[24:27], a[184:187], v[76:79], a[24:27]
    s_waitcnt lgkmcnt(0)
    v_cvt_pk_bf16_f32 v75, v70, v71
    v_add_f32 v81, v81, v71
    v_mfma_f32_16x16x32_bf16 a[28:31], a[188:191], v[76:79], a[28:31]
    s_add_u32 m0, s32, 0
    v_exp_f32 v64, v64
    v_mfma_f32_16x16x32_bf16 v[68:71], a[144:147], v[160:163], v[96:99]
    buffer_load_dwordx4 v122, s[20:23], s30 offen offset:0 nt lds
    v_add_f32 v82, v82, v64
    v_mfma_f32_16x16x32_bf16 v[68:71], a[148:151], v[164:167], v[68:71]
    v_exp_f32 v65, v65
    v_mfma_f32_16x16x32_bf16 v[68:71], a[152:155], v[168:171], v[68:71]
    v_cvt_pk_bf16_f32 v76, v64, v65
    v_add_f32 v82, v82, v65
    v_mfma_f32_16x16x32_bf16 v[68:71], a[156:159], v[172:175], v[68:71]
    v_exp_f32 v66, v66
    v_mfma_f32_16x16x32_bf16 a[32:35], a[160:163], v[72:75], a[32:35]
    v_add_f32 v82, v82, v66
    v_mfma_f32_16x16x32_bf16 a[36:39], a[164:167], v[72:75], a[36:39]
    v_exp_f32 v67, v67
    v_mfma_f32_16x16x32_bf16 a[40:43], a[168:171], v[72:75], a[40:43]
    v_cvt_pk_bf16_f32 v77, v66, v67
    v_add_f32 v82, v82, v67
    v_mfma_f32_16x16x32_bf16 a[44:47], a[172:175], v[72:75], a[44:47]
    s_add_u32 m0, s32, 32
    v_exp_f32 v68, v68
    v_mfma_f32_16x16x32_bf16 v[64:67], a[128:131], v[176:179], v[100:103]
    buffer_load_dwordx4 v122, s[20:23], s30 offen offset:1024 nt lds
    v_add_f32 v82, v82, v68
    v_mfma_f32_16x16x32_bf16 v[64:67], a[132:135], v[180:183], v[64:67]
    v_exp_f32 v69, v69
    v_mfma_f32_16x16x32_bf16 v[64:67], a[136:139], v[184:187], v[64:67]
    v_cvt_pk_bf16_f32 v78, v68, v69
    v_add_f32 v82, v82, v69
    v_mfma_f32_16x16x32_bf16 v[64:67], a[140:143], v[188:191], v[64:67]
    v_exp_f32 v70, v70
    v_mfma_f32_16x16x32_bf16 a[48:51], a[176:179], v[72:75], a[48:51]
    v_add_f32 v82, v82, v70
    v_mfma_f32_16x16x32_bf16 a[52:55], a[180:183], v[72:75], a[52:55]
    v_exp_f32 v71, v71
    v_mfma_f32_16x16x32_bf16 a[56:59], a[184:187], v[72:75], a[56:59]
    v_cvt_pk_bf16_f32 v79, v70, v71
    v_add_f32 v82, v82, v71
    v_mfma_f32_16x16x32_bf16 a[60:63], a[188:191], v[72:75], a[60:63]
    s_add_u32 m0, s32, 64
    v_exp_f32 v64, v64
    v_mfma_f32_16x16x32_bf16 v[68:71], a[144:147], v[176:179], v[100:103]
    buffer_load_dwordx4 v122, s[20:23], s30 offen offset:2048 nt lds
    v_add_f32 v83, v83, v64
    v_mfma_f32_16x16x32_bf16 v[68:71], a[148:151], v[180:183], v[68:71]
    v_exp_f32 v65, v65
    v_mfma_f32_16x16x32_bf16 v[68:71], a[152:155], v[184:187], v[68:71]
    v_cvt_pk_bf16_f32 v72, v64, v65
    v_add_f32 v83, v83, v65
    v_mfma_f32_16x16x32_bf16 v[68:71], a[156:159], v[188:191], v[68:71]
    v_exp_f32 v66, v66
    v_mfma_f32_16x16x32_bf16 a[64:67], a[160:163], v[76:79], a[64:67]
    v_add_f32 v83, v83, v66
    v_mfma_f32_16x16x32_bf16 a[68:71], a[164:167], v[76:79], a[68:71]
    v_exp_f32 v67, v67
    v_mfma_f32_16x16x32_bf16 a[72:75], a[168:171], v[76:79], a[72:75]
    v_cvt_pk_bf16_f32 v73, v66, v67
    v_add_f32 v83, v83, v67
    v_mfma_f32_16x16x32_bf16 a[76:79], a[172:175], v[76:79], a[76:79]
    s_add_u32 m0, s32, 96
    v_exp_f32 v68, v68
    v_mfma_f32_16x16x32_bf16 v[64:67], a[128:131], v[192:195], v[104:107]
    buffer_load_dwordx4 v122, s[20:23], s30 offen offset:3072 nt lds
    v_add_f32 v83, v83, v68
    v_mfma_f32_16x16x32_bf16 v[64:67], a[132:135], v[196:199], v[64:67]
    v_exp_f32 v69, v69
    v_mfma_f32_16x16x32_bf16 v[64:67], a[136:139], v[200:203], v[64:67]
    v_cvt_pk_bf16_f32 v74, v68, v69
    v_add_f32 v83, v83, v69
    v_mfma_f32_16x16x32_bf16 v[64:67], a[140:143], v[204:207], v[64:67]
    v_exp_f32 v70, v70
    v_mfma_f32_16x16x32_bf16 a[80:83], a[176:179], v[76:79], a[80:83]
    v_add_f32 v83, v83, v70
    v_mfma_f32_16x16x32_bf16 a[84:87], a[180:183], v[76:79], a[84:87]
    v_exp_f32 v71, v71
    v_mfma_f32_16x16x32_bf16 a[88:91], a[184:187], v[76:79], a[88:91]
    v_cvt_pk_bf16_f32 v75, v70, v71
    v_add_f32 v83, v83, v71
    v_mfma_f32_16x16x32_bf16 a[92:95], a[188:191], v[76:79], a[92:95]
    v_exp_f32 v64, v64
    v_mfma_f32_16x16x32_bf16 v[68:71], a[144:147], v[192:195], v[104:107]
    v_add_f32 v84, v84, v64
    v_mfma_f32_16x16x32_bf16 v[68:71], a[148:151], v[196:199], v[68:71]
    v_exp_f32 v65, v65
    v_mfma_f32_16x16x32_bf16 v[68:71], a[152:155], v[200:203], v[68:71]
    v_cvt_pk_bf16_f32 v76, v64, v65
    v_add_f32 v84, v84, v65
    v_mfma_f32_16x16x32_bf16 v[68:71], a[156:159], v[204:207], v[68:71]
    v_exp_f32 v66, v66
    v_mfma_f32_16x16x32_bf16 a[96:99], a[160:163], v[72:75], a[96:99]
    v_add_f32 v84, v84, v66
    v_mfma_f32_16x16x32_bf16 a[100:103], a[164:167], v[72:75], a[100:103]
    v_exp_f32 v67, v67
    v_mfma_f32_16x16x32_bf16 a[104:107], a[168:171], v[72:75], a[104:107]
    v_cvt_pk_bf16_f32 v77, v66, v67
    v_add_f32 v84, v84, v67
    v_mfma_f32_16x16x32_bf16 a[108:111], a[172:175], v[72:75], a[108:111]
    v_exp_f32 v68, v68
    v_mfma_f32_16x16x32_bf16 v[64:67], a[128:131], v[208:211], v[108:111]
    v_add_f32 v84, v84, v68
    v_mfma_f32_16x16x32_bf16 v[64:67], a[132:135], v[212:215], v[64:67]
    v_exp_f32 v69, v69
    v_mfma_f32_16x16x32_bf16 v[64:67], a[136:139], v[216:219], v[64:67]
    v_cvt_pk_bf16_f32 v78, v68, v69
    v_add_f32 v84, v84, v69
    v_mfma_f32_16x16x32_bf16 v[64:67], a[140:143], v[220:223], v[64:67]
    v_exp_f32 v70, v70
    v_mfma_f32_16x16x32_bf16 a[112:115], a[176:179], v[72:75], a[112:115]
    v_add_f32 v84, v84, v70
    v_mfma_f32_16x16x32_bf16 a[116:119], a[180:183], v[72:75], a[116:119]
    v_exp_f32 v71, v71
    v_mfma_f32_16x16x32_bf16 a[120:123], a[184:187], v[72:75], a[120:123]
    v_cvt_pk_bf16_f32 v79, v70, v71
    v_add_f32 v84, v84, v71
    v_mfma_f32_16x16x32_bf16 a[124:127], a[188:191], v[72:75], a[124:127]
    v_exp_f32 v64, v64
    v_mfma_f32_16x16x32_bf16 v[68:71], a[144:147], v[208:211], v[108:111]
    v_add_f32 v85, v85, v64
    v_mfma_f32_16x16x32_bf16 v[68:71], a[148:151], v[212:215], v[68:71]
    v_exp_f32 v65, v65
    v_mfma_f32_16x16x32_bf16 v[68:71], a[152:155], v[216:219], v[68:71]
    v_cvt_pk_bf16_f32 v72, v64, v65
    v_add_f32 v85, v85, v65
    v_mfma_f32_16x16x32_bf16 v[68:71], a[156:159], v[220:223], v[68:71]
    v_exp_f32 v66, v66
    v_mfma_f32_16x16x32_bf16 v[0:3], a[160:163], v[76:79], v[0:3]
    v_add_f32 v85, v85, v66
    v_mfma_f32_16x16x32_bf16 v[4:7], a[164:167], v[76:79], v[4:7]
    v_exp_f32 v67, v67
    v_mfma_f32_16x16x32_bf16 v[8:11], a[168:171], v[76:79], v[8:11]
    s_waitcnt vmcnt(8)
    v_cvt_pk_bf16_f32 v73, v66, v67
    v_add_f32 v85, v85, v67
    v_mfma_f32_16x16x32_bf16 v[12:15], a[172:175], v[76:79], v[12:15]
    s_barrier
    v_exp_f32 v68, v68
    v_mfma_f32_16x16x32_bf16 v[64:67], a[128:131], v[224:227], v[112:115]
    ds_read_b128 a[128:131], v120 offset:16896
    v_add_f32 v85, v85, v68
    v_mfma_f32_16x16x32_bf16 v[64:67], a[132:135], v[228:231], v[64:67]
    v_exp_f32 v69, v69
    v_mfma_f32_16x16x32_bf16 v[64:67], a[136:139], v[232:235], v[64:67]
    v_cvt_pk_bf16_f32 v74, v68, v69
    v_add_f32 v85, v85, v69
    v_mfma_f32_16x16x32_bf16 v[64:67], a[140:143], v[236:239], v[64:67]
    v_exp_f32 v70, v70
    v_mfma_f32_16x16x32_bf16 v[16:19], a[176:179], v[76:79], v[16:19]
    ds_read_b128 a[132:135], v120 offset:16960
    v_add_f32 v85, v85, v70
    v_mfma_f32_16x16x32_bf16 v[20:23], a[180:183], v[76:79], v[20:23]
    ds_read_b128 a[136:139], v120 offset:17024
    v_exp_f32 v71, v71
    v_mfma_f32_16x16x32_bf16 v[24:27], a[184:187], v[76:79], v[24:27]
    v_cvt_pk_bf16_f32 v75, v70, v71
    v_add_f32 v85, v85, v71
    v_mfma_f32_16x16x32_bf16 v[28:31], a[188:191], v[76:79], v[28:31]
    v_exp_f32 v64, v64
    v_mfma_f32_16x16x32_bf16 v[68:71], a[144:147], v[224:227], v[112:115]
    s_mov_b32 s31, 50688
    ds_read_b128 a[140:143], v120 offset:17088
    v_add_f32 v86, v86, v64
    v_add_u32 v121, s41, v121
    v_mfma_f32_16x16x32_bf16 v[68:71], a[148:151], v[228:231], v[68:71]
    s_mov_b32 s32, 118272
    v_exp_f32 v65, v65
    v_mfma_f32_16x16x32_bf16 v[68:71], a[152:155], v[232:235], v[68:71]
    s_mov_b32 s52, 49152
    v_cvt_pk_bf16_f32 v76, v64, v65
    v_add_f32 v86, v86, v65
    v_mfma_f32_16x16x32_bf16 v[68:71], a[156:159], v[236:239], v[68:71]
    s_mov_b32 s53, 53248
    v_exp_f32 v66, v66
    v_mfma_f32_16x16x32_bf16 v[32:35], a[160:163], v[72:75], v[32:35]
    s_mov_b32 s54, 57344
    ds_read_b128 a[144:147], v120 offset:17408
    v_add_f32 v86, v86, v66
    v_mfma_f32_16x16x32_bf16 v[36:39], a[164:167], v[72:75], v[36:39]
    s_mov_b32 s55, 61440
    ds_read_b128 a[148:151], v120 offset:17472
    v_exp_f32 v67, v67
    v_mfma_f32_16x16x32_bf16 v[40:43], a[168:171], v[72:75], v[40:43]
    s_mov_b32 s29, 1
    v_cvt_pk_bf16_f32 v77, v66, v67
    v_add_f32 v86, v86, v67
    v_mfma_f32_16x16x32_bf16 v[44:47], a[172:175], v[72:75], v[44:47]
    s_waitcnt lgkmcnt(5)
    v_exp_f32 v68, v68
    v_add_u32 v120, s41, v120
.p2align 6
L_loopb:
    v_mfma_f32_16x16x32_bf16 v[64:67], a[128:131], v[128:131], v[88:91]
    s_waitcnt lgkmcnt(4)
    ds_read_b128 a[152:155], v120 offset:640
    v_add_f32 v86, v86, v68
    v_mfma_f32_16x16x32_bf16 v[64:67], a[132:135], v[132:135], v[64:67]
    s_waitcnt lgkmcnt(4)
    v_exp_f32 v69, v69
    v_mfma_f32_16x16x32_bf16 v[64:67], a[136:139], v[136:139], v[64:67]
    s_waitcnt lgkmcnt(3)
    v_cvt_pk_bf16_f32 v78, v68, v69
    v_add_f32 v86, v86, v69
    v_mfma_f32_16x16x32_bf16 v[64:67], a[140:143], v[140:143], v[64:67]
    s_add_u32 m0, s31, 0
    v_exp_f32 v70, v70
    v_mfma_f32_16x16x32_bf16 v[48:51], a[176:179], v[72:75], v[48:51]
    ds_read_b128 a[156:159], v120 offset:704
    buffer_load_dwordx4 v122, s[16:19], s52 offen offset:0 nt lds
    v_add_f32_e64 v86, v86, v70
    v_mfma_f32_16x16x32_bf16 v[52:55], a[180:183], v[72:75], v[52:55]
    v_exp_f32_e64 v71, v71
    v_mfma_f32_16x16x32_bf16 v[56:59], a[184:187], v[72:75], v[56:59]
    v_cvt_pk_bf16_f32 v79, v70, v71
    v_add_f32_e64 v86, v86, v71
    v_mfma_f32_16x16x32_bf16 v[60:63], a[188:191], v[72:75], v[60:63]
    s_waitcnt lgkmcnt(3)
    v_exp_f32 v64, v64
    v_mfma_f32_16x16x32_bf16 v[68:71], a[144:147], v[128:131], v[88:91]
    s_waitcnt lgkmcnt(2)
    v_add_f32 v80, v80, v64
    v_mfma_f32_16x16x32_bf16 v[68:71], a[148:151], v[132:135], v[68:71]
    s_waitcnt lgkmcnt(1)
    s_add_u32 m0, s31, 32
    v_exp_f32_e64 v65, v65
    v_mfma_f32_16x16x32_bf16 v[68:71], a[152:155], v[136:139], v[68:71]
    s_waitcnt lgkmcnt(0)
    buffer_load_dwordx4 v122, s[16:19], s52 offen offset:1024 nt lds
    v_cvt_pk_bf16_f32 v72, v64, v65
    v_add_f32 v80, v80, v65
    v_mfma_f32_16x16x32_bf16 v[68:71], a[156:159], v[140:143], v[68:71]
    v_exp_f32_e64 v66, v66
    v_mfma_f32_16x16x32_bf16 a[192:195], a[160:163], v[76:79], a[192:195]
    ds_read_b64_tr_b16 a[160:161], v121 offset:0
    v_add_f32_e64 v80, v80, v66
    v_mfma_f32_16x16x32_bf16 a[196:199], a[164:167], v[76:79], a[196:199]
    ds_read_b64_tr_b16 a[162:163], v121 offset:512
    v_exp_f32_e64 v67, v67
    v_mfma_f32_16x16x32_bf16 a[200:203], a[168:171], v[76:79], a[200:203]
    v_cvt_pk_bf16_f32 v73, v66, v67
    v_add_f32_e64 v80, v80, v67
    v_mfma_f32_16x16x32_bf16 a[204:207], a[172:175], v[76:79], a[204:207]
    s_add_u32 m0, s31, 64
    ds_read_b64_tr_b16 a[164:165], v121 offset:32
    v_exp_f32 v68, v68
    v_mfma_f32_16x16x32_bf16 v[64:67], a[128:131], v[144:147], v[92:95]
    ds_read_b64_tr_b16 a[166:167], v121 offset:544
    buffer_load_dwordx4 v122, s[16:19], s52 offen offset:2048 nt lds
    v_add_f32_e64 v80, v80, v68
    v_mfma_f32_16x16x32_bf16 v[64:67], a[132:135], v[148:151], v[64:67]
    ds_read_b64_tr_b16 a[168:169], v121 offset:64
    v_exp_f32_e64 v69, v69
    v_mfma_f32_16x16x32_bf16 v[64:67], a[136:139], v[152:155], v[64:67]
    v_cvt_pk_bf16_f32 v74, v68, v69
    v_add_f32_e64 v80, v80, v69
    v_mfma_f32_16x16x32_bf16 v[64:67], a[140:143], v[156:159], v[64:67]
    ds_read_b64_tr_b16 a[170:171], v121 offset:576
    v_exp_f32_e64 v70, v70
    v_mfma_f32_16x16x32_bf16 a[208:211], a[176:179], v[76:79], a[208:211]
    ds_read_b64_tr_b16 a[172:173], v121 offset:96
    v_add_f32_e64 v80, v80, v70
    v_mfma_f32_16x16x32_bf16 a[212:215], a[180:183], v[76:79], a[212:215]
    s_add_u32 m0, s31, 96
    ds_read_b64_tr_b16 a[174:175], v121 offset:608
    v_exp_f32_e64 v71, v71
    v_mfma_f32_16x16x32_bf16 a[216:219], a[184:187], v[76:79], a[216:219]
    buffer_load_dwordx4 v122, s[16:19], s52 offen offset:3072 nt lds
    v_cvt_pk_bf16_f32 v75, v70, v71
    v_add_f32_e64 v80, v80, v71
    v_mfma_f32_16x16x32_bf16 a[220:223], a[188:191], v[76:79], a[220:223]
    ds_read_b64_tr_b16 a[176:177], v121 offset:128
    v_exp_f32_e64 v64, v64
    v_mfma_f32_16x16x32_bf16 v[68:71], a[144:147], v[144:147], v[92:95]
    ds_read_b64_tr_b16 a[178:179], v121 offset:640
    v_add_f32_e64 v81, v81, v64
    v_mfma_f32_16x16x32_bf16 v[68:71], a[148:151], v[148:151], v[68:71]
    ds_read_b64_tr_b16 a[180:181], v121 offset:160
    v_exp_f32_e64 v65, v65
    v_mfma_f32_16x16x32_bf16 v[68:71], a[152:155], v[152:155], v[68:71]
    v_cvt_pk_bf16_f32 v76, v64, v65
    v_add_f32_e64 v81, v81, v65
    v_mfma_f32_16x16x32_bf16 v[68:71], a[156:159], v[156:159], v[68:71]
    s_waitcnt lgkmcnt(9)
    s_add_u32 m0, s31, 4224
    ds_read_b64_tr_b16 a[182:183], v121 offset:672
    v_exp_f32 v66, v66
    v_mfma_f32_16x16x32_bf16 a[0:3], a[160:163], v[72:75], a[0:3]
    s_waitcnt lgkmcnt(8)
    ds_read_b64_tr_b16 a[184:185], v121 offset:192
    buffer_load_dwordx4 v122, s[16:19], s53 offen offset:0 nt lds
    v_add_f32 v81, v81, v66
    v_mfma_f32_16x16x32_bf16 a[4:7], a[164:167], v[72:75], a[4:7]
    s_waitcnt lgkmcnt(7)
    ds_read_b64_tr_b16 a[186:187], v121 offset:704
    v_exp_f32 v67, v67
    v_mfma_f32_16x16x32_bf16 a[8:11], a[168:171], v[72:75], a[8:11]
    s_waitcnt lgkmcnt(6)
    v_cvt_pk_bf16_f32 v77, v66, v67
    v_add_f32 v81, v81, v67
    v_mfma_f32_16x16x32_bf16 a[12:15], a[172:175], v[72:75], a[12:15]
    ds_read_b64_tr_b16 a[188:189], v121 offset:224
    v_exp_f32_e64 v68, v68
    v_mfma_f32_16x16x32_bf16 v[64:67], a[128:131], v[160:163], v[96:99]
    ds_read_b64_tr_b16 a[190:191], v121 offset:736
    v_add_f32_e64 v81, v81, v68
    v_mfma_f32_16x16x32_bf16 v[64:67], a[132:135], v[164:167], v[64:67]
    s_add_u32 m0, s31, 4256
    v_exp_f32_e64 v69, v69
    v_mfma_f32_16x16x32_bf16 v[64:67], a[136:139], v[168:171], v[64:67]
    buffer_load_dwordx4 v122, s[16:19], s53 offen offset:1024 nt lds
    v_cvt_pk_bf16_f32 v78, v68, v69
    v_add_f32_e64 v81, v81, v69
    v_mfma_f32_16x16x32_bf16 v[64:67], a[140:143], v[172:175], v[64:67]
    s_waitcnt lgkmcnt(6)
    v_exp_f32 v70, v70
    v_mfma_f32_16x16x32_bf16 a[16:19], a[176:179], v[72:75], a[16:19]
    s_waitcnt lgkmcnt(4)
    v_add_f32 v81, v81, v70
    v_mfma_f32_16x16x32_bf16 a[20:23], a[180:183], v[72:75], a[20:23]
    s_waitcnt lgkmcnt(2)
    v_exp_f32 v71, v71
    v_mfma_f32_16x16x32_bf16 a[24:27], a[184:187], v[72:75], a[24:27]
    s_waitcnt lgkmcnt(0)
    v_cvt_pk_bf16_f32 v79, v70, v71
    v_add_f32 v81, v81, v71
    v_mfma_f32_16x16x32_bf16 a[28:31], a[188:191], v[72:75], a[28:31]
    s_add_u32 m0, s31, 4288
    v_exp_f32_e64 v64, v64
    v_mfma_f32_16x16x32_bf16 v[68:71], a[144:147], v[160:163], v[96:99]
    buffer_load_dwordx4 v122, s[16:19], s53 offen offset:2048 nt lds
    v_add_f32_e64 v82, v82, v64
    v_mfma_f32_16x16x32_bf16 v[68:71], a[148:151], v[164:167], v[68:71]
    v_exp_f32_e64 v65, v65
    v_mfma_f32_16x16x32_bf16 v[68:71], a[152:155], v[168:171], v[68:71]
    v_cvt_pk_bf16_f32 v72, v64, v65
    v_add_f32_e64 v82, v82, v65
    v_mfma_f32_16x16x32_bf16 v[68:71], a[156:159], v[172:175], v[68:71]
    v_exp_f32_e64 v66, v66
    v_mfma_f32_16x16x32_bf16 a[32:35], a[160:163], v[76:79], a[32:35]
    v_add_f32_e64 v82, v82, v66
    v_mfma_f32_16x16x32_bf16 a[36:39], a[164:167], v[76:79], a[36:39]
    s_add_u32 m0, s31, 4320
    v_exp_f32_e64 v67, v67
    v_mfma_f32_16x16x32_bf16 a[40:43], a[168:171], v[76:79], a[40:43]
    buffer_load_dwordx4 v122, s[16:19], s53 offen offset:3072 nt lds
    v_cvt_pk_bf16_f32 v73, v66, v67
    v_add_f32_e64 v82, v82, v67
    v_mfma_f32_16x16x32_bf16 a[44:47], a[172:175], v[76:79], a[44:47]
    v_exp_f32_e64 v68, v68
    v_mfma_f32_16x16x32_bf16 v[64:67], a[128:131], v[176:179], v[100:103]
    v_add_f32_e64 v82, v82, v68
    v_mfma_f32_16x16x32_bf16 v[64:67], a[132:135], v[180:183], v[64:67]
    v_exp_f32_e64 v69, v69
    v_mfma_f32_16x16x32_bf16 v[64:67], a[136:139], v[184:187], v[64:67]
    v_cvt_pk_bf16_f32 v74, v68, v69
    v_add_f32_e64 v82, v82, v69
    v_mfma_f32_16x16x32_bf16 v[64:67], a[140:143], v[188:191], v[64:67]
    s_add_u32 m0, s31, 8448
    v_exp_f32_e64 v70, v70
    v_mfma_f32_16x16x32_bf16 a[48:51], a[176:179], v[76:79], a[48:51]
    buffer_load_dwordx4 v122, s[16:19], s54 offen offset:0 nt lds
    v_add_f32_e64 v82, v82, v70
    v_mfma_f32_16x16x32_bf16 a[52:55], a[180:183], v[76:79], a[52:55]
    v_exp_f32_e64 v71, v71
    v_mfma_f32_16x16x32_bf16 a[56:59], a[184:187], v[76:79], a[56:59]
    v_cvt_pk_bf16_f32 v75, v70, v71
    v_add_f32_e64 v82, v82, v71
    v_mfma_f32_16x16x32_bf16 a[60:63], a[188:191], v[76:79], a[60:63]
    v_exp_f32_e64 v64, v64
    v_mfma_f32_16x16x32_bf16 v[68:71], a[144:147], v[176:179], v[100:103]
    v_add_f32_e64 v83, v83, v64
    v_mfma_f32_16x16x32_bf16 v[68:71], a[148:151], v[180:183], v[68:71]
    s_add_u32 m0, s31, 8480
    v_exp_f32_e64 v65, v65
    v_mfma_f32_16x16x32_bf16 v[68:71], a[152:155], v[184:187], v[68:71]
    buffer_load_dwordx4 v122, s[16:19], s54 offen offset:1024 nt lds
    v_cvt_pk_bf16_f32 v76, v64, v65
    v_add_f32_e64 v83, v83, v65
    v_mfma_f32_16x16x32_bf16 v[68:71], a[156:159], v[188:191], v[68:71]
    v_exp_f32_e64 v66, v66
    v_mfma_f32_16x16x32_bf16 a[64:67], a[160:163], v[72:75], a[64:67]
    v_add_f32_e64 v83, v83, v66
    v_mfma_f32_16x16x32_bf16 a[68:71], a[164:167], v[72:75], a[68:71]
    v_exp_f32_e64 v67, v67
    v_mfma_f32_16x16x32_bf16 a[72:75], a[168:171], v[72:75], a[72:75]
    v_cvt_pk_bf16_f32 v77, v66, v67
    v_add_f32_e64 v83, v83, v67
    v_mfma_f32_16x16x32_bf16 a[76:79], a[172:175], v[72:75], a[76:79]
    s_add_u32 m0, s31, 8512
    v_exp_f32_e64 v68, v68
    v_mfma_f32_16x16x32_bf16 v[64:67], a[128:131], v[192:195], v[104:107]
    buffer_load_dwordx4 v122, s[16:19], s54 offen offset:2048 nt lds
    v_add_f32_e64 v83, v83, v68
    v_mfma_f32_16x16x32_bf16 v[64:67], a[132:135], v[196:199], v[64:67]
    v_exp_f32_e64 v69, v69
    v_mfma_f32_16x16x32_bf16 v[64:67], a[136:139], v[200:203], v[64:67]
    v_cvt_pk_bf16_f32 v78, v68, v69
    v_add_f32_e64 v83, v83, v69
    v_mfma_f32_16x16x32_bf16 v[64:67], a[140:143], v[204:207], v[64:67]
    v_exp_f32_e64 v70, v70
    v_mfma_f32_16x16x32_bf16 a[80:83], a[176:179], v[72:75], a[80:83]
    v_add_f32_e64 v83, v83, v70
    v_mfma_f32_16x16x32_bf16 a[84:87], a[180:183], v[72:75], a[84:87]
    s_add_u32 m0, s31, 8544
    v_exp_f32_e64 v71, v71
    v_mfma_f32_16x16x32_bf16 a[88:91], a[184:187], v[72:75], a[88:91]
    buffer_load_dwordx4 v122, s[16:19], s54 offen offset:3072 nt lds
    v_cvt_pk_bf16_f32 v79, v70, v71
    v_add_f32_e64 v83, v83, v71
    v_mfma_f32_16x16x32_bf16 a[92:95], a[188:191], v[72:75], a[92:95]
    v_exp_f32_e64 v64, v64
    v_mfma_f32_16x16x32_bf16 v[68:71], a[144:147], v[192:195], v[104:107]
    v_add_f32_e64 v84, v84, v64
    v_mfma_f32_16x16x32_bf16 v[68:71], a[148:151], v[196:199], v[68:71]
    v_exp_f32_e64 v65, v65
    v_mfma_f32_16x16x32_bf16 v[68:71], a[152:155], v[200:203], v[68:71]
    v_cvt_pk_bf16_f32 v72, v64, v65
    v_add_f32_e64 v84, v84, v65
    v_mfma_f32_16x16x32_bf16 v[68:71], a[156:159], v[204:207], v[68:71]
    s_add_u32 m0, s31, 12672
    v_exp_f32_e64 v66, v66
    v_mfma_f32_16x16x32_bf16 a[96:99], a[160:163], v[76:79], a[96:99]
    buffer_load_dwordx4 v122, s[16:19], s55 offen offset:0 nt lds
    v_add_f32_e64 v84, v84, v66
    v_mfma_f32_16x16x32_bf16 a[100:103], a[164:167], v[76:79], a[100:103]
    v_exp_f32_e64 v67, v67
    v_mfma_f32_16x16x32_bf16 a[104:107], a[168:171], v[76:79], a[104:107]
    v_cvt_pk_bf16_f32 v73, v66, v67
    v_add_f32_e64 v84, v84, v67
    v_mfma_f32_16x16x32_bf16 a[108:111], a[172:175], v[76:79], a[108:111]
    v_exp_f32_e64 v68, v68
    v_mfma_f32_16x16x32_bf16 v[64:67], a[128:131], v[208:211], v[108:111]
    v_add_f32_e64 v84, v84, v68
    v_mfma_f32_16x16x32_bf16 v[64:67], a[132:135], v[212:215], v[64:67]
    s_add_u32 m0, s31, 12704
    v_exp_f32_e64 v69, v69
    v_mfma_f32_16x16x32_bf16 v[64:67], a[136:139], v[216:219], v[64:67]
    buffer_load_dwordx4 v122, s[16:19], s55 offen offset:1024 nt lds
    v_cvt_pk_bf16_f32 v74, v68, v69
    v_add_f32_e64 v84, v84, v69
    v_mfma_f32_16x16x32_bf16 v[64:67], a[140:143], v[220:223], v[64:67]
    v_exp_f32_e64 v70, v70
    v_mfma_f32_16x16x32_bf16 a[112:115], a[176:179], v[76:79], a[112:115]
    v_add_f32_e64 v84, v84, v70
    v_mfma_f32_16x16x32_bf16 a[116:119], a[180:183], v[76:79], a[116:119]
    v_exp_f32_e64 v71, v71
    v_mfma_f32_16x16x32_bf16 a[120:123], a[184:187], v[76:79], a[120:123]
    v_cvt_pk_bf16_f32 v75, v70, v71
    v_add_f32_e64 v84, v84, v71
    v_mfma_f32_16x16x32_bf16 a[124:127], a[188:191], v[76:79], a[124:127]
    s_add_u32 m0, s31, 12736
    v_exp_f32_e64 v64, v64
    v_mfma_f32_16x16x32_bf16 v[68:71], a[144:147], v[208:211], v[108:111]
    buffer_load_dwordx4 v122, s[16:19], s55 offen offset:2048 nt lds
    v_add_f32_e64 v85, v85, v64
    v_mfma_f32_16x16x32_bf16 v[68:71], a[148:151], v[212:215], v[68:71]
    v_exp_f32_e64 v65, v65
    v_mfma_f32_16x16x32_bf16 v[68:71], a[152:155], v[216:219], v[68:71]
    v_cvt_pk_bf16_f32 v76, v64, v65
    v_add_f32_e64 v85, v85, v65
    v_mfma_f32_16x16x32_bf16 v[68:71], a[156:159], v[220:223], v[68:71]
    v_exp_f32_e64 v66, v66
    v_mfma_f32_16x16x32_bf16 v[0:3], a[160:163], v[72:75], v[0:3]
    v_add_f32_e64 v85, v85, v66
    v_mfma_f32_16x16x32_bf16 v[4:7], a[164:167], v[72:75], v[4:7]
    s_add_u32 m0, s31, 12768
    v_exp_f32_e64 v67, v67
    v_mfma_f32_16x16x32_bf16 v[8:11], a[168:171], v[72:75], v[8:11]
    buffer_load_dwordx4 v122, s[16:19], s55 offen offset:3072 nt lds
    v_cvt_pk_bf16_f32 v77, v66, v67
    v_add_f32_e64 v85, v85, v67
    v_mfma_f32_16x16x32_bf16 v[12:15], a[172:175], v[72:75], v[12:15]
    v_exp_f32_e64 v68, v68
    v_mfma_f32_16x16x32_bf16 v[64:67], a[128:131], v[224:227], v[112:115]
    ds_read_b128 a[128:131], v120 offset:8448
    v_add_f32_e64 v85, v85, v68
    v_mfma_f32_16x16x32_bf16 v[64:67], a[132:135], v[228:231], v[64:67]
    v_exp_f32_e64 v69, v69
    v_mfma_f32_16x16x32_bf16 v[64:67], a[136:139], v[232:235], v[64:67]
    v_cvt_pk_bf16_f32 v78, v68, v69
    v_add_f32_e64 v85, v85, v69
    v_mfma_f32_16x16x32_bf16 v[64:67], a[140:143], v[236:239], v[64:67]
    s_add_u32 m0, s32, 0
    v_exp_f32 v70, v70
    v_mfma_f32_16x16x32_bf16 v[16:19], a[176:179], v[72:75], v[16:19]
    ds_read_b128 a[132:135], v120 offset:8512
    buffer_load_dwordx4 v122, s[20:23], s52 offen offset:0 nt lds
    v_add_f32_e64 v85, v85, v70
    v_mfma_f32_16x16x32_bf16 v[20:23], a[180:183], v[72:75], v[20:23]
    ds_read_b128 a[136:139], v120 offset:8576
    v_exp_f32_e64 v71, v71
    v_mfma_f32_16x16x32_bf16 v[24:27], a[184:187], v[72:75], v[24:27]
    v_cvt_pk_bf16_f32 v79, v70, v71
    v_add_f32_e64 v85, v85, v71
    v_mfma_f32_16x16x32_bf16 v[28:31], a[188:191], v[72:75], v[28:31]
    v_exp_f32_e64 v64, v64
    v_mfma_f32_16x16x32_bf16 v[68:71], a[144:147], v[224:227], v[112:115]
    ds_read_b128 a[140:143], v120 offset:8640
    v_add_f32_e64 v86, v86, v64
    v_mfma_f32_16x16x32_bf16 v[68:71], a[148:151], v[228:231], v[68:71]
    s_add_u32 m0, s32, 32
    v_exp_f32 v65, v65
    v_mfma_f32_16x16x32_bf16 v[68:71], a[152:155], v[232:235], v[68:71]
    buffer_load_dwordx4 v122, s[20:23], s52 offen offset:1024 nt lds
    v_cvt_pk_bf16_f32 v72, v64, v65
    v_add_f32_e64 v86, v86, v65
    v_mfma_f32_16x16x32_bf16 v[68:71], a[156:159], v[236:239], v[68:71]
    v_exp_f32_e64 v66, v66
    v_mfma_f32_16x16x32_bf16 v[32:35], a[160:163], v[76:79], v[32:35]
    ds_read_b128 a[144:147], v120 offset:8960
    v_add_f32_e64 v86, v86, v66
    v_mfma_f32_16x16x32_bf16 v[36:39], a[164:167], v[76:79], v[36:39]
    ds_read_b128 a[148:151], v120 offset:9024
    v_exp_f32_e64 v67, v67
    v_mfma_f32_16x16x32_bf16 v[40:43], a[168:171], v[76:79], v[40:43]
    v_cvt_pk_bf16_f32 v73, v66, v67
    v_add_f32_e64 v86, v86, v67
    v_mfma_f32_16x16x32_bf16 v[44:47], a[172:175], v[76:79], v[44:47]
    s_waitcnt lgkmcnt(5)
    s_add_u32 m0, s32, 64
    v_exp_f32_e64 v68, v68
    v_mfma_f32_16x16x32_bf16 v[64:67], a[128:131], v[128:131], v[88:91]
    s_waitcnt lgkmcnt(4)
    ds_read_b128 a[152:155], v120 offset:9088
    buffer_load_dwordx4 v122, s[20:23], s52 offen offset:2048 nt lds
    v_add_f32 v86, v86, v68
    v_mfma_f32_16x16x32_bf16 v[64:67], a[132:135], v[132:135], v[64:67]
    s_waitcnt lgkmcnt(4)
    v_exp_f32 v69, v69
    v_mfma_f32_16x16x32_bf16 v[64:67], a[136:139], v[136:139], v[64:67]
    s_waitcnt lgkmcnt(3)
    v_cvt_pk_bf16_f32 v74, v68, v69
    v_add_f32 v86, v86, v69
    v_mfma_f32_16x16x32_bf16 v[64:67], a[140:143], v[140:143], v[64:67]
    v_exp_f32_e64 v70, v70
    v_mfma_f32_16x16x32_bf16 v[48:51], a[176:179], v[76:79], v[48:51]
    ds_read_b128 a[156:159], v120 offset:9152
    v_add_f32_e64 v86, v86, v70
    v_mfma_f32_16x16x32_bf16 v[52:55], a[180:183], v[76:79], v[52:55]
    s_add_u32 m0, s32, 96
    v_exp_f32_e64 v71, v71
    v_mfma_f32_16x16x32_bf16 v[56:59], a[184:187], v[76:79], v[56:59]
    buffer_load_dwordx4 v122, s[20:23], s52 offen offset:3072 nt lds
    v_cvt_pk_bf16_f32 v75, v70, v71
    v_add_f32_e64 v86, v86, v71
    v_mfma_f32_16x16x32_bf16 v[60:63], a[188:191], v[76:79], v[60:63]
    s_waitcnt lgkmcnt(3)
    v_exp_f32 v64, v64
    v_mfma_f32_16x16x32_bf16 v[68:71], a[144:147], v[128:131], v[88:91]
    s_waitcnt lgkmcnt(2)
    v_add_f32 v80, v80, v64
    v_mfma_f32_16x16x32_bf16 v[68:71], a[148:151], v[132:135], v[68:71]
    s_waitcnt lgkmcnt(1)
    v_exp_f32 v65, v65
    v_mfma_f32_16x16x32_bf16 v[68:71], a[152:155], v[136:139], v[68:71]
    s_waitcnt lgkmcnt(0)
    v_cvt_pk_bf16_f32 v76, v64, v65
    v_add_f32 v80, v80, v65
    v_mfma_f32_16x16x32_bf16 v[68:71], a[156:159], v[140:143], v[68:71]
    s_add_u32 m0, s32, 4224
    v_exp_f32_e64 v66, v66
    v_mfma_f32_16x16x32_bf16 a[192:195], a[160:163], v[72:75], a[192:195]
    ds_read_b64_tr_b16 a[160:161], v121 offset:8448
    buffer_load_dwordx4 v122, s[20:23], s53 offen offset:0 nt lds
    v_add_f32_e64 v80, v80, v66
    v_mfma_f32_16x16x32_bf16 a[196:199], a[164:167], v[72:75], a[196:199]
    ds_read_b64_tr_b16 a[162:163], v121 offset:8960
    v_exp_f32_e64 v67, v67
    v_mfma_f32_16x16x32_bf16 a[200:203], a[168:171], v[72:75], a[200:203]
    v_cvt_pk_bf16_f32 v77, v66, v67
    v_add_f32_e64 v80, v80, v67
    v_mfma_f32_16x16x32_bf16 a[204:207], a[172:175], v[72:75], a[204:207]
    ds_read_b64_tr_b16 a[164:165], v121 offset:8480
    v_exp_f32_e64 v68, v68
    v_mfma_f32_16x16x32_bf16 v[64:67], a[128:131], v[144:147], v[92:95]
    ds_read_b64_tr_b16 a[166:167], v121 offset:8992
    v_add_f32_e64 v80, v80, v68
    v_mfma_f32_16x16x32_bf16 v[64:67], a[132:135], v[148:151], v[64:67]
    s_add_u32 m0, s32, 4256
    ds_read_b64_tr_b16 a[168:169], v121 offset:8512
    v_exp_f32_e64 v69, v69
    v_mfma_f32_16x16x32_bf16 v[64:67], a[136:139], v[152:155], v[64:67]
    buffer_load_dwordx4 v122, s[20:23], s53 offen offset:1024 nt lds
    v_cvt_pk_bf16_f32 v78, v68, v69
    v_add_f32_e64 v80, v80, v69
    v_mfma_f32_16x16x32_bf16 v[64:67], a[140:143], v[156:159], v[64:67]
    ds_read_b64_tr_b16 a[170:171], v121 offset:9024
    v_exp_f32_e64 v70, v70
    v_mfma_f32_16x16x32_bf16 a[208:211], a[176:179], v[72:75], a[208:211]
    ds_read_b64_tr_b16 a[172:173], v121 offset:8544
    v_add_f32_e64 v80, v80, v70
    v_mfma_f32_16x16x32_bf16 a[212:215], a[180:183], v[72:75], a[212:215]
    ds_read_b64_tr_b16 a[174:175], v121 offset:9056
    v_exp_f32_e64 v71, v71
    v_mfma_f32_16x16x32_bf16 a[216:219], a[184:187], v[72:75], a[216:219]
    v_cvt_pk_bf16_f32 v79, v70, v71
    v_add_f32_e64 v80, v80, v71
    v_mfma_f32_16x16x32_bf16 a[220:223], a[188:191], v[72:75], a[220:223]
    s_add_u32 m0, s32, 4288
    ds_read_b64_tr_b16 a[176:177], v121 offset:8576
    v_exp_f32_e64 v64, v64
    v_mfma_f32_16x16x32_bf16 v[68:71], a[144:147], v[144:147], v[92:95]
    ds_read_b64_tr_b16 a[178:179], v121 offset:9088
    buffer_load_dwordx4 v122, s[20:23], s53 offen offset:2048 nt lds
    v_add_f32_e64 v81, v81, v64
    v_mfma_f32_16x16x32_bf16 v[68:71], a[148:151], v[148:151], v[68:71]
    ds_read_b64_tr_b16 a[180:181], v121 offset:8608
    v_exp_f32_e64 v65, v65
    v_mfma_f32_16x16x32_bf16 v[68:71], a[152:155], v[152:155], v[68:71]
    v_cvt_pk_bf16_f32 v72, v64, v65
    v_add_f32_e64 v81, v81, v65
    v_mfma_f32_16x16x32_bf16 v[68:71], a[156:159], v[156:159], v[68:71]
    s_waitcnt lgkmcnt(9)
    ds_read_b64_tr_b16 a[182:183], v121 offset:9120
    v_exp_f32 v66, v66
    v_mfma_f32_16x16x32_bf16 a[0:3], a[160:163], v[76:79], a[0:3]
    s_waitcnt lgkmcnt(8)
    ds_read_b64_tr_b16 a[184:185], v121 offset:8640
    v_add_f32 v81, v81, v66
    v_mfma_f32_16x16x32_bf16 a[4:7], a[164:167], v[76:79], a[4:7]
    s_waitcnt lgkmcnt(7)
    s_add_u32 m0, s32, 4320
    ds_read_b64_tr_b16 a[186:187], v121 offset:9152
    v_exp_f32 v67, v67
    v_mfma_f32_16x16x32_bf16 a[8:11], a[168:171], v[76:79], a[8:11]
    s_waitcnt lgkmcnt(6)
    buffer_load_dwordx4 v122, s[20:23], s53 offen offset:3072 nt lds
    v_cvt_pk_bf16_f32 v73, v66, v67
    v_add_f32 v81, v81, v67
    v_mfma_f32_16x16x32_bf16 a[12:15], a[172:175], v[76:79], a[12:15]
    ds_read_b64_tr_b16 a[188:189], v121 offset:8672
    v_exp_f32_e64 v68, v68
    v_mfma_f32_16x16x32_bf16 v[64:67], a[128:131], v[160:163], v[96:99]
    ds_read_b64_tr_b16 a[190:191], v121 offset:9184
    v_add_f32_e64 v81, v81, v68
    v_mfma_f32_16x16x32_bf16 v[64:67], a[132:135], v[164:167], v[64:67]
    v_exp_f32_e64 v69, v69
    v_mfma_f32_16x16x32_bf16 v[64:67], a[136:139], v[168:171], v[64:67]
    v_cvt_pk_bf16_f32 v74, v68, v69
    v_add_f32_e64 v81, v81, v69
    v_mfma_f32_16x16x32_bf16 v[64:67], a[140:143], v[172:175], v[64:67]
    s_waitcnt lgkmcnt(6)
    s_add_u32 m0, s32, 8448
    v_exp_f32 v70, v70
    v_mfma_f32_16x16x32_bf16 a[16:19], a[176:179], v[76:79], a[16:19]
    s_waitcnt lgkmcnt(4)
    buffer_load_dwordx4 v122, s[20:23], s54 offen offset:0 nt lds
    v_add_f32 v81, v81, v70
    v_mfma_f32_16x16x32_bf16 a[20:23], a[180:183], v[76:79], a[20:23]
    s_waitcnt lgkmcnt(2)
    v_exp_f32 v71, v71
    v_mfma_f32_16x16x32_bf16 a[24:27], a[184:187], v[76:79], a[24:27]
    s_waitcnt lgkmcnt(0)
    v_cvt_pk_bf16_f32 v75, v70, v71
    v_add_f32 v81, v81, v71
    v_mfma_f32_16x16x32_bf16 a[28:31], a[188:191], v[76:79], a[28:31]
    v_exp_f32_e64 v64, v64
    v_mfma_f32_16x16x32_bf16 v[68:71], a[144:147], v[160:163], v[96:99]
    v_add_f32_e64 v82, v82, v64
    v_mfma_f32_16x16x32_bf16 v[68:71], a[148:151], v[164:167], v[68:71]
    s_add_u32 m0, s32, 8480
    v_exp_f32_e64 v65, v65
    v_mfma_f32_16x16x32_bf16 v[68:71], a[152:155], v[168:171], v[68:71]
    s_and_b32 s36, s29, 3
    s_cmp_eq_u32 s36, 3
    s_cselect_b32 s33, -50688, s41
    buffer_load_dwordx4 v122, s[20:23], s54 offen offset:1024 nt lds
    v_cvt_pk_bf16_f32 v76, v64, v65
    v_add_f32_e64 v82, v82, v65
    v_mfma_f32_16x16x32_bf16 v[68:71], a[156:159], v[172:175], v[68:71]
    v_exp_f32_e64 v66, v66
    v_mfma_f32_16x16x32_bf16 a[32:35], a[160:163], v[72:75], a[32:35]
    v_add_f32_e64 v82, v82, v66
    v_mfma_f32_16x16x32_bf16 a[36:39], a[164:167], v[72:75], a[36:39]
    v_exp_f32_e64 v67, v67
    v_mfma_f32_16x16x32_bf16 a[40:43], a[168:171], v[72:75], a[40:43]
    v_cvt_pk_bf16_f32 v77, v66, v67
    v_add_f32_e64 v82, v82, v67
    v_mfma_f32_16x16x32_bf16 a[44:47], a[172:175], v[72:75], a[44:47]
    s_add_u32 m0, s32, 8512
    v_exp_f32_e64 v68, v68
    v_mfma_f32_16x16x32_bf16 v[64:67], a[128:131], v[176:179], v[100:103]
    buffer_load_dwordx4 v122, s[20:23], s54 offen offset:2048 nt lds
    v_add_f32 v82, v82, v68
    v_add_u32 v120, s33, v120
    v_mfma_f32_16x16x32_bf16 v[64:67], a[132:135], v[180:183], v[64:67]
    v_exp_f32_e64 v69, v69
    v_mfma_f32_16x16x32_bf16 v[64:67], a[136:139], v[184:187], v[64:67]
    v_cvt_pk_bf16_f32 v78, v68, v69
    v_add_f32_e64 v82, v82, v69
    v_mfma_f32_16x16x32_bf16 v[64:67], a[140:143], v[188:191], v[64:67]
    v_exp_f32_e64 v70, v70
    v_mfma_f32_16x16x32_bf16 a[48:51], a[176:179], v[72:75], a[48:51]
    v_add_f32 v82, v82, v70
    v_add_u32 v121, s33, v121
    v_mfma_f32_16x16x32_bf16 a[52:55], a[180:183], v[72:75], a[52:55]
    s_add_u32 m0, s32, 8544
    v_exp_f32_e64 v71, v71
    v_mfma_f32_16x16x32_bf16 a[56:59], a[184:187], v[72:75], a[56:59]
    buffer_load_dwordx4 v122, s[20:23], s54 offen offset:3072 nt lds
    v_cvt_pk_bf16_f32 v79, v70, v71
    v_add_f32_e64 v82, v82, v71
    v_mfma_f32_16x16x32_bf16 a[60:63], a[188:191], v[72:75], a[60:63]
    v_exp_f32_e64 v64, v64
    v_mfma_f32_16x16x32_bf16 v[68:71], a[144:147], v[176:179], v[100:103]
    v_add_f32_e64 v83, v83, v64
    v_mfma_f32_16x16x32_bf16 v[68:71], a[148:151], v[180:183], v[68:71]
    v_exp_f32_e64 v65, v65
    v_mfma_f32_16x16x32_bf16 v[68:71], a[152:155], v[184:187], v[68:71]
    v_cvt_pk_bf16_f32 v72, v64, v65
    v_add_f32_e64 v83, v83, v65
    v_mfma_f32_16x16x32_bf16 v[68:71], a[156:159], v[188:191], v[68:71]
    s_add_u32 m0, s32, 12672
    v_exp_f32_e64 v66, v66
    v_mfma_f32_16x16x32_bf16 a[64:67], a[160:163], v[76:79], a[64:67]
    buffer_load_dwordx4 v122, s[20:23], s55 offen offset:0 nt lds
    v_add_f32_e64 v83, v83, v66
    v_mfma_f32_16x16x32_bf16 a[68:71], a[164:167], v[76:79], a[68:71]
    v_exp_f32_e64 v67, v67
    v_mfma_f32_16x16x32_bf16 a[72:75], a[168:171], v[76:79], a[72:75]
    v_cvt_pk_bf16_f32 v73, v66, v67
    v_add_f32_e64 v83, v83, v67
    v_mfma_f32_16x16x32_bf16 a[76:79], a[172:175], v[76:79], a[76:79]
    v_exp_f32_e64 v68, v68
    v_mfma_f32_16x16x32_bf16 v[64:67], a[128:131], v[192:195], v[104:107]
    v_add_f32_e64 v83, v83, v68
    v_mfma_f32_16x16x32_bf16 v[64:67], a[132:135], v[196:199], v[64:67]
    s_add_u32 m0, s32, 12704
    v_exp_f32_e64 v69, v69
    v_mfma_f32_16x16x32_bf16 v[64:67], a[136:139], v[200:203], v[64:67]
    buffer_load_dwordx4 v122, s[20:23], s55 offen offset:1024 nt lds
    v_cvt_pk_bf16_f32 v74, v68, v69
    v_add_f32_e64 v83, v83, v69
    v_mfma_f32_16x16x32_bf16 v[64:67], a[140:143], v[204:207], v[64:67]
    v_exp_f32_e64 v70, v70
    v_mfma_f32_16x16x32_bf16 a[80:83], a[176:179], v[76:79], a[80:83]
    v_add_f32_e64 v83, v83, v70
    v_mfma_f32_16x16x32_bf16 a[84:87], a[180:183], v[76:79], a[84:87]
    v_exp_f32_e64 v71, v71
    v_mfma_f32_16x16x32_bf16 a[88:91], a[184:187], v[76:79], a[88:91]
    v_cvt_pk_bf16_f32 v75, v70, v71
    v_add_f32_e64 v83, v83, v71
    v_mfma_f32_16x16x32_bf16 a[92:95], a[188:191], v[76:79], a[92:95]
    s_add_u32 m0, s32, 12736
    v_exp_f32_e64 v64, v64
    v_mfma_f32_16x16x32_bf16 v[68:71], a[144:147], v[192:195], v[104:107]
    buffer_load_dwordx4 v122, s[20:23], s55 offen offset:2048 nt lds
    v_add_f32_e64 v84, v84, v64
    v_mfma_f32_16x16x32_bf16 v[68:71], a[148:151], v[196:199], v[68:71]
    v_exp_f32_e64 v65, v65
    v_mfma_f32_16x16x32_bf16 v[68:71], a[152:155], v[200:203], v[68:71]
    v_cvt_pk_bf16_f32 v76, v64, v65
    v_add_f32_e64 v84, v84, v65
    v_mfma_f32_16x16x32_bf16 v[68:71], a[156:159], v[204:207], v[68:71]
    v_exp_f32_e64 v66, v66
    v_mfma_f32_16x16x32_bf16 a[96:99], a[160:163], v[72:75], a[96:99]
    v_add_f32_e64 v84, v84, v66
    v_mfma_f32_16x16x32_bf16 a[100:103], a[164:167], v[72:75], a[100:103]
    s_add_u32 m0, s32, 12768
    v_exp_f32_e64 v67, v67
    v_mfma_f32_16x16x32_bf16 a[104:107], a[168:171], v[72:75], a[104:107]
    buffer_load_dwordx4 v122, s[20:23], s55 offen offset:3072 nt lds
    v_cvt_pk_bf16_f32 v77, v66, v67
    v_add_f32_e64 v84, v84, v67
    v_mfma_f32_16x16x32_bf16 a[108:111], a[172:175], v[72:75], a[108:111]
    v_exp_f32_e64 v68, v68
    v_mfma_f32_16x16x32_bf16 v[64:67], a[128:131], v[208:211], v[108:111]
    v_add_f32_e64 v84, v84, v68
    v_mfma_f32_16x16x32_bf16 v[64:67], a[132:135], v[212:215], v[64:67]
    v_exp_f32_e64 v69, v69
    v_mfma_f32_16x16x32_bf16 v[64:67], a[136:139], v[216:219], v[64:67]
    v_cvt_pk_bf16_f32 v78, v68, v69
    v_add_f32_e64 v84, v84, v69
    v_mfma_f32_16x16x32_bf16 v[64:67], a[140:143], v[220:223], v[64:67]
    v_exp_f32_e64 v70, v70
    v_mfma_f32_16x16x32_bf16 a[112:115], a[176:179], v[72:75], a[112:115]
    v_add_f32_e64 v84, v84, v70
    v_mfma_f32_16x16x32_bf16 a[116:119], a[180:183], v[72:75], a[116:119]
    v_exp_f32_e64 v71, v71
    v_mfma_f32_16x16x32_bf16 a[120:123], a[184:187], v[72:75], a[120:123]
    v_cvt_pk_bf16_f32 v79, v70, v71
    v_add_f32_e64 v84, v84, v71
    v_mfma_f32_16x16x32_bf16 a[124:127], a[188:191], v[72:75], a[124:127]
    s_waitcnt vmcnt(32)
    v_exp_f32 v64, v64
    v_mfma_f32_16x16x32_bf16 v[68:71], a[144:147], v[208:211], v[108:111]
    s_barrier
    v_add_f32 v85, v85, v64
    v_mfma_f32_16x16x32_bf16 v[68:71], a[148:151], v[212:215], v[68:71]
    v_exp_f32_e64 v65, v65
    v_mfma_f32_16x16x32_bf16 v[68:71], a[152:155], v[216:219], v[68:71]
    s_cmp_eq_u32 s36, 1
    v_cvt_pk_bf16_f32 v72, v64, v65
    v_add_f32 v85, v85, v65
    v_mfma_f32_16x16x32_bf16 v[68:71], a[156:159], v[220:223], v[68:71]
    s_cselect_b32 s38, -50688, s41
    v_exp_f32_e64 v66, v66
    v_mfma_f32_16x16x32_bf16 v[0:3], a[160:163], v[76:79], v[0:3]
    s_add_u32 s31, s31, s38
    v_add_f32 v85, v85, v66
    v_mfma_f32_16x16x32_bf16 v[4:7], a[164:167], v[76:79], v[4:7]
    s_add_u32 s32, s32, s38
    v_exp_f32 v67, v67
    v_mfma_f32_16x16x32_bf16 v[8:11], a[168:171], v[76:79], v[8:11]
    s_add_u32 s52, s52, 16384
    v_cvt_pk_bf16_f32 v73, v66, v67
    v_add_f32_e64 v85, v85, v67
    v_mfma_f32_16x16x32_bf16 v[12:15], a[172:175], v[76:79], v[12:15]
    s_add_u32 s53, s53, 16384
    v_exp_f32_e64 v68, v68
    v_mfma_f32_16x16x32_bf16 v[64:67], a[128:131], v[224:227], v[112:115]
    s_add_u32 s54, s54, 16384
    ds_read_b128 a[128:131], v120 offset:0
    v_add_f32_e64 v85, v85, v68
    v_mfma_f32_16x16x32_bf16 v[64:67], a[132:135], v[228:231], v[64:67]
    s_add_u32 s55, s55, 16384
    v_exp_f32_e64 v69, v69
    v_mfma_f32_16x16x32_bf16 v[64:67], a[136:139], v[232:235], v[64:67]
    s_add_u32 s29, s29, 1
    v_cvt_pk_bf16_f32 v74, v68, v69
    v_add_f32 v85, v85, v69
    v_mfma_f32_16x16x32_bf16 v[64:67], a[140:143], v[236:239], v[64:67]
    s_cmp_lt_u32 s29, 14
    v_exp_f32 v70, v70
    v_mfma_f32_16x16x32_bf16 v[16:19], a[176:179], v[76:79], v[16:19]
    ds_read_b128 a[132:135], v120 offset:64
    v_add_f32_e64 v85, v85, v70
    v_mfma_f32_16x16x32_bf16 v[20:23], a[180:183], v[76:79], v[20:23]
    ds_read_b128 a[136:139], v120 offset:128
    v_exp_f32_e64 v71, v71
    v_mfma_f32_16x16x32_bf16 v[24:27], a[184:187], v[76:79], v[24:27]
    v_cvt_pk_bf16_f32 v75, v70, v71
    v_add_f32_e64 v85, v85, v71
    v_mfma_f32_16x16x32_bf16 v[28:31], a[188:191], v[76:79], v[28:31]
    v_exp_f32_e64 v64, v64
    v_mfma_f32_16x16x32_bf16 v[68:71], a[144:147], v[224:227], v[112:115]
    ds_read_b128 a[140:143], v120 offset:192
    v_add_f32_e64 v86, v86, v64
    v_mfma_f32_16x16x32_bf16 v[68:71], a[148:151], v[228:231], v[68:71]
    v_exp_f32_e64 v65, v65
    v_mfma_f32_16x16x32_bf16 v[68:71], a[152:155], v[232:235], v[68:71]
    v_cvt_pk_bf16_f32 v76, v64, v65
    v_add_f32_e64 v86, v86, v65
    v_mfma_f32_16x16x32_bf16 v[68:71], a[156:159], v[236:239], v[68:71]
    v_exp_f32_e64 v66, v66
    v_mfma_f32_16x16x32_bf16 v[32:35], a[160:163], v[72:75], v[32:35]
    ds_read_b128 a[144:147], v120 offset:512
    v_add_f32_e64 v86, v86, v66
    v_mfma_f32_16x16x32_bf16 v[36:39], a[164:167], v[72:75], v[36:39]
    ds_read_b128 a[148:151], v120 offset:576
    v_exp_f32_e64 v67, v67
    v_mfma_f32_16x16x32_bf16 v[40:43], a[168:171], v[72:75], v[40:43]
    v_cvt_pk_bf16_f32 v77, v66, v67
    v_add_f32_e64 v86, v86, v67
    v_mfma_f32_16x16x32_bf16 v[44:47], a[172:175], v[72:75], v[44:47]
    s_waitcnt lgkmcnt(5)
    v_exp_f32 v68, v68
    s_cbranch_scc1 L_loopb
    v_mfma_f32_16x16x32_bf16 v[64:67], a[128:131], v[128:131], v[88:91]
    s_waitcnt lgkmcnt(4)
    ds_read_b128 a[152:155], v120 offset:640
    v_add_f32 v86, v86, v68
    v_mfma_f32_16x16x32_bf16 v[64:67], a[132:135], v[132:135], v[64:67]
    s_waitcnt lgkmcnt(4)
    v_exp_f32 v69, v69
    v_mfma_f32_16x16x32_bf16 v[64:67], a[136:139], v[136:139], v[64:67]
    s_waitcnt lgkmcnt(3)
    v_cvt_pk_bf16_f32 v78, v68, v69
    v_add_f32 v86, v86, v69
    v_mfma_f32_16x16x32_bf16 v[64:67], a[140:143], v[140:143], v[64:67]
    v_exp_f32 v70, v70
    v_mfma_f32_16x16x32_bf16 v[48:51], a[176:179], v[72:75], v[48:51]
    ds_read_b128 a[156:159], v120 offset:704
    v_add_f32 v86, v86, v70
    v_mfma_f32_16x16x32_bf16 v[52:55], a[180:183], v[72:75], v[52:55]
    v_exp_f32 v71, v71
    v_mfma_f32_16x16x32_bf16 v[56:59], a[184:187], v[72:75], v[56:59]
    v_cvt_pk_bf16_f32 v79, v70, v71
    v_add_f32 v86, v86, v71
    v_mfma_f32_16x16x32_bf16 v[60:63], a[188:191], v[72:75], v[60:63]
    s_waitcnt lgkmcnt(3)
    v_exp_f32 v64, v64
    v_mfma_f32_16x16x32_bf16 v[68:71], a[144:147], v[128:131], v[88:91]
    s_waitcnt lgkmcnt(2)
    v_add_f32 v80, v80, v64
    v_mfma_f32_16x16x32_bf16 v[68:71], a[148:151], v[132:135], v[68:71]
    s_waitcnt lgkmcnt(1)
    v_exp_f32 v65, v65
    v_mfma_f32_16x16x32_bf16 v[68:71], a[152:155], v[136:139], v[68:71]
    s_waitcnt lgkmcnt(0)
    v_cvt_pk_bf16_f32 v72, v64, v65
    v_add_f32 v80, v80, v65
    v_mfma_f32_16x16x32_bf16 v[68:71], a[156:159], v[140:143], v[68:71]
    v_exp_f32 v66, v66
    v_mfma_f32_16x16x32_bf16 a[192:195], a[160:163], v[76:79], a[192:195]
    ds_read_b64_tr_b16 a[160:161], v121 offset:0
    v_add_f32 v80, v80, v66
    v_mfma_f32_16x16x32_bf16 a[196:199], a[164:167], v[76:79], a[196:199]
    ds_read_b64_tr_b16 a[162:163], v121 offset:512
    v_exp_f32 v67, v67
    v_mfma_f32_16x16x32_bf16 a[200:203], a[168:171], v[76:79], a[200:203]
    v_cvt_pk_bf16_f32 v73, v66, v67
    v_add_f32 v80, v80, v67
    v_mfma_f32_16x16x32_bf16 a[204:207], a[172:175], v[76:79], a[204:207]
    ds_read_b64_tr_b16 a[164:165], v121 offset:32
    v_exp_f32 v68, v68
    v_mfma_f32_16x16x32_bf16 v[64:67], a[128:131], v[144:147], v[92:95]
    ds_read_b64_tr_b16 a[166:167], v121 offset:544
    v_add_f32 v80, v80, v68
    v_mfma_f32_16x16x32_bf16 v[64:67], a[132:135], v[148:151], v[64:67]
    ds_read_b64_tr_b16 a[168:169], v121 offset:64
    v_exp_f32 v69, v69
    v_mfma_f32_16x16x32_bf16 v[64:67], a[136:139], v[152:155], v[64:67]
    v_cvt_pk_bf16_f32 v74, v68, v69
    v_add_f32 v80, v80, v69
    v_mfma_f32_16x16x32_bf16 v[64:67], a[140:143], v[156:159], v[64:67]
    ds_read_b64_tr_b16 a[170:171], v121 offset:576
    v_exp_f32 v70, v70
    v_mfma_f32_16x16x32_bf16 a[208:211], a[176:179], v[76:79], a[208:211]
    ds_read_b64_tr_b16 a[172:173], v121 offset:96
    v_add_f32 v80, v80, v70
    v_mfma_f32_16x16x32_bf16 a[212:215], a[180:183], v[76:79], a[212:215]
    ds_read_b64_tr_b16 a[174:175], v121 offset:608
    v_exp_f32 v71, v71
    v_mfma_f32_16x16x32_bf16 a[216:219], a[184:187], v[76:79], a[216:219]
    v_cvt_pk_bf16_f32 v75, v70, v71
    v_add_f32 v80, v80, v71
    v_mfma_f32_16x16x32_bf16 a[220:223], a[188:191], v[76:79], a[220:223]
    ds_read_b64_tr_b16 a[176:177], v121 offset:128
    v_exp_f32 v64, v64
    v_mfma_f32_16x16x32_bf16 v[68:71], a[144:147], v[144:147], v[92:95]
    ds_read_b64_tr_b16 a[178:179], v121 offset:640
    v_add_f32 v81, v81, v64
    v_mfma_f32_16x16x32_bf16 v[68:71], a[148:151], v[148:151], v[68:71]
    ds_read_b64_tr_b16 a[180:181], v121 offset:160
    v_exp_f32 v65, v65
    v_mfma_f32_16x16x32_bf16 v[68:71], a[152:155], v[152:155], v[68:71]
    v_cvt_pk_bf16_f32 v76, v64, v65
    v_add_f32 v81, v81, v65
    v_mfma_f32_16x16x32_bf16 v[68:71], a[156:159], v[156:159], v[68:71]
    s_waitcnt lgkmcnt(9)
    ds_read_b64_tr_b16 a[182:183], v121 offset:672
    v_exp_f32 v66, v66
    v_mfma_f32_16x16x32_bf16 a[0:3], a[160:163], v[72:75], a[0:3]
    s_waitcnt lgkmcnt(8)
    ds_read_b64_tr_b16 a[184:185], v121 offset:192
    v_add_f32 v81, v81, v66
    v_mfma_f32_16x16x32_bf16 a[4:7], a[164:167], v[72:75], a[4:7]
    s_waitcnt lgkmcnt(7)
    ds_read_b64_tr_b16 a[186:187], v121 offset:704
    v_exp_f32 v67, v67
    v_mfma_f32_16x16x32_bf16 a[8:11], a[168:171], v[72:75], a[8:11]
    s_waitcnt lgkmcnt(6)
    v_cvt_pk_bf16_f32 v77, v66, v67
    v_add_f32 v81, v81, v67
    v_mfma_f32_16x16x32_bf16 a[12:15], a[172:175], v[72:75], a[12:15]
    ds_read_b64_tr_b16 a[188:189], v121 offset:224
    v_exp_f32 v68, v68
    v_mfma_f32_16x16x32_bf16 v[64:67], a[128:131], v[160:163], v[96:99]
    ds_read_b64_tr_b16 a[190:191], v121 offset:736
    v_add_f32 v81, v81, v68
    v_mfma_f32_16x16x32_bf16 v[64:67], a[132:135], v[164:167], v[64:67]
    v_exp_f32 v69, v69
    v_mfma_f32_16x16x32_bf16 v[64:67], a[136:139], v[168:171], v[64:67]
    v_cvt_pk_bf16_f32 v78, v68, v69
    v_add_f32 v81, v81, v69
    v_mfma_f32_16x16x32_bf16 v[64:67], a[140:143], v[172:175], v[64:67]
    s_waitcnt lgkmcnt(6)
    v_exp_f32 v70, v70
    v_mfma_f32_16x16x32_bf16 a[16:19], a[176:179], v[72:75], a[16:19]
    s_waitcnt lgkmcnt(4)
    v_add_f32 v81, v81, v70
    v_mfma_f32_16x16x32_bf16 a[20:23], a[180:183], v[72:75], a[20:23]
    s_waitcnt lgkmcnt(2)
    v_exp_f32 v71, v71
    v_mfma_f32_16x16x32_bf16 a[24:27], a[184:187], v[72:75], a[24:27]
    s_waitcnt lgkmcnt(0)
    v_cvt_pk_bf16_f32 v79, v70, v71
    v_add_f32 v81, v81, v71
    v_mfma_f32_16x16x32_bf16 a[28:31], a[188:191], v[72:75], a[28:31]
    v_exp_f32 v64, v64
    v_mfma_f32_16x16x32_bf16 v[68:71], a[144:147], v[160:163], v[96:99]
    v_add_f32 v82, v82, v64
    v_mfma_f32_16x16x32_bf16 v[68:71], a[148:151], v[164:167], v[68:71]
    v_exp_f32 v65, v65
    v_mfma_f32_16x16x32_bf16 v[68:71], a[152:155], v[168:171], v[68:71]
    v_cvt_pk_bf16_f32 v72, v64, v65
    v_add_f32 v82, v82, v65
    v_mfma_f32_16x16x32_bf16 v[68:71], a[156:159], v[172:175], v[68:71]
    v_exp_f32 v66, v66
    v_mfma_f32_16x16x32_bf16 a[32:35], a[160:163], v[76:79], a[32:35]
    v_add_f32 v82, v82, v66
    v_mfma_f32_16x16x32_bf16 a[36:39], a[164:167], v[76:79], a[36:39]
    v_exp_f32 v67, v67
    v_mfma_f32_16x16x32_bf16 a[40:43], a[168:171], v[76:79], a[40:43]
    v_cvt_pk_bf16_f32 v73, v66, v67
    v_add_f32 v82, v82, v67
    v_mfma_f32_16x16x32_bf16 a[44:47], a[172:175], v[76:79], a[44:47]
    v_exp_f32 v68, v68
    v_mfma_f32_16x16x32_bf16 v[64:67], a[128:131], v[176:179], v[100:103]
    ds_read_b128 a[128:131], v120 offset:8448
    v_add_f32 v82, v82, v68
    v_mfma_f32_16x16x32_bf16 v[64:67], a[132:135], v[180:183], v[64:67]
    v_exp_f32 v69, v69
    v_mfma_f32_16x16x32_bf16 v[64:67], a[136:139], v[184:187], v[64:67]
    v_cvt_pk_bf16_f32 v74, v68, v69
    v_add_f32 v82, v82, v69
    v_mfma_f32_16x16x32_bf16 v[64:67], a[140:143], v[188:191], v[64:67]
    v_exp_f32 v70, v70
    v_mfma_f32_16x16x32_bf16 a[48:51], a[176:179], v[76:79], a[48:51]
    ds_read_b128 a[132:135], v120 offset:8512
    v_add_f32 v82, v82, v70
    v_mfma_f32_16x16x32_bf16 a[52:55], a[180:183], v[76:79], a[52:55]
    ds_read_b128 a[136:139], v120 offset:8576
    v_exp_f32 v71, v71
    v_mfma_f32_16x16x32_bf16 a[56:59], a[184:187], v[76:79], a[56:59]
    v_cvt_pk_bf16_f32 v75, v70, v71
    v_add_f32 v82, v82, v71
    v_mfma_f32_16x16x32_bf16 a[60:63], a[188:191], v[76:79], a[60:63]
    v_exp_f32 v64, v64
    v_mfma_f32_16x16x32_bf16 v[68:71], a[144:147], v[176:179], v[100:103]
    ds_read_b128 a[140:143], v120 offset:8640
    v_add_f32 v83, v83, v64
    v_mfma_f32_16x16x32_bf16 v[68:71], a[148:151], v[180:183], v[68:71]
    v_exp_f32 v65, v65
    v_mfma_f32_16x16x32_bf16 v[68:71], a[152:155], v[184:187], v[68:71]
    v_cvt_pk_bf16_f32 v76, v64, v65
    v_add_f32 v83, v83, v65
    v_mfma_f32_16x16x32_bf16 v[68:71], a[156:159], v[188:191], v[68:71]
    v_exp_f32 v66, v66
    v_mfma_f32_16x16x32_bf16 a[64:67], a[160:163], v[72:75], a[64:67]
    ds_read_b128 a[144:147], v120 offset:8960
    v_add_f32 v83, v83, v66
    v_mfma_f32_16x16x32_bf16 a[68:71], a[164:167], v[72:75], a[68:71]
    ds_read_b128 a[148:151], v120 offset:9024
    v_exp_f32 v67, v67
    v_mfma_f32_16x16x32_bf16 a[72:75], a[168:171], v[72:75], a[72:75]
    v_cvt_pk_bf16_f32 v77, v66, v67
    v_add_f32 v83, v83, v67
    v_mfma_f32_16x16x32_bf16 a[76:79], a[172:175], v[72:75], a[76:79]
    s_waitcnt lgkmcnt(5)
    v_exp_f32 v68, v68
    v_mfma_f32_16x16x32_bf16 v[64:67], a[128:131], v[128:131], v[88:91]
    s_waitcnt lgkmcnt(4)
    ds_read_b128 a[152:155], v120 offset:9088
    v_add_f32 v83, v83, v68
    v_mfma_f32_16x16x32_bf16 v[64:67], a[132:135], v[132:135], v[64:67]
    s_waitcnt lgkmcnt(4)
    v_exp_f32 v69, v69
    v_mfma_f32_16x16x32_bf16 v[64:67], a[136:139], v[136:139], v[64:67]
    s_waitcnt lgkmcnt(3)
    v_cvt_pk_bf16_f32 v78, v68, v69
    v_add_f32 v83, v83, v69
    v_mfma_f32_16x16x32_bf16 v[64:67], a[140:143], v[140:143], v[64:67]
    v_exp_f32 v70, v70
    v_mfma_f32_16x16x32_bf16 a[80:83], a[176:179], v[72:75], a[80:83]
    ds_read_b128 a[156:159], v120 offset:9152
    v_add_f32 v83, v83, v70
    v_mfma_f32_16x16x32_bf16 a[84:87], a[180:183], v[72:75], a[84:87]
    v_exp_f32 v71, v71
    v_mfma_f32_16x16x32_bf16 a[88:91], a[184:187], v[72:75], a[88:91]
    v_cvt_pk_bf16_f32 v79, v70, v71
    v_add_f32 v83, v83, v71
    v_mfma_f32_16x16x32_bf16 a[92:95], a[188:191], v[72:75], a[92:95]
    s_waitcnt lgkmcnt(3)
    v_exp_f32 v64, v64
    v_mfma_f32_16x16x32_bf16 v[68:71], a[144:147], v[128:131], v[88:91]
    s_waitcnt lgkmcnt(2)
    v_add_f32 v80, v80, v64
    v_mfma_f32_16x16x32_bf16 v[68:71], a[148:151], v[132:135], v[68:71]
    s_waitcnt lgkmcnt(1)
    v_exp_f32 v65, v65
    v_mfma_f32_16x16x32_bf16 v[68:71], a[152:155], v[136:139], v[68:71]
    s_waitcnt lgkmcnt(0)
    v_cvt_pk_bf16_f32 v72, v64, v65
    v_add_f32 v80, v80, v65
    v_mfma_f32_16x16x32_bf16 v[68:71], a[156:159], v[140:143], v[68:71]
    v_exp_f32 v66, v66
    v_mfma_f32_16x16x32_bf16 a[96:99], a[160:163], v[76:79], a[96:99]
    ds_read_b64_tr_b16 a[160:161], v121 offset:8448
    v_add_f32 v80, v80, v66
    v_mfma_f32_16x16x32_bf16 a[100:103], a[164:167], v[76:79], a[100:103]
    ds_read_b64_tr_b16 a[162:163], v121 offset:8960
    v_exp_f32 v67, v67
    v_mfma_f32_16x16x32_bf16 a[104:107], a[168:171], v[76:79], a[104:107]
    v_cvt_pk_bf16_f32 v73, v66, v67
    v_add_f32 v80, v80, v67
    v_mfma_f32_16x16x32_bf16 a[108:111], a[172:175], v[76:79], a[108:111]
    ds_read_b64_tr_b16 a[164:165], v121 offset:8480
    v_exp_f32 v68, v68
    v_mfma_f32_16x16x32_bf16 v[64:67], a[128:131], v[144:147], v[92:95]
    ds_read_b64_tr_b16 a[166:167], v121 offset:8992
    v_add_f32 v80, v80, v68
    v_mfma_f32_16x16x32_bf16 v[64:67], a[132:135], v[148:151], v[64:67]
    ds_read_b64_tr_b16 a[168:169], v121 offset:8512
    v_exp_f32 v69, v69
    v_mfma_f32_16x16x32_bf16 v[64:67], a[136:139], v[152:155], v[64:67]
    v_cvt_pk_bf16_f32 v74, v68, v69
    v_add_f32 v80, v80, v69
    v_mfma_f32_16x16x32_bf16 v[64:67], a[140:143], v[156:159], v[64:67]
    ds_read_b64_tr_b16 a[170:171], v121 offset:9024
    v_exp_f32 v70, v70
    v_mfma_f32_16x16x32_bf16 a[112:115], a[176:179], v[76:79], a[112:115]
    ds_read_b64_tr_b16 a[172:173], v121 offset:8544
    v_add_f32 v80, v80, v70
    v_mfma_f32_16x16x32_bf16 a[116:119], a[180:183], v[76:79], a[116:119]
    ds_read_b64_tr_b16 a[174:175], v121 offset:9056
    v_exp_f32 v71, v71
    v_mfma_f32_16x16x32_bf16 a[120:123], a[184:187], v[76:79], a[120:123]
    v_cvt_pk_bf16_f32 v75, v70, v71
    v_add_f32 v80, v80, v71
    v_mfma_f32_16x16x32_bf16 a[124:127], a[188:191], v[76:79], a[124:127]
    ds_read_b64_tr_b16 a[176:177], v121 offset:8576
    v_exp_f32 v64, v64
    v_mfma_f32_16x16x32_bf16 v[68:71], a[144:147], v[144:147], v[92:95]
    ds_read_b64_tr_b16 a[178:179], v121 offset:9088
    v_add_f32 v81, v81, v64
    v_mfma_f32_16x16x32_bf16 v[68:71], a[148:151], v[148:151], v[68:71]
    ds_read_b64_tr_b16 a[180:181], v121 offset:8608
    v_exp_f32 v65, v65
    v_mfma_f32_16x16x32_bf16 v[68:71], a[152:155], v[152:155], v[68:71]
    v_cvt_pk_bf16_f32 v76, v64, v65
    v_add_f32 v81, v81, v65
    v_mfma_f32_16x16x32_bf16 v[68:71], a[156:159], v[156:159], v[68:71]
    s_waitcnt lgkmcnt(9)
    ds_read_b64_tr_b16 a[182:183], v121 offset:9120
    v_exp_f32 v66, v66
    v_mfma_f32_16x16x32_bf16 a[0:3], a[160:163], v[72:75], a[0:3]
    s_waitcnt lgkmcnt(8)
    ds_read_b64_tr_b16 a[184:185], v121 offset:8640
    v_add_f32 v81, v81, v66
    v_mfma_f32_16x16x32_bf16 a[4:7], a[164:167], v[72:75], a[4:7]
    s_waitcnt lgkmcnt(7)
    ds_read_b64_tr_b16 a[186:187], v121 offset:9152
    v_exp_f32 v67, v67
    v_mfma_f32_16x16x32_bf16 a[8:11], a[168:171], v[72:75], a[8:11]
    s_waitcnt lgkmcnt(6)
    v_cvt_pk_bf16_f32 v77, v66, v67
    v_add_f32 v81, v81, v67
    v_mfma_f32_16x16x32_bf16 a[12:15], a[172:175], v[72:75], a[12:15]
    ds_read_b64_tr_b16 a[188:189], v121 offset:8672
    v_exp_f32 v68, v68
    v_mfma_f32_16x16x32_bf16 v[64:67], a[128:131], v[160:163], v[96:99]
    ds_read_b64_tr_b16 a[190:191], v121 offset:9184
    v_add_f32 v81, v81, v68
    v_mfma_f32_16x16x32_bf16 v[64:67], a[132:135], v[164:167], v[64:67]
    v_exp_f32 v69, v69
    v_mfma_f32_16x16x32_bf16 v[64:67], a[136:139], v[168:171], v[64:67]
    v_cvt_pk_bf16_f32 v78, v68, v69
    v_add_f32 v81, v81, v69
    v_mfma_f32_16x16x32_bf16 v[64:67], a[140:143], v[172:175], v[64:67]
    s_waitcnt lgkmcnt(6)
    v_exp_f32 v70, v70
    v_mfma_f32_16x16x32_bf16 a[16:19], a[176:179], v[72:75], a[16:19]
    s_waitcnt lgkmcnt(4)
    v_add_f32 v81, v81, v70
    v_mfma_f32_16x16x32_bf16 a[20:23], a[180:183], v[72:75], a[20:23]
    s_waitcnt lgkmcnt(2)
    v_exp_f32 v71, v71
    v_mfma_f32_16x16x32_bf16 a[24:27], a[184:187], v[72:75], a[24:27]
    s_waitcnt lgkmcnt(0)
    v_cvt_pk_bf16_f32 v79, v70, v71
    v_add_f32 v81, v81, v71
    v_mfma_f32_16x16x32_bf16 a[28:31], a[188:191], v[72:75], a[28:31]
    s_waitcnt vmcnt(0)
    v_exp_f32 v64, v64
    v_mfma_f32_16x16x32_bf16 v[68:71], a[144:147], v[160:163], v[96:99]
    s_barrier
    v_add_f32 v82, v82, v64
    v_mfma_f32_16x16x32_bf16 v[68:71], a[148:151], v[164:167], v[68:71]
    v_exp_f32 v65, v65
    v_mfma_f32_16x16x32_bf16 v[68:71], a[152:155], v[168:171], v[68:71]
    v_cvt_pk_bf16_f32 v72, v64, v65
    v_add_f32 v82, v82, v65
    v_mfma_f32_16x16x32_bf16 v[68:71], a[156:159], v[172:175], v[68:71]
    v_exp_f32 v66, v66
    v_mfma_f32_16x16x32_bf16 a[32:35], a[160:163], v[76:79], a[32:35]
    v_add_f32 v82, v82, v66
    v_mfma_f32_16x16x32_bf16 a[36:39], a[164:167], v[76:79], a[36:39]
    v_exp_f32 v67, v67
    v_mfma_f32_16x16x32_bf16 a[40:43], a[168:171], v[76:79], a[40:43]
    v_cvt_pk_bf16_f32 v73, v66, v67
    v_add_f32 v82, v82, v67
    v_mfma_f32_16x16x32_bf16 a[44:47], a[172:175], v[76:79], a[44:47]
    v_exp_f32 v68, v68
    v_mfma_f32_16x16x32_bf16 v[64:67], a[128:131], v[176:179], v[100:103]
    ds_read_b128 a[128:131], v120 offset:16896
    v_add_f32 v82, v82, v68
    v_mfma_f32_16x16x32_bf16 v[64:67], a[132:135], v[180:183], v[64:67]
    v_exp_f32 v69, v69
    v_mfma_f32_16x16x32_bf16 v[64:67], a[136:139], v[184:187], v[64:67]
    v_cvt_pk_bf16_f32 v74, v68, v69
    v_add_f32 v82, v82, v69
    v_mfma_f32_16x16x32_bf16 v[64:67], a[140:143], v[188:191], v[64:67]
    v_exp_f32 v70, v70
    v_mfma_f32_16x16x32_bf16 a[48:51], a[176:179], v[76:79], a[48:51]
    ds_read_b128 a[132:135], v120 offset:16960
    v_add_f32 v82, v82, v70
    v_mfma_f32_16x16x32_bf16 a[52:55], a[180:183], v[76:79], a[52:55]
    ds_read_b128 a[136:139], v120 offset:17024
    v_exp_f32 v71, v71
    v_mfma_f32_16x16x32_bf16 a[56:59], a[184:187], v[76:79], a[56:59]
    v_cvt_pk_bf16_f32 v75, v70, v71
    v_add_f32 v82, v82, v71
    v_mfma_f32_16x16x32_bf16 a[60:63], a[188:191], v[76:79], a[60:63]
    v_exp_f32 v64, v64
    v_mfma_f32_16x16x32_bf16 v[68:71], a[144:147], v[176:179], v[100:103]
    ds_read_b128 a[140:143], v120 offset:17088
    v_add_f32 v83, v83, v64
    v_mfma_f32_16x16x32_bf16 v[68:71], a[148:151], v[180:183], v[68:71]
    v_exp_f32 v65, v65
    v_mfma_f32_16x16x32_bf16 v[68:71], a[152:155], v[184:187], v[68:71]
    v_cvt_pk_bf16_f32 v76, v64, v65
    v_add_f32 v83, v83, v65
    v_mfma_f32_16x16x32_bf16 v[68:71], a[156:159], v[188:191], v[68:71]
    v_exp_f32 v66, v66
    v_mfma_f32_16x16x32_bf16 a[64:67], a[160:163], v[72:75], a[64:67]
    ds_read_b128 a[144:147], v120 offset:17408
    v_add_f32 v83, v83, v66
    v_mfma_f32_16x16x32_bf16 a[68:71], a[164:167], v[72:75], a[68:71]
    ds_read_b128 a[148:151], v120 offset:17472
    v_exp_f32 v67, v67
    v_mfma_f32_16x16x32_bf16 a[72:75], a[168:171], v[72:75], a[72:75]
    v_cvt_pk_bf16_f32 v77, v66, v67
    v_add_f32 v83, v83, v67
    v_mfma_f32_16x16x32_bf16 a[76:79], a[172:175], v[72:75], a[76:79]
    s_waitcnt lgkmcnt(5)
    v_exp_f32 v68, v68
    v_mfma_f32_16x16x32_bf16 v[64:67], a[128:131], v[128:131], v[88:91]
    s_waitcnt lgkmcnt(4)
    ds_read_b128 a[152:155], v120 offset:17536
    v_add_f32 v83, v83, v68
    v_mfma_f32_16x16x32_bf16 v[64:67], a[132:135], v[132:135], v[64:67]
    s_waitcnt lgkmcnt(4)
    v_exp_f32 v69, v69
    v_mfma_f32_16x16x32_bf16 v[64:67], a[136:139], v[136:139], v[64:67]
    s_waitcnt lgkmcnt(3)
    v_cvt_pk_bf16_f32 v78, v68, v69
    v_add_f32 v83, v83, v69
    v_mfma_f32_16x16x32_bf16 v[64:67], a[140:143], v[140:143], v[64:67]
    v_exp_f32 v70, v70
    v_mfma_f32_16x16x32_bf16 a[80:83], a[176:179], v[72:75], a[80:83]
    ds_read_b128 a[156:159], v120 offset:17600
    v_add_f32 v83, v83, v70
    v_mfma_f32_16x16x32_bf16 a[84:87], a[180:183], v[72:75], a[84:87]
    v_exp_f32 v71, v71
    v_mfma_f32_16x16x32_bf16 a[88:91], a[184:187], v[72:75], a[88:91]
    v_cvt_pk_bf16_f32 v79, v70, v71
    v_add_f32 v83, v83, v71
    v_mfma_f32_16x16x32_bf16 a[92:95], a[188:191], v[72:75], a[92:95]
    s_waitcnt lgkmcnt(3)
    v_exp_f32 v64, v64
    v_mfma_f32_16x16x32_bf16 v[68:71], a[144:147], v[128:131], v[88:91]
    s_waitcnt lgkmcnt(2)
    v_add_f32 v80, v80, v64
    v_mfma_f32_16x16x32_bf16 v[68:71], a[148:151], v[132:135], v[68:71]
    s_waitcnt lgkmcnt(1)
    v_exp_f32 v65, v65
    v_mfma_f32_16x16x32_bf16 v[68:71], a[152:155], v[136:139], v[68:71]
    s_waitcnt lgkmcnt(0)
    v_cvt_pk_bf16_f32 v72, v64, v65
    v_add_f32 v80, v80, v65
    v_mfma_f32_16x16x32_bf16 v[68:71], a[156:159], v[140:143], v[68:71]
    v_exp_f32 v66, v66
    v_mfma_f32_16x16x32_bf16 a[96:99], a[160:163], v[76:79], a[96:99]
    ds_read_b64_tr_b16 a[160:161], v121 offset:16896
    v_add_f32 v80, v80, v66
    v_mfma_f32_16x16x32_bf16 a[100:103], a[164:167], v[76:79], a[100:103]
    ds_read_b64_tr_b16 a[162:163], v121 offset:17408
    v_exp_f32 v67, v67
    v_mfma_f32_16x16x32_bf16 a[104:107], a[168:171], v[76:79], a[104:107]
    v_cvt_pk_bf16_f32 v73, v66, v67
    v_add_f32 v80, v80, v67
    v_mfma_f32_16x16x32_bf16 a[108:111], a[172:175], v[76:79], a[108:111]
    ds_read_b64_tr_b16 a[164:165], v121 offset:16928
    v_exp_f32 v68, v68
    v_mfma_f32_16x16x32_bf16 v[64:67], a[128:131], v[144:147], v[92:95]
    ds_read_b64_tr_b16 a[166:167], v121 offset:17440
    v_add_f32 v80, v80, v68
    v_mfma_f32_16x16x32_bf16 v[64:67], a[132:135], v[148:151], v[64:67]
    ds_read_b64_tr_b16 a[168:169], v121 offset:16960
    v_exp_f32 v69, v69
    v_mfma_f32_16x16x32_bf16 v[64:67], a[136:139], v[152:155], v[64:67]
    v_cvt_pk_bf16_f32 v74, v68, v69
    v_add_f32 v80, v80, v69
    v_mfma_f32_16x16x32_bf16 v[64:67], a[140:143], v[156:159], v[64:67]
    ds_read_b64_tr_b16 a[170:171], v121 offset:17472
    v_exp_f32 v70, v70
    v_mfma_f32_16x16x32_bf16 a[112:115], a[176:179], v[76:79], a[112:115]
    ds_read_b64_tr_b16 a[172:173], v121 offset:16992
    v_add_f32 v80, v80, v70
    v_mfma_f32_16x16x32_bf16 a[116:119], a[180:183], v[76:79], a[116:119]
    ds_read_b64_tr_b16 a[174:175], v121 offset:17504
    v_exp_f32 v71, v71
    v_mfma_f32_16x16x32_bf16 a[120:123], a[184:187], v[76:79], a[120:123]
    v_cvt_pk_bf16_f32 v75, v70, v71
    v_add_f32 v80, v80, v71
    v_mfma_f32_16x16x32_bf16 a[124:127], a[188:191], v[76:79], a[124:127]
    ds_read_b64_tr_b16 a[176:177], v121 offset:17024
    v_exp_f32 v64, v64
    v_mfma_f32_16x16x32_bf16 v[68:71], a[144:147], v[144:147], v[92:95]
    ds_read_b64_tr_b16 a[178:179], v121 offset:17536
    v_add_f32 v81, v81, v64
    v_mfma_f32_16x16x32_bf16 v[68:71], a[148:151], v[148:151], v[68:71]
    ds_read_b64_tr_b16 a[180:181], v121 offset:17056
    v_exp_f32 v65, v65
    v_mfma_f32_16x16x32_bf16 v[68:71], a[152:155], v[152:155], v[68:71]
    v_cvt_pk_bf16_f32 v76, v64, v65
    v_add_f32 v81, v81, v65
    v_mfma_f32_16x16x32_bf16 v[68:71], a[156:159], v[156:159], v[68:71]
    s_waitcnt lgkmcnt(9)
    ds_read_b64_tr_b16 a[182:183], v121 offset:17568
    v_exp_f32 v66, v66
    v_mfma_f32_16x16x32_bf16 a[0:3], a[160:163], v[72:75], a[0:3]
    s_waitcnt lgkmcnt(8)
    ds_read_b64_tr_b16 a[184:185], v121 offset:17088
    v_add_f32 v81, v81, v66
    v_mfma_f32_16x16x32_bf16 a[4:7], a[164:167], v[72:75], a[4:7]
    s_waitcnt lgkmcnt(7)
    ds_read_b64_tr_b16 a[186:187], v121 offset:17600
    v_exp_f32 v67, v67
    v_mfma_f32_16x16x32_bf16 a[8:11], a[168:171], v[72:75], a[8:11]
    s_waitcnt lgkmcnt(6)
    v_cvt_pk_bf16_f32 v77, v66, v67
    v_add_f32 v81, v81, v67
    v_mfma_f32_16x16x32_bf16 a[12:15], a[172:175], v[72:75], a[12:15]
    ds_read_b64_tr_b16 a[188:189], v121 offset:17120
    v_exp_f32 v68, v68
    v_mfma_f32_16x16x32_bf16 v[64:67], a[128:131], v[160:163], v[96:99]
    ds_read_b64_tr_b16 a[190:191], v121 offset:17632
    v_add_f32 v81, v81, v68
    v_mfma_f32_16x16x32_bf16 v[64:67], a[132:135], v[164:167], v[64:67]
    v_exp_f32 v69, v69
    v_mfma_f32_16x16x32_bf16 v[64:67], a[136:139], v[168:171], v[64:67]
    v_cvt_pk_bf16_f32 v78, v68, v69
    v_add_f32 v81, v81, v69
    v_mfma_f32_16x16x32_bf16 v[64:67], a[140:143], v[172:175], v[64:67]
    s_waitcnt lgkmcnt(6)
    v_exp_f32 v70, v70
    v_mfma_f32_16x16x32_bf16 a[16:19], a[176:179], v[72:75], a[16:19]
    s_waitcnt lgkmcnt(4)
    v_add_f32 v81, v81, v70
    v_mfma_f32_16x16x32_bf16 a[20:23], a[180:183], v[72:75], a[20:23]
    s_waitcnt lgkmcnt(2)
    v_exp_f32 v71, v71
    v_mfma_f32_16x16x32_bf16 a[24:27], a[184:187], v[72:75], a[24:27]
    s_waitcnt lgkmcnt(0)
    v_cvt_pk_bf16_f32 v79, v70, v71
    v_add_f32 v81, v81, v71
    v_mfma_f32_16x16x32_bf16 a[28:31], a[188:191], v[72:75], a[28:31]
    v_exp_f32 v64, v64
    v_mfma_f32_16x16x32_bf16 v[68:71], a[144:147], v[160:163], v[96:99]
    v_add_f32 v82, v82, v64
    v_mfma_f32_16x16x32_bf16 v[68:71], a[148:151], v[164:167], v[68:71]
    v_exp_f32 v65, v65
    v_mfma_f32_16x16x32_bf16 v[68:71], a[152:155], v[168:171], v[68:71]
    v_cvt_pk_bf16_f32 v72, v64, v65
    v_add_f32 v82, v82, v65
    v_mfma_f32_16x16x32_bf16 v[68:71], a[156:159], v[172:175], v[68:71]
    v_exp_f32 v66, v66
    v_mfma_f32_16x16x32_bf16 a[32:35], a[160:163], v[76:79], a[32:35]
    v_add_f32 v82, v82, v66
    v_mfma_f32_16x16x32_bf16 a[36:39], a[164:167], v[76:79], a[36:39]
    v_exp_f32 v67, v67
    v_mfma_f32_16x16x32_bf16 a[40:43], a[168:171], v[76:79], a[40:43]
    v_cvt_pk_bf16_f32 v73, v66, v67
    v_add_f32 v82, v82, v67
    v_mfma_f32_16x16x32_bf16 a[44:47], a[172:175], v[76:79], a[44:47]
    v_exp_f32 v68, v68
    v_mfma_f32_16x16x32_bf16 v[64:67], a[128:131], v[176:179], v[100:103]
    ds_read_b128 a[128:131], v120 offset:25344
    v_add_f32 v82, v82, v68
    v_mfma_f32_16x16x32_bf16 v[64:67], a[132:135], v[180:183], v[64:67]
    v_exp_f32 v69, v69
    v_mfma_f32_16x16x32_bf16 v[64:67], a[136:139], v[184:187], v[64:67]
    v_cvt_pk_bf16_f32 v74, v68, v69
    v_add_f32 v82, v82, v69
    v_mfma_f32_16x16x32_bf16 v[64:67], a[140:143], v[188:191], v[64:67]
    v_exp_f32 v70, v70
    v_mfma_f32_16x16x32_bf16 a[48:51], a[176:179], v[76:79], a[48:51]
    ds_read_b128 a[132:135], v120 offset:25408
    v_add_f32 v82, v82, v70
    v_mfma_f32_16x16x32_bf16 a[52:55], a[180:183], v[76:79], a[52:55]
    ds_read_b128 a[136:139], v120 offset:25472
    v_exp_f32 v71, v71
    v_mfma_f32_16x16x32_bf16 a[56:59], a[184:187], v[76:79], a[56:59]
    v_cvt_pk_bf16_f32 v75, v70, v71
    v_add_f32 v82, v82, v71
    v_mfma_f32_16x16x32_bf16 a[60:63], a[188:191], v[76:79], a[60:63]
    v_exp_f32 v64, v64
    v_mfma_f32_16x16x32_bf16 v[68:71], a[144:147], v[176:179], v[100:103]
    ds_read_b128 a[140:143], v120 offset:25536
    v_add_f32 v83, v83, v64
    v_mfma_f32_16x16x32_bf16 v[68:71], a[148:151], v[180:183], v[68:71]
    v_exp_f32 v65, v65
    v_mfma_f32_16x16x32_bf16 v[68:71], a[152:155], v[184:187], v[68:71]
    v_cvt_pk_bf16_f32 v76, v64, v65
    v_add_f32 v83, v83, v65
    v_mfma_f32_16x16x32_bf16 v[68:71], a[156:159], v[188:191], v[68:71]
    v_exp_f32 v66, v66
    v_mfma_f32_16x16x32_bf16 a[64:67], a[160:163], v[72:75], a[64:67]
    ds_read_b128 a[144:147], v120 offset:25856
    v_add_f32 v83, v83, v66
    v_mfma_f32_16x16x32_bf16 a[68:71], a[164:167], v[72:75], a[68:71]
    ds_read_b128 a[148:151], v120 offset:25920
    v_exp_f32 v67, v67
    v_mfma_f32_16x16x32_bf16 a[72:75], a[168:171], v[72:75], a[72:75]
    v_cvt_pk_bf16_f32 v77, v66, v67
    v_add_f32 v83, v83, v67
    v_mfma_f32_16x16x32_bf16 a[76:79], a[172:175], v[72:75], a[76:79]
    s_waitcnt lgkmcnt(5)
    v_exp_f32 v68, v68
    v_mfma_f32_16x16x32_bf16 v[64:67], a[128:131], v[128:131], v[88:91]
    s_waitcnt lgkmcnt(4)
    ds_read_b128 a[152:155], v120 offset:25984
    v_add_f32 v83, v83, v68
    v_mfma_f32_16x16x32_bf16 v[64:67], a[132:135], v[132:135], v[64:67]
    s_waitcnt lgkmcnt(4)
    v_exp_f32 v69, v69
    v_mfma_f32_16x16x32_bf16 v[64:67], a[136:139], v[136:139], v[64:67]
    s_waitcnt lgkmcnt(3)
    v_cvt_pk_bf16_f32 v78, v68, v69
    v_add_f32 v83, v83, v69
    v_mfma_f32_16x16x32_bf16 v[64:67], a[140:143], v[140:143], v[64:67]
    v_exp_f32 v70, v70
    v_mfma_f32_16x16x32_bf16 a[80:83], a[176:179], v[72:75], a[80:83]
    ds_read_b128 a[156:159], v120 offset:26048
    v_add_f32 v83, v83, v70
    v_mfma_f32_16x16x32_bf16 a[84:87], a[180:183], v[72:75], a[84:87]
    v_exp_f32 v71, v71
    v_mfma_f32_16x16x32_bf16 a[88:91], a[184:187], v[72:75], a[88:91]
    v_cvt_pk_bf16_f32 v79, v70, v71
    v_add_f32 v83, v83, v71
    v_mfma_f32_16x16x32_bf16 a[92:95], a[188:191], v[72:75], a[92:95]
    s_waitcnt lgkmcnt(3)
    v_exp_f32 v64, v64
    v_mfma_f32_16x16x32_bf16 v[68:71], a[144:147], v[128:131], v[88:91]
    s_waitcnt lgkmcnt(2)
    v_add_f32 v80, v80, v64
    v_mfma_f32_16x16x32_bf16 v[68:71], a[148:151], v[132:135], v[68:71]
    s_waitcnt lgkmcnt(1)
    v_exp_f32 v65, v65
    v_mfma_f32_16x16x32_bf16 v[68:71], a[152:155], v[136:139], v[68:71]
    s_waitcnt lgkmcnt(0)
    v_cvt_pk_bf16_f32 v72, v64, v65
    v_add_f32 v80, v80, v65
    v_mfma_f32_16x16x32_bf16 v[68:71], a[156:159], v[140:143], v[68:71]
    v_exp_f32 v66, v66
    v_mfma_f32_16x16x32_bf16 a[96:99], a[160:163], v[76:79], a[96:99]
    ds_read_b64_tr_b16 a[160:161], v121 offset:25344
    v_add_f32 v80, v80, v66
    v_mfma_f32_16x16x32_bf16 a[100:103], a[164:167], v[76:79], a[100:103]
    ds_read_b64_tr_b16 a[162:163], v121 offset:25856
    v_exp_f32 v67, v67
    v_mfma_f32_16x16x32_bf16 a[104:107], a[168:171], v[76:79], a[104:107]
    v_cvt_pk_bf16_f32 v73, v66, v67
    v_add_f32 v80, v80, v67
    v_mfma_f32_16x16x32_bf16 a[108:111], a[172:175], v[76:79], a[108:111]
    ds_read_b64_tr_b16 a[164:165], v121 offset:25376
    v_exp_f32 v68, v68
    v_mfma_f32_16x16x32_bf16 v[64:67], a[128:131], v[144:147], v[92:95]
    ds_read_b64_tr_b16 a[166:167], v121 offset:25888
    v_add_f32 v80, v80, v68
    v_mfma_f32_16x16x32_bf16 v[64:67], a[132:135], v[148:151], v[64:67]
    ds_read_b64_tr_b16 a[168:169], v121 offset:25408
    v_exp_f32 v69, v69
    v_mfma_f32_16x16x32_bf16 v[64:67], a[136:139], v[152:155], v[64:67]
    v_cvt_pk_bf16_f32 v74, v68, v69
    v_add_f32 v80, v80, v69
    v_mfma_f32_16x16x32_bf16 v[64:67], a[140:143], v[156:159], v[64:67]
    ds_read_b64_tr_b16 a[170:171], v121 offset:25920
    v_exp_f32 v70, v70
    v_mfma_f32_16x16x32_bf16 a[112:115], a[176:179], v[76:79], a[112:115]
    ds_read_b64_tr_b16 a[172:173], v121 offset:25440
    v_add_f32 v80, v80, v70
    v_mfma_f32_16x16x32_bf16 a[116:119], a[180:183], v[76:79], a[116:119]
    ds_read_b64_tr_b16 a[174:175], v121 offset:25952
    v_exp_f32 v71, v71
    v_mfma_f32_16x16x32_bf16 a[120:123], a[184:187], v[76:79], a[120:123]
    v_cvt_pk_bf16_f32 v75, v70, v71
    v_add_f32 v80, v80, v71
    v_mfma_f32_16x16x32_bf16 a[124:127], a[188:191], v[76:79], a[124:127]
    ds_read_b64_tr_b16 a[176:177], v121 offset:25472
    v_exp_f32 v64, v64
    v_mfma_f32_16x16x32_bf16 v[68:71], a[144:147], v[144:147], v[92:95]
    ds_read_b64_tr_b16 a[178:179], v121 offset:25984
    v_add_f32 v81, v81, v64
    v_mfma_f32_16x16x32_bf16 v[68:71], a[148:151], v[148:151], v[68:71]
    ds_read_b64_tr_b16 a[180:181], v121 offset:25504
    v_exp_f32 v65, v65
    v_mfma_f32_16x16x32_bf16 v[68:71], a[152:155], v[152:155], v[68:71]
    v_cvt_pk_bf16_f32 v76, v64, v65
    v_add_f32 v81, v81, v65
    v_mfma_f32_16x16x32_bf16 v[68:71], a[156:159], v[156:159], v[68:71]
    s_waitcnt lgkmcnt(9)
    ds_read_b64_tr_b16 a[182:183], v121 offset:26016
    v_exp_f32 v66, v66
    v_mfma_f32_16x16x32_bf16 a[0:3], a[160:163], v[72:75], a[0:3]
    s_waitcnt lgkmcnt(8)
    ds_read_b64_tr_b16 a[184:185], v121 offset:25536
    v_add_f32 v81, v81, v66
    v_mfma_f32_16x16x32_bf16 a[4:7], a[164:167], v[72:75], a[4:7]
    s_waitcnt lgkmcnt(7)
    ds_read_b64_tr_b16 a[186:187], v121 offset:26048
    v_exp_f32 v67, v67
    v_mfma_f32_16x16x32_bf16 a[8:11], a[168:171], v[72:75], a[8:11]
    s_waitcnt lgkmcnt(6)
    v_cvt_pk_bf16_f32 v77, v66, v67
    v_add_f32 v81, v81, v67
    v_mfma_f32_16x16x32_bf16 a[12:15], a[172:175], v[72:75], a[12:15]
    ds_read_b64_tr_b16 a[188:189], v121 offset:25568
    v_exp_f32 v68, v68
    v_mfma_f32_16x16x32_bf16 v[64:67], a[128:131], v[160:163], v[96:99]
    ds_read_b64_tr_b16 a[190:191], v121 offset:26080
    v_add_f32 v81, v81, v68
    v_mfma_f32_16x16x32_bf16 v[64:67], a[132:135], v[164:167], v[64:67]
    v_exp_f32 v69, v69
    v_mfma_f32_16x16x32_bf16 v[64:67], a[136:139], v[168:171], v[64:67]
    v_cvt_pk_bf16_f32 v78, v68, v69
    v_add_f32 v81, v81, v69
    v_mfma_f32_16x16x32_bf16 v[64:67], a[140:143], v[172:175], v[64:67]
    s_waitcnt lgkmcnt(6)
    v_exp_f32 v70, v70
    v_mfma_f32_16x16x32_bf16 a[16:19], a[176:179], v[72:75], a[16:19]
    s_waitcnt lgkmcnt(4)
    v_add_f32 v81, v81, v70
    v_mfma_f32_16x16x32_bf16 a[20:23], a[180:183], v[72:75], a[20:23]
    s_waitcnt lgkmcnt(2)
    v_exp_f32 v71, v71
    v_mfma_f32_16x16x32_bf16 a[24:27], a[184:187], v[72:75], a[24:27]
    s_waitcnt lgkmcnt(0)
    v_cvt_pk_bf16_f32 v79, v70, v71
    v_add_f32 v81, v81, v71
    v_mfma_f32_16x16x32_bf16 a[28:31], a[188:191], v[72:75], a[28:31]
    v_exp_f32 v64, v64
    v_mfma_f32_16x16x32_bf16 v[68:71], a[144:147], v[160:163], v[96:99]
    v_add_f32 v82, v82, v64
    v_mfma_f32_16x16x32_bf16 v[68:71], a[148:151], v[164:167], v[68:71]
    v_exp_f32 v65, v65
    v_mfma_f32_16x16x32_bf16 v[68:71], a[152:155], v[168:171], v[68:71]
    v_cvt_pk_bf16_f32 v72, v64, v65
    v_add_f32 v82, v82, v65
    v_mfma_f32_16x16x32_bf16 v[68:71], a[156:159], v[172:175], v[68:71]
    v_exp_f32 v66, v66
    v_mfma_f32_16x16x32_bf16 a[32:35], a[160:163], v[76:79], a[32:35]
    v_add_f32 v82, v82, v66
    v_mfma_f32_16x16x32_bf16 a[36:39], a[164:167], v[76:79], a[36:39]
    v_exp_f32 v67, v67
    v_mfma_f32_16x16x32_bf16 a[40:43], a[168:171], v[76:79], a[40:43]
    v_cvt_pk_bf16_f32 v73, v66, v67
    v_add_f32 v82, v82, v67
    v_mfma_f32_16x16x32_bf16 a[44:47], a[172:175], v[76:79], a[44:47]
    v_exp_f32 v68, v68
    v_mfma_f32_16x16x32_bf16 v[64:67], a[128:131], v[176:179], v[100:103]
    ds_read_b128 a[128:131], v120 offset:0
    v_add_f32 v82, v82, v68
    v_mfma_f32_16x16x32_bf16 v[64:67], a[132:135], v[180:183], v[64:67]
    v_exp_f32 v69, v69
    v_mfma_f32_16x16x32_bf16 v[64:67], a[136:139], v[184:187], v[64:67]
    v_cvt_pk_bf16_f32 v74, v68, v69
    v_add_f32 v82, v82, v69
    v_mfma_f32_16x16x32_bf16 v[64:67], a[140:143], v[188:191], v[64:67]
    v_exp_f32 v70, v70
    v_mfma_f32_16x16x32_bf16 a[48:51], a[176:179], v[76:79], a[48:51]
    ds_read_b128 a[132:135], v120 offset:64
    v_add_f32 v82, v82, v70
    v_mfma_f32_16x16x32_bf16 a[52:55], a[180:183], v[76:79], a[52:55]
    ds_read_b128 a[136:139], v120 offset:128
    v_exp_f32 v71, v71
    v_mfma_f32_16x16x32_bf16 a[56:59], a[184:187], v[76:79], a[56:59]
    v_cvt_pk_bf16_f32 v75, v70, v71
    v_add_f32 v82, v82, v71
    v_mfma_f32_16x16x32_bf16 a[60:63], a[188:191], v[76:79], a[60:63]
    v_exp_f32 v64, v64
    v_mfma_f32_16x16x32_bf16 v[68:71], a[144:147], v[176:179], v[100:103]
    ds_read_b128 a[140:143], v120 offset:192
    v_add_f32 v83, v83, v64
    v_mfma_f32_16x16x32_bf16 v[68:71], a[148:151], v[180:183], v[68:71]
    v_exp_f32 v65, v65
    v_mfma_f32_16x16x32_bf16 v[68:71], a[152:155], v[184:187], v[68:71]
    v_cvt_pk_bf16_f32 v76, v64, v65
    v_add_f32 v83, v83, v65
    v_mfma_f32_16x16x32_bf16 v[68:71], a[156:159], v[188:191], v[68:71]
    v_exp_f32 v66, v66
    v_mfma_f32_16x16x32_bf16 a[64:67], a[160:163], v[72:75], a[64:67]
    ds_read_b128 a[144:147], v120 offset:512
    v_add_f32 v83, v83, v66
    v_mfma_f32_16x16x32_bf16 a[68:71], a[164:167], v[72:75], a[68:71]
    ds_read_b128 a[148:151], v120 offset:576
    v_exp_f32 v67, v67
    v_mfma_f32_16x16x32_bf16 a[72:75], a[168:171], v[72:75], a[72:75]
    v_cvt_pk_bf16_f32 v77, v66, v67
    v_add_f32 v83, v83, v67
    v_mfma_f32_16x16x32_bf16 a[76:79], a[172:175], v[72:75], a[76:79]
    s_waitcnt lgkmcnt(5)
    v_exp_f32 v68, v68
    v_mfma_f32_16x16x32_bf16 v[64:67], a[128:131], v[192:195], v[104:107]
    s_waitcnt lgkmcnt(4)
    ds_read_b128 a[152:155], v120 offset:640
    v_add_f32 v83, v83, v68
    v_mfma_f32_16x16x32_bf16 v[64:67], a[132:135], v[196:199], v[64:67]
    s_waitcnt lgkmcnt(4)
    v_exp_f32 v69, v69
    v_mfma_f32_16x16x32_bf16 v[64:67], a[136:139], v[200:203], v[64:67]
    s_waitcnt lgkmcnt(3)
    v_cvt_pk_bf16_f32 v78, v68, v69
    v_add_f32 v83, v83, v69
    v_mfma_f32_16x16x32_bf16 v[64:67], a[140:143], v[204:207], v[64:67]
    v_exp_f32 v70, v70
    v_mfma_f32_16x16x32_bf16 a[80:83], a[176:179], v[72:75], a[80:83]
    ds_read_b128 a[156:159], v120 offset:704
    v_add_f32 v83, v83, v70
    v_mfma_f32_16x16x32_bf16 a[84:87], a[180:183], v[72:75], a[84:87]
    v_exp_f32 v71, v71
    v_mfma_f32_16x16x32_bf16 a[88:91], a[184:187], v[72:75], a[88:91]
    v_cvt_pk_bf16_f32 v79, v70, v71
    v_add_f32 v83, v83, v71
    v_mfma_f32_16x16x32_bf16 a[92:95], a[188:191], v[72:75], a[92:95]
    s_waitcnt lgkmcnt(3)
    v_exp_f32 v64, v64
    v_mfma_f32_16x16x32_bf16 v[68:71], a[144:147], v[192:195], v[104:107]
    s_waitcnt lgkmcnt(2)
    v_add_f32 v84, v84, v64
    v_permlane32_swap_b32 v80, v81
    v_mfma_f32_16x16x32_bf16 v[68:71], a[148:151], v[196:199], v[68:71]
    s_waitcnt lgkmcnt(1)
    v_exp_f32 v65, v65
    v_permlane32_swap_b32 v82, v83
    v_add_f32 v80, v80, v81
    v_add_f32 v82, v82, v83
    v_mfma_f32_16x16x32_bf16 v[68:71], a[152:155], v[200:203], v[68:71]
    s_waitcnt lgkmcnt(0)
    v_cvt_pk_bf16_f32 v72, v64, v65
    v_add_f32 v84, v84, v65
    v_permlane16_swap_b32 v80, v82
    v_add_f32 v80, v80, v82
    v_cmp_nge_f32 vcc, 0x53800000, v80
    v_mfma_f32_16x16x32_bf16 v[68:71], a[156:159], v[204:207], v[68:71]
    v_exp_f32 v66, v66
    v_rcp_f32 v80, v80
    v_mfma_f32_16x16x32_bf16 a[96:99], a[160:163], v[76:79], a[96:99]
    s_or_b64 s[48:49], s[48:49], vcc
    ds_read_b64_tr_b16 a[160:161], v121 offset:0
    v_add_f32 v84, v84, v66
    v_mov_b32 v82, v80
    v_mfma_f32_16x16x32_bf16 a[100:103], a[164:167], v[76:79], a[100:103]
    ds_read_b64_tr_b16 a[162:163], v121 offset:512
    v_exp_f32 v67, v67
    v_permlane16_swap_b32 v80, v82
    v_mov_b32 v81, v80
    v_mov_b32 v83, v82
    v_mfma_f32_16x16x32_bf16 a[104:107], a[168:171], v[76:79], a[104:107]
    v_cvt_pk_bf16_f32 v73, v66, v67
    v_add_f32 v84, v84, v67
    v_permlane32_swap_b32 v80, v81
    v_mfma_f32_16x16x32_bf16 a[108:111], a[172:175], v[76:79], a[108:111]
    ds_read_b64_tr_b16 a[164:165], v121 offset:32
    v_exp_f32 v68, v68
    v_permlane32_swap_b32 v82, v83
    v_accvgpr_read_b32 v88, a0
    v_accvgpr_read_b32 v89, a1
    v_mfma_f32_16x16x32_bf16 v[64:67], a[128:131], v[208:211], v[108:111]
    ds_read_b64_tr_b16 a[166:167], v121 offset:544
    v_add_f32 v84, v84, v68
    v_accvgpr_read_b32 v90, a2
    v_accvgpr_read_b32 v91, a3
    v_accvgpr_read_b32 v92, a4
    v_mfma_f32_16x16x32_bf16 v[64:67], a[132:135], v[212:215], v[64:67]
    ds_read_b64_tr_b16 a[168:169], v121 offset:64
    v_exp_f32 v69, v69
    v_accvgpr_read_b32 v93, a5
    v_accvgpr_read_b32 v94, a6
    v_accvgpr_read_b32 v95, a7
    v_mfma_f32_16x16x32_bf16 v[64:67], a[136:139], v[216:219], v[64:67]
    v_cvt_pk_bf16_f32 v74, v68, v69
    v_add_f32 v84, v84, v69
    v_mul_f32 v88, v88, v80
    v_mul_f32 v89, v89, v80
    v_mul_f32 v90, v90, v80
    v_mfma_f32_16x16x32_bf16 v[64:67], a[140:143], v[220:223], v[64:67]
    ds_read_b64_tr_b16 a[170:171], v121 offset:576
    v_exp_f32 v70, v70
    v_mul_f32 v91, v91, v80
    v_mul_f32 v92, v92, v80
    v_mul_f32 v93, v93, v80
    v_mfma_f32_16x16x32_bf16 a[112:115], a[176:179], v[76:79], a[112:115]
    ds_read_b64_tr_b16 a[172:173], v121 offset:96
    v_add_f32 v84, v84, v70
    v_mul_f32 v94, v94, v80
    v_mul_f32 v95, v95, v80
    v_cvt_pk_bf16_f32 v96, v88, v89
    v_mfma_f32_16x16x32_bf16 a[116:119], a[180:183], v[76:79], a[116:119]
    ds_read_b64_tr_b16 a[174:175], v121 offset:608
    v_exp_f32 v71, v71
    v_cvt_pk_bf16_f32 v97, v90, v91
    v_cvt_pk_bf16_f32 v98, v92, v93
    v_cvt_pk_bf16_f32 v99, v94, v95
    v_mfma_f32_16x16x32_bf16 a[120:123], a[184:187], v[76:79], a[120:123]
    ds_write_b64 v123, v[96:97] offset:0
    v_cvt_pk_bf16_f32 v75, v70, v71
    v_add_f32 v84, v84, v71
    v_mfma_f32_16x16x32_bf16 a[124:127], a[188:191], v[76:79], a[124:127]
    ds_read_b64_tr_b16 a[176:177], v121 offset:128
    ds_write_b64 v123, v[98:99] offset:32
    v_exp_f32 v64, v64
    v_accvgpr_read_b32 v88, a8
    v_accvgpr_read_b32 v89, a9
    v_mfma_f32_16x16x32_bf16 v[68:71], a[144:147], v[208:211], v[108:111]
    ds_read_b64_tr_b16 a[178:179], v121 offset:640
    v_add_f32 v85, v85, v64
    v_accvgpr_read_b32 v90, a10
    v_accvgpr_read_b32 v91, a11
    v_accvgpr_read_b32 v92, a12
    v_mfma_f32_16x16x32_bf16 v[68:71], a[148:151], v[212:215], v[68:71]
    ds_read_b64_tr_b16 a[180:181], v121 offset:160
    v_exp_f32 v65, v65
    v_accvgpr_read_b32 v93, a13
    v_accvgpr_read_b32 v94, a14
    v_accvgpr_read_b32 v95, a15
    v_mfma_f32_16x16x32_bf16 v[68:71], a[152:155], v[216:219], v[68:71]
    v_cvt_pk_bf16_f32 v76, v64, v65
    v_add_f32 v85, v85, v65
    v_mul_f32 v88, v88, v80
    v_mul_f32 v89, v89, v80
    v_mul_f32 v90, v90, v80
    v_mfma_f32_16x16x32_bf16 v[68:71], a[156:159], v[220:223], v[68:71]
    s_waitcnt lgkmcnt(11)
    ds_read_b64_tr_b16 a[182:183], v121 offset:672
    v_exp_f32 v66, v66
    v_mul_f32 v91, v91, v80
    v_mul_f32 v92, v92, v80
    v_mul_f32 v93, v93, v80
    v_mfma_f32_16x16x32_bf16 v[0:3], a[160:163], v[72:75], v[0:3]
    s_waitcnt lgkmcnt(10)
    ds_read_b64_tr_b16 a[184:185], v121 offset:192
    v_add_f32 v85, v85, v66
    v_mul_f32 v94, v94, v80
    v_mul_f32 v95, v95, v80
    v_cvt_pk_bf16_f32 v96, v88, v89
    v_mfma_f32_16x16x32_bf16 v[4:7], a[164:167], v[72:75], v[4:7]
    s_waitcnt lgkmcnt(9)
    ds_read_b64_tr_b16 a[186:187], v121 offset:704
    v_exp_f32 v67, v67
    v_cvt_pk_bf16_f32 v97, v90, v91
    v_cvt_pk_bf16_f32 v98, v92, v93
    v_cvt_pk_bf16_f32 v99, v94, v95
    v_mfma_f32_16x16x32_bf16 v[8:11], a[168:171], v[72:75], v[8:11]
    s_waitcnt lgkmcnt(8)
    ds_write_b64 v123, v[96:97] offset:64
    v_cvt_pk_bf16_f32 v77, v66, v67
    v_add_f32 v85, v85, v67
    v_mfma_f32_16x16x32_bf16 v[12:15], a[172:175], v[72:75], v[12:15]
    ds_read_b64_tr_b16 a[188:189], v121 offset:224
    ds_write_b64 v123, v[98:99] offset:96
    v_exp_f32 v68, v68
    v_accvgpr_read_b32 v88, a16
    v_accvgpr_read_b32 v89, a17
    v_mfma_f32_16x16x32_bf16 v[64:67], a[128:131], v[224:227], v[112:115]
    ds_read_b64_tr_b16 a[190:191], v121 offset:736
    ds_read_b128 a[128:131], v120 offset:8448
    v_add_f32 v85, v85, v68
    v_accvgpr_read_b32 v90, a18
    v_accvgpr_read_b32 v91, a19
    v_accvgpr_read_b32 v92, a20
    v_mfma_f32_16x16x32_bf16 v[64:67], a[132:135], v[228:231], v[64:67]
    v_exp_f32 v69, v69
    v_accvgpr_read_b32 v93, a21
    v_accvgpr_read_b32 v94, a22
    v_accvgpr_read_b32 v95, a23
    v_mfma_f32_16x16x32_bf16 v[64:67], a[136:139], v[232:235], v[64:67]
    v_cvt_pk_bf16_f32 v78, v68, v69
    v_add_f32 v85, v85, v69
    v_mul_f32 v88, v88, v80
    v_mul_f32 v89, v89, v80
    v_mul_f32 v90, v90, v80
    v_mfma_f32_16x16x32_bf16 v[64:67], a[140:143], v[236:239], v[64:67]
    s_waitcnt lgkmcnt(9)
    v_exp_f32 v70, v70
    v_mul_f32 v91, v91, v80
    v_mul_f32 v92, v92, v80
    v_mul_f32 v93, v93, v80
    v_mfma_f32_16x16x32_bf16 v[16:19], a[176:179], v[72:75], v[16:19]
    s_waitcnt lgkmcnt(7)
    ds_read_b128 a[132:135], v120 offset:8512
    v_add_f32 v85, v85, v70
    v_mul_f32 v94, v94, v80
    v_mul_f32 v95, v95, v80
    v_cvt_pk_bf16_f32 v96, v88, v89
    v_mfma_f32_16x16x32_bf16 v[20:23], a[180:183], v[72:75], v[20:23]
    s_waitcnt lgkmcnt(6)
    ds_read_b128 a[136:139], v120 offset:8576
    v_exp_f32 v71, v71
    v_cvt_pk_bf16_f32 v97, v90, v91
    v_cvt_pk_bf16_f32 v98, v92, v93
    v_cvt_pk_bf16_f32 v99, v94, v95
    v_mfma_f32_16x16x32_bf16 v[24:27], a[184:187], v[72:75], v[24:27]
    s_waitcnt lgkmcnt(3)
    ds_write_b64 v123, v[96:97] offset:128
    v_cvt_pk_bf16_f32 v79, v70, v71
    v_add_f32 v85, v85, v71
    v_mfma_f32_16x16x32_bf16 v[28:31], a[188:191], v[72:75], v[28:31]
    ds_write_b64 v123, v[98:99] offset:160
    v_exp_f32 v64, v64
    v_accvgpr_read_b32 v88, a24
    v_accvgpr_read_b32 v89, a25
    v_mfma_f32_16x16x32_bf16 v[68:71], a[144:147], v[224:227], v[112:115]
    ds_read_b128 a[140:143], v120 offset:8640
    v_add_f32 v86, v86, v64
    v_accvgpr_read_b32 v90, a26
    v_accvgpr_read_b32 v91, a27
    v_accvgpr_read_b32 v92, a28
    v_mfma_f32_16x16x32_bf16 v[68:71], a[148:151], v[228:231], v[68:71]
    v_exp_f32 v65, v65
    v_accvgpr_read_b32 v93, a29
    v_accvgpr_read_b32 v94, a30
    v_accvgpr_read_b32 v95, a31
    v_mfma_f32_16x16x32_bf16 v[68:71], a[152:155], v[232:235], v[68:71]
    v_cvt_pk_bf16_f32 v72, v64, v65
    v_add_f32 v86, v86, v65
    v_mul_f32 v88, v88, v80
    v_mul_f32 v89, v89, v80
    v_mul_f32 v90, v90, v80
    v_mfma_f32_16x16x32_bf16 v[68:71], a[156:159], v[236:239], v[68:71]
    v_exp_f32 v66, v66
    v_mul_f32 v91, v91, v80
    v_mul_f32 v92, v92, v80
    v_mul_f32 v93, v93, v80
    v_mfma_f32_16x16x32_bf16 v[32:35], a[160:163], v[76:79], v[32:35]
    ds_read_b128 a[144:147], v120 offset:8960
    v_add_f32 v86, v86, v66
    v_mul_f32 v94, v94, v80
    v_mul_f32 v95, v95, v80
    v_cvt_pk_bf16_f32 v96, v88, v89
    v_mfma_f32_16x16x32_bf16 v[36:39], a[164:167], v[76:79], v[36:39]
    ds_read_b128 a[148:151], v120 offset:9024
    v_exp_f32 v67, v67
    v_cvt_pk_bf16_f32 v97, v90, v91
    v_cvt_pk_bf16_f32 v98, v92, v93
    v_cvt_pk_bf16_f32 v99, v94, v95
    v_mfma_f32_16x16x32_bf16 v[40:43], a[168:171], v[76:79], v[40:43]
    ds_write_b64 v123, v[96:97] offset:192
    v_cvt_pk_bf16_f32 v73, v66, v67
    v_add_f32 v86, v86, v67
    v_mfma_f32_16x16x32_bf16 v[44:47], a[172:175], v[76:79], v[44:47]
    s_waitcnt lgkmcnt(8)
    ds_write_b64 v123, v[98:99] offset:224
    v_exp_f32 v68, v68
    v_mfma_f32_16x16x32_bf16 v[64:67], a[128:131], v[192:195], v[104:107]
    s_waitcnt lgkmcnt(8)
    ds_read_b128 a[152:155], v120 offset:9088
    ds_read_b128 v[100:103], v124 offset:0
    v_add_f32 v86, v86, v68
    v_accvgpr_read_b32 v88, a32
    v_accvgpr_read_b32 v89, a33
    v_mfma_f32_16x16x32_bf16 v[64:67], a[132:135], v[196:199], v[64:67]
    s_waitcnt lgkmcnt(9)
    v_exp_f32 v69, v69
    v_accvgpr_read_b32 v90, a34
    v_accvgpr_read_b32 v91, a35
    v_accvgpr_read_b32 v92, a36
    v_mfma_f32_16x16x32_bf16 v[64:67], a[136:139], v[200:203], v[64:67]
    s_waitcnt lgkmcnt(6)
    v_cvt_pk_bf16_f32 v74, v68, v69
    v_add_f32 v86, v86, v69
    v_accvgpr_read_b32 v93, a37
    v_accvgpr_read_b32 v94, a38
    v_accvgpr_read_b32 v95, a39
    v_mfma_f32_16x16x32_bf16 v[64:67], a[140:143], v[204:207], v[64:67]
    v_exp_f32 v70, v70
    v_mul_f32 v88, v88, v81
    v_mul_f32 v89, v89, v81
    v_mul_f32 v90, v90, v81
    v_mfma_f32_16x16x32_bf16 v[48:51], a[176:179], v[76:79], v[48:51]
    ds_read_b128 a[156:159], v120 offset:9152
    v_add_f32 v86, v86, v70
    v_mul_f32 v91, v91, v81
    v_mul_f32 v92, v92, v81
    v_mul_f32 v93, v93, v81
    v_mfma_f32_16x16x32_bf16 v[52:55], a[180:183], v[76:79], v[52:55]
    v_exp_f32 v71, v71
    v_mul_f32 v94, v94, v81
    v_mul_f32 v95, v95, v81
    v_cvt_pk_bf16_f32 v96, v88, v89
    v_mfma_f32_16x16x32_bf16 v[56:59], a[184:187], v[76:79], v[56:59]
    v_cvt_pk_bf16_f32 v75, v70, v71
    v_add_f32 v86, v86, v71
    v_cvt_pk_bf16_f32 v97, v90, v91
    v_cvt_pk_bf16_f32 v98, v92, v93
    v_cvt_pk_bf16_f32 v99, v94, v95
    v_mfma_f32_16x16x32_bf16 v[60:63], a[188:191], v[76:79], v[60:63]
    s_waitcnt lgkmcnt(6)
    ds_write_b64 v123, v[96:97] offset:4352
    v_exp_f32 v64, v64
    v_mfma_f32_16x16x32_bf16 v[68:71], a[144:147], v[192:195], v[104:107]
    s_waitcnt lgkmcnt(6)
    ds_write_b64 v123, v[98:99] offset:4384
    v_add_f32 v84, v84, v64
    v_mfma_f32_16x16x32_bf16 v[68:71], a[148:151], v[196:199], v[68:71]
    s_waitcnt lgkmcnt(15)
    s_waitcnt lgkmcnt(3)
    buffer_store_dwordx4 v[100:103], v122, s[24:27], s39 offen offset:0 sc1 nt
    v_exp_f32 v65, v65
    v_mfma_f32_16x16x32_bf16 v[68:71], a[152:155], v[200:203], v[68:71]
    s_waitcnt lgkmcnt(2)
    ds_read_b128 v[100:103], v124 offset:1088
    v_cvt_pk_bf16_f32 v76, v64, v65
    v_add_f32 v84, v84, v65
    v_accvgpr_read_b32 v88, a40
    v_accvgpr_read_b32 v89, a41
    v_mfma_f32_16x16x32_bf16 v[68:71], a[156:159], v[204:207], v[68:71]
    v_exp_f32 v66, v66
    v_accvgpr_read_b32 v90, a42
    v_accvgpr_read_b32 v91, a43
    v_accvgpr_read_b32 v92, a44
    v_mfma_f32_16x16x32_bf16 a[192:195], a[160:163], v[72:75], a[192:195]
    ds_read_b64_tr_b16 a[160:161], v121 offset:8448
    v_add_f32 v84, v84, v66
    v_accvgpr_read_b32 v93, a45
    v_accvgpr_read_b32 v94, a46
    v_accvgpr_read_b32 v95, a47
    v_mfma_f32_16x16x32_bf16 a[196:199], a[164:167], v[72:75], a[196:199]
    ds_read_b64_tr_b16 a[162:163], v121 offset:8960
    v_exp_f32 v67, v67
    v_mul_f32 v88, v88, v81
    v_mul_f32 v89, v89, v81
    v_mul_f32 v90, v90, v81
    v_mfma_f32_16x16x32_bf16 a[200:203], a[168:171], v[72:75], a[200:203]
    v_cvt_pk_bf16_f32 v77, v66, v67
    v_add_f32 v84, v84, v67
    v_mul_f32 v91, v91, v81
    v_mul_f32 v92, v92, v81
    v_mul_f32 v93, v93, v81
    v_mfma_f32_16x16x32_bf16 a[204:207], a[172:175], v[72:75], a[204:207]
    ds_read_b64_tr_b16 a[164:165], v121 offset:8480
    v_exp_f32 v68, v68
    v_mul_f32 v94, v94, v81
    v_mul_f32 v95, v95, v81
    v_cvt_pk_bf16_f32 v96, v88, v89
    v_mfma_f32_16x16x32_bf16 v[64:67], a[128:131], v[208:211], v[108:111]
    ds_read_b64_tr_b16 a[166:167], v121 offset:8992
    v_add_f32 v84, v84, v68
    v_cvt_pk_bf16_f32 v97, v90, v91
    v_cvt_pk_bf16_f32 v98, v92, v93
    v_cvt_pk_bf16_f32 v99, v94, v95
    v_mfma_f32_16x16x32_bf16 v[64:67], a[132:135], v[212:215], v[64:67]
    ds_read_b64_tr_b16 a[168:169], v121 offset:8512
    ds_write_b64 v123, v[96:97] offset:4416
    v_exp_f32 v69, v69
    v_mfma_f32_16x16x32_bf16 v[64:67], a[136:139], v[216:219], v[64:67]
    ds_write_b64 v123, v[98:99] offset:4448
    v_cvt_pk_bf16_f32 v78, v68, v69
    v_add_f32 v84, v84, v69
    v_mfma_f32_16x16x32_bf16 v[64:67], a[140:143], v[220:223], v[64:67]
    s_waitcnt lgkmcnt(7)
    ds_read_b64_tr_b16 a[170:171], v121 offset:9024
    buffer_store_dwordx4 v[100:103], v122, s[24:27], s39 offen offset:1024 sc1 nt
    v_exp_f32 v70, v70
    v_mfma_f32_16x16x32_bf16 a[208:211], a[176:179], v[72:75], a[208:211]
    ds_read_b64_tr_b16 a[172:173], v121 offset:8544
    ds_read_b128 v[100:103], v124 offset:2176
    v_add_f32 v84, v84, v70
    v_accvgpr_read_b32 v88, a48
    v_accvgpr_read_b32 v89, a49
    v_mfma_f32_16x16x32_bf16 a[212:215], a[180:183], v[72:75], a[212:215]
    ds_read_b64_tr_b16 a[174:175], v121 offset:9056
    v_exp_f32 v71, v71
    v_accvgpr_read_b32 v90, a50
    v_accvgpr_read_b32 v91, a51
    v_accvgpr_read_b32 v92, a52
    v_mfma_f32_16x16x32_bf16 a[216:219], a[184:187], v[72:75], a[216:219]
    v_cvt_pk_bf16_f32 v79, v70, v71
    v_add_f32 v84, v84, v71
    v_accvgpr_read_b32 v93, a53
    v_accvgpr_read_b32 v94, a54
    v_accvgpr_read_b32 v95, a55
    v_mfma_f32_16x16x32_bf16 a[220:223], a[188:191], v[72:75], a[220:223]
    ds_read_b64_tr_b16 a[176:177], v121 offset:8576
    v_exp_f32 v64, v64
    v_mul_f32 v88, v88, v81
    v_mul_f32 v89, v89, v81
    v_mul_f32 v90, v90, v81
    v_mfma_f32_16x16x32_bf16 v[68:71], a[144:147], v[208:211], v[108:111]
    ds_read_b64_tr_b16 a[178:179], v121 offset:9088
    v_add_f32 v85, v85, v64
    v_mul_f32 v91, v91, v81
    v_mul_f32 v92, v92, v81
    v_mul_f32 v93, v93, v81
    v_mfma_f32_16x16x32_bf16 v[68:71], a[148:151], v[212:215], v[68:71]
    ds_read_b64_tr_b16 a[180:181], v121 offset:8608
    v_exp_f32 v65, v65
    v_mul_f32 v94, v94, v81
    v_mul_f32 v95, v95, v81
    v_cvt_pk_bf16_f32 v96, v88, v89
    v_mfma_f32_16x16x32_bf16 v[68:71], a[152:155], v[216:219], v[68:71]
    v_cvt_pk_bf16_f32 v72, v64, v65
    v_add_f32 v85, v85, v65
    v_cvt_pk_bf16_f32 v97, v90, v91
    v_cvt_pk_bf16_f32 v98, v92, v93
    v_cvt_pk_bf16_f32 v99, v94, v95
    v_mfma_f32_16x16x32_bf16 v[68:71], a[156:159], v[220:223], v[68:71]
    s_waitcnt lgkmcnt(12)
    ds_read_b64_tr_b16 a[182:183], v121 offset:9120
    ds_write_b64 v123, v[96:97] offset:4480
    v_exp_f32 v66, v66
    v_mfma_f32_16x16x32_bf16 v[0:3], a[160:163], v[76:79], v[0:3]
    s_waitcnt lgkmcnt(12)
    ds_read_b64_tr_b16 a[184:185], v121 offset:8640
    ds_write_b64 v123, v[98:99] offset:4512
    v_add_f32 v85, v85, v66
    v_mfma_f32_16x16x32_bf16 v[4:7], a[164:167], v[76:79], v[4:7]
    s_waitcnt lgkmcnt(15)
    s_waitcnt lgkmcnt(8)
    ds_read_b64_tr_b16 a[186:187], v121 offset:9152
    buffer_store_dwordx4 v[100:103], v122, s[24:27], s39 offen offset:2048 sc1 nt
    v_exp_f32 v67, v67
    v_mfma_f32_16x16x32_bf16 v[8:11], a[168:171], v[76:79], v[8:11]
    s_waitcnt lgkmcnt(8)
    ds_read_b128 v[100:103], v124 offset:3264
    v_cvt_pk_bf16_f32 v73, v66, v67
    v_add_f32 v85, v85, v67
    v_accvgpr_read_b32 v88, a56
    v_accvgpr_read_b32 v89, a57
    v_mfma_f32_16x16x32_bf16 v[12:15], a[172:175], v[76:79], v[12:15]
    ds_read_b64_tr_b16 a[188:189], v121 offset:8672
    v_exp_f32 v68, v68
    v_accvgpr_read_b32 v90, a58
    v_accvgpr_read_b32 v91, a59
    v_accvgpr_read_b32 v92, a60
    v_mfma_f32_16x16x32_bf16 v[64:67], a[128:131], v[224:227], v[112:115]
    ds_read_b64_tr_b16 a[190:191], v121 offset:9184
    ds_read_b128 a[128:131], v120 offset:16896
    v_add_f32 v85, v85, v68
    v_accvgpr_read_b32 v93, a61
    v_accvgpr_read_b32 v94, a62
    v_accvgpr_read_b32 v95, a63
    v_mfma_f32_16x16x32_bf16 v[64:67], a[132:135], v[228:231], v[64:67]
    v_exp_f32 v69, v69
    v_mul_f32 v88, v88, v81
    v_mul_f32 v89, v89, v81
    v_mul_f32 v90, v90, v81
    v_mfma_f32_16x16x32_bf16 v[64:67], a[136:139], v[232:235], v[64:67]
    v_cvt_pk_bf16_f32 v74, v68, v69
    v_add_f32 v85, v85, v69
    v_mul_f32 v91, v91, v81
    v_mul_f32 v92, v92, v81
    v_mul_f32 v93, v93, v81
    v_mfma_f32_16x16x32_bf16 v[64:67], a[140:143], v[236:239], v[64:67]
    s_waitcnt lgkmcnt(10)
    v_exp_f32 v70, v70
    v_mul_f32 v94, v94, v81
    v_mul_f32 v95, v95, v81
    v_cvt_pk_bf16_f32 v96, v88, v89
    v_mfma_f32_16x16x32_bf16 v[16:19], a[176:179], v[76:79], v[16:19]
    s_waitcnt lgkmcnt(8)
    ds_read_b128 a[132:135], v120 offset:16960
    v_add_f32 v85, v85, v70
    v_cvt_pk_bf16_f32 v97, v90, v91
    v_cvt_pk_bf16_f32 v98, v92, v93
    v_cvt_pk_bf16_f32 v99, v94, v95
    v_mfma_f32_16x16x32_bf16 v[20:23], a[180:183], v[76:79], v[20:23]
    s_waitcnt lgkmcnt(5)
    ds_read_b128 a[136:139], v120 offset:17024
    ds_write_b64 v123, v[96:97] offset:4544
    v_exp_f32 v71, v71
    v_mfma_f32_16x16x32_bf16 v[24:27], a[184:187], v[76:79], v[24:27]
    s_waitcnt lgkmcnt(4)
    ds_write_b64 v123, v[98:99] offset:4576
    v_cvt_pk_bf16_f32 v75, v70, v71
    v_add_f32 v85, v85, v71
    v_mfma_f32_16x16x32_bf16 v[28:31], a[188:191], v[76:79], v[28:31]
    s_waitcnt lgkmcnt(7)
    buffer_store_dwordx4 v[100:103], v122, s[24:27], s39 offen offset:3072 sc1 nt
    v_exp_f32 v64, v64
    v_mfma_f32_16x16x32_bf16 v[68:71], a[144:147], v[224:227], v[112:115]
    s_add_u32 s39, s39, 4096
    ds_read_b128 a[140:143], v120 offset:17088
    ds_read_b128 v[100:103], v124 offset:4352
    v_add_f32 v86, v86, v64
    v_accvgpr_read_b32 v88, a64
    v_accvgpr_read_b32 v89, a65
    v_mfma_f32_16x16x32_bf16 v[68:71], a[148:151], v[228:231], v[68:71]
    v_exp_f32 v65, v65
    v_accvgpr_read_b32 v90, a66
    v_accvgpr_read_b32 v91, a67
    v_accvgpr_read_b32 v92, a68
    v_mfma_f32_16x16x32_bf16 v[68:71], a[152:155], v[232:235], v[68:71]
    v_cvt_pk_bf16_f32 v76, v64, v65
    v_add_f32 v86, v86, v65
    v_accvgpr_read_b32 v93, a69
    v_accvgpr_read_b32 v94, a70
    v_accvgpr_read_b32 v95, a71
    v_mfma_f32_16x16x32_bf16 v[68:71], a[156:159], v[236:239], v[68:71]
    v_exp_f32 v66, v66
    v_mul_f32 v88, v88, v82
    v_mul_f32 v89, v89, v82
    v_mul_f32 v90, v90, v82
    v_mfma_f32_16x16x32_bf16 v[32:35], a[160:163], v[72:75], v[32:35]
    ds_read_b128 a[144:147], v120 offset:17408
    v_add_f32 v86, v86, v66
    v_mul_f32 v91, v91, v82
    v_mul_f32 v92, v92, v82
    v_mul_f32 v93, v93, v82
    v_mfma_f32_16x16x32_bf16 v[36:39], a[164:167], v[72:75], v[36:39]
    ds_read_b128 a[148:151], v120 offset:17472
    v_exp_f32 v67, v67
    v_mul_f32 v94, v94, v82
    v_mul_f32 v95, v95, v82
    v_cvt_pk_bf16_f32 v96, v88, v89
    v_mfma_f32_16x16x32_bf16 v[40:43], a[168:171], v[72:75], v[40:43]
    v_cvt_pk_bf16_f32 v77, v66, v67
    v_add_f32 v86, v86, v67
    v_cvt_pk_bf16_f32 v97, v90, v91
    v_cvt_pk_bf16_f32 v98, v92, v93
    v_cvt_pk_bf16_f32 v99, v94, v95
    v_mfma_f32_16x16x32_bf16 v[44:47], a[172:175], v[72:75], v[44:47]
    s_waitcnt lgkmcnt(8)
    ds_write_b64 v123, v[96:97] offset:0
    v_exp_f32 v68, v68
    v_mfma_f32_16x16x32_bf16 v[64:67], a[128:131], v[192:195], v[104:107]
    s_waitcnt lgkmcnt(8)
    ds_read_b128 a[152:155], v120 offset:17536
    ds_write_b64 v123, v[98:99] offset:32
    v_add_f32 v86, v86, v68
    v_mfma_f32_16x16x32_bf16 v[64:67], a[132:135], v[196:199], v[64:67]
    s_waitcnt lgkmcnt(15)
    s_waitcnt lgkmcnt(5)
    buffer_store_dwordx4 v[100:103], v122, s[24:27], s39 offen offset:0 sc1 nt
    v_exp_f32 v69, v69
    v_mfma_f32_16x16x32_bf16 v[64:67], a[136:139], v[200:203], v[64:67]
    s_waitcnt lgkmcnt(6)
    ds_read_b128 v[100:103], v124 offset:5440
    v_cvt_pk_bf16_f32 v78, v68, v69
    v_add_f32 v86, v86, v69
    v_accvgpr_read_b32 v88, a72
    v_accvgpr_read_b32 v89, a73
    v_mfma_f32_16x16x32_bf16 v[64:67], a[140:143], v[204:207], v[64:67]
    v_exp_f32 v70, v70
    v_accvgpr_read_b32 v90, a74
    v_accvgpr_read_b32 v91, a75
    v_accvgpr_read_b32 v92, a76
    v_mfma_f32_16x16x32_bf16 v[48:51], a[176:179], v[72:75], v[48:51]
    ds_read_b128 a[156:159], v120 offset:17600
    v_add_f32 v86, v86, v70
    v_accvgpr_read_b32 v93, a77
    v_accvgpr_read_b32 v94, a78
    v_accvgpr_read_b32 v95, a79
    v_mfma_f32_16x16x32_bf16 v[52:55], a[180:183], v[72:75], v[52:55]
    v_exp_f32 v71, v71
    v_mul_f32 v88, v88, v82
    v_mul_f32 v89, v89, v82
    v_mul_f32 v90, v90, v82
    v_mfma_f32_16x16x32_bf16 v[56:59], a[184:187], v[72:75], v[56:59]
    v_cvt_pk_bf16_f32 v79, v70, v71
    v_add_f32 v86, v86, v71
    v_mul_f32 v91, v91, v82
    v_mul_f32 v92, v92, v82
    v_mul_f32 v93, v93, v82
    v_mfma_f32_16x16x32_bf16 v[60:63], a[188:191], v[72:75], v[60:63]
    s_waitcnt lgkmcnt(6)
    v_exp_f32 v64, v64
    v_mul_f32 v94, v94, v82
    v_mul_f32 v95, v95, v82
    v_cvt_pk_bf16_f32 v96, v88, v89
    v_mfma_f32_16x16x32_bf16 v[68:71], a[144:147], v[192:195], v[104:107]
    s_waitcnt lgkmcnt(5)
    v_add_f32 v84, v84, v64
    v_cvt_pk_bf16_f32 v97, v90, v91
    v_cvt_pk_bf16_f32 v98, v92, v93
    v_cvt_pk_bf16_f32 v99, v94, v95
    v_mfma_f32_16x16x32_bf16 v[68:71], a[148:151], v[196:199], v[68:71]
    s_waitcnt lgkmcnt(3)
    ds_write_b64 v123, v[96:97] offset:64
    v_exp_f32 v65, v65
    v_mfma_f32_16x16x32_bf16 v[68:71], a[152:155], v[200:203], v[68:71]
    s_waitcnt lgkmcnt(1)
    ds_write_b64 v123, v[98:99] offset:96
    v_cvt_pk_bf16_f32 v72, v64, v65
    v_add_f32 v84, v84, v65
    v_mfma_f32_16x16x32_bf16 v[68:71], a[156:159], v[204:207], v[68:71]
    s_waitcnt lgkmcnt(3)
    buffer_store_dwordx4 v[100:103], v122, s[24:27], s39 offen offset:1024 sc1 nt
    v_exp_f32 v66, v66
    v_mfma_f32_16x16x32_bf16 a[192:195], a[160:163], v[76:79], a[192:195]
    ds_read_b64_tr_b16 a[160:161], v121 offset:16896
    ds_read_b128 v[100:103], v124 offset:6528
    v_add_f32 v84, v84, v66
    v_accvgpr_read_b32 v88, a80
    v_accvgpr_read_b32 v89, a81
    v_mfma_f32_16x16x32_bf16 a[196:199], a[164:167], v[76:79], a[196:199]
    ds_read_b64_tr_b16 a[162:163], v121 offset:17408
    v_exp_f32 v67, v67
    v_accvgpr_read_b32 v90, a82
    v_accvgpr_read_b32 v91, a83
    v_accvgpr_read_b32 v92, a84
    v_mfma_f32_16x16x32_bf16 a[200:203], a[168:171], v[76:79], a[200:203]
    v_cvt_pk_bf16_f32 v73, v66, v67
    v_add_f32 v84, v84, v67
    v_accvgpr_read_b32 v93, a85
    v_accvgpr_read_b32 v94, a86
    v_accvgpr_read_b32 v95, a87
    v_mfma_f32_16x16x32_bf16 a[204:207], a[172:175], v[76:79], a[204:207]
    ds_read_b64_tr_b16 a[164:165], v121 offset:16928
    v_exp_f32 v68, v68
    v_mul_f32 v88, v88, v82
    v_mul_f32 v89, v89, v82
    v_mul_f32 v90, v90, v82
    v_mfma_f32_16x16x32_bf16 v[64:67], a[128:131], v[208:211], v[108:111]
    ds_read_b64_tr_b16 a[166:167], v121 offset:17440
    v_add_f32 v84, v84, v68
    v_mul_f32 v91, v91, v82
    v_mul_f32 v92, v92, v82
    v_mul_f32 v93, v93, v82
    v_mfma_f32_16x16x32_bf16 v[64:67], a[132:135], v[212:215], v[64:67]
    ds_read_b64_tr_b16 a[168:169], v121 offset:16960
    v_exp_f32 v69, v69
    v_mul_f32 v94, v94, v82
    v_mul_f32 v95, v95, v82
    v_cvt_pk_bf16_f32 v96, v88, v89
    v_mfma_f32_16x16x32_bf16 v[64:67], a[136:139], v[216:219], v[64:67]
    v_cvt_pk_bf16_f32 v74, v68, v69
    v_add_f32 v84, v84, v69
    v_cvt_pk_bf16_f32 v97, v90, v91
    v_cvt_pk_bf16_f32 v98, v92, v93
    v_cvt_pk_bf16_f32 v99, v94, v95
    v_mfma_f32_16x16x32_bf16 v[64:67], a[140:143], v[220:223], v[64:67]
    ds_read_b64_tr_b16 a[170:171], v121 offset:17472
    ds_write_b64 v123, v[96:97] offset:128
    v_exp_f32 v70, v70
    v_mfma_f32_16x16x32_bf16 a[208:211], a[176:179], v[76:79], a[208:211]
    ds_read_b64_tr_b16 a[172:173], v121 offset:16992
    ds_write_b64 v123, v[98:99] offset:160
    v_add_f32 v84, v84, v70
    v_mfma_f32_16x16x32_bf16 a[212:215], a[180:183], v[76:79], a[212:215]
    s_waitcnt lgkmcnt(8)
    ds_read_b64_tr_b16 a[174:175], v121 offset:17504
    buffer_store_dwordx4 v[100:103], v122, s[24:27], s39 offen offset:2048 sc1 nt
    v_exp_f32 v71, v71
    v_mfma_f32_16x16x32_bf16 a[216:219], a[184:187], v[76:79], a[216:219]
    ds_read_b128 v[100:103], v124 offset:7616
    v_cvt_pk_bf16_f32 v75, v70, v71
    v_add_f32 v84, v84, v71
    v_accvgpr_read_b32 v88, a88
    v_accvgpr_read_b32 v89, a89
    v_mfma_f32_16x16x32_bf16 a[220:223], a[188:191], v[76:79], a[220:223]
    ds_read_b64_tr_b16 a[176:177], v121 offset:17024
    v_exp_f32 v64, v64
    v_accvgpr_read_b32 v90, a90
    v_accvgpr_read_b32 v91, a91
    v_accvgpr_read_b32 v92, a92
    v_mfma_f32_16x16x32_bf16 v[68:71], a[144:147], v[208:211], v[108:111]
    ds_read_b64_tr_b16 a[178:179], v121 offset:17536
    v_add_f32 v85, v85, v64
    v_accvgpr_read_b32 v93, a93
    v_accvgpr_read_b32 v94, a94
    v_accvgpr_read_b32 v95, a95
    v_mfma_f32_16x16x32_bf16 v[68:71], a[148:151], v[212:215], v[68:71]
    ds_read_b64_tr_b16 a[180:181], v121 offset:17056
    v_exp_f32 v65, v65
    v_mul_f32 v88, v88, v82
    v_mul_f32 v89, v89, v82
    v_mul_f32 v90, v90, v82
    v_mfma_f32_16x16x32_bf16 v[68:71], a[152:155], v[216:219], v[68:71]
    v_cvt_pk_bf16_f32 v76, v64, v65
    v_add_f32 v85, v85, v65
    v_mul_f32 v91, v91, v82
    v_mul_f32 v92, v92, v82
    v_mul_f32 v93, v93, v82
    v_mfma_f32_16x16x32_bf16 v[68:71], a[156:159], v[220:223], v[68:71]
    s_waitcnt lgkmcnt(12)
    ds_read_b64_tr_b16 a[182:183], v121 offset:17568
    v_exp_f32 v66, v66
    v_mul_f32 v94, v94, v82
    v_mul_f32 v95, v95, v82
    v_cvt_pk_bf16_f32 v96, v88, v89
    v_mfma_f32_16x16x32_bf16 v[0:3], a[160:163], v[72:75], v[0:3]
    s_waitcnt lgkmcnt(11)
    ds_read_b64_tr_b16 a[184:185], v121 offset:17088
    v_add_f32 v85, v85, v66
    v_cvt_pk_bf16_f32 v97, v90, v91
    v_cvt_pk_bf16_f32 v98, v92, v93
    v_cvt_pk_bf16_f32 v99, v94, v95
    v_mfma_f32_16x16x32_bf16 v[4:7], a[164:167], v[72:75], v[4:7]
    s_waitcnt lgkmcnt(10)
    ds_read_b64_tr_b16 a[186:187], v121 offset:17600
    ds_write_b64 v123, v[96:97] offset:192
    v_exp_f32 v67, v67
    v_mfma_f32_16x16x32_bf16 v[8:11], a[168:171], v[72:75], v[8:11]
    s_waitcnt lgkmcnt(8)
    ds_write_b64 v123, v[98:99] offset:224
    v_cvt_pk_bf16_f32 v77, v66, v67
    v_add_f32 v85, v85, v67
    v_mfma_f32_16x16x32_bf16 v[12:15], a[172:175], v[72:75], v[12:15]
    s_waitcnt lgkmcnt(8)
    ds_read_b64_tr_b16 a[188:189], v121 offset:17120
    buffer_store_dwordx4 v[100:103], v122, s[24:27], s39 offen offset:3072 sc1 nt
    v_exp_f32 v68, v68
    v_mfma_f32_16x16x32_bf16 v[64:67], a[128:131], v[224:227], v[112:115]
    s_add_u32 s39, s39, 4096
    ds_read_b64_tr_b16 a[190:191], v121 offset:17632
    ds_read_b128 a[128:131], v120 offset:25344
    ds_read_b128 v[100:103], v124 offset:0
    v_add_f32 v85, v85, v68
    v_accvgpr_read_b32 v88, a96
    v_accvgpr_read_b32 v89, a97
    v_mfma_f32_16x16x32_bf16 v[64:67], a[132:135], v[228:231], v[64:67]
    v_exp_f32 v69, v69
    v_accvgpr_read_b32 v90, a98
    v_accvgpr_read_b32 v91, a99
    v_accvgpr_read_b32 v92, a100
    v_mfma_f32_16x16x32_bf16 v[64:67], a[136:139], v[232:235], v[64:67]
    v_cvt_pk_bf16_f32 v78, v68, v69
    v_add_f32 v85, v85, v69
    v_accvgpr_read_b32 v93, a101
    v_accvgpr_read_b32 v94, a102
    v_accvgpr_read_b32 v95, a103
    v_mfma_f32_16x16x32_bf16 v[64:67], a[140:143], v[236:239], v[64:67]
    s_waitcnt lgkmcnt(10)
    v_exp_f32 v70, v70
    v_mul_f32 v88, v88, v83
    v_mul_f32 v89, v89, v83
    v_mul_f32 v90, v90, v83
    v_mfma_f32_16x16x32_bf16 v[16:19], a[176:179], v[72:75], v[16:19]
    s_waitcnt lgkmcnt(8)
    ds_read_b128 a[132:135], v120 offset:25408
    v_add_f32 v85, v85, v70
    v_mul_f32 v91, v91, v83
    v_mul_f32 v92, v92, v83
    v_mul_f32 v93, v93, v83
    v_mfma_f32_16x16x32_bf16 v[20:23], a[180:183], v[72:75], v[20:23]
    s_waitcnt lgkmcnt(7)
    ds_read_b128 a[136:139], v120 offset:25472
    v_exp_f32 v71, v71
    v_mul_f32 v94, v94, v83
    v_mul_f32 v95, v95, v83
    v_cvt_pk_bf16_f32 v96, v88, v89
    v_mfma_f32_16x16x32_bf16 v[24:27], a[184:187], v[72:75], v[24:27]
    s_waitcnt lgkmcnt(4)
    v_cvt_pk_bf16_f32 v79, v70, v71
    v_add_f32 v85, v85, v71
    v_cvt_pk_bf16_f32 v97, v90, v91
    v_cvt_pk_bf16_f32 v98, v92, v93
    v_cvt_pk_bf16_f32 v99, v94, v95
    v_mfma_f32_16x16x32_bf16 v[28:31], a[188:191], v[72:75], v[28:31]
    ds_write_b64 v123, v[96:97] offset:4352
    v_exp_f32 v64, v64
    v_mfma_f32_16x16x32_bf16 v[68:71], a[144:147], v[224:227], v[112:115]
    ds_read_b128 a[140:143], v120 offset:25536
    ds_write_b64 v123, v[98:99] offset:4384
    v_add_f32 v86, v86, v64
    v_mfma_f32_16x16x32_bf16 v[68:71], a[148:151], v[228:231], v[68:71]
    s_waitcnt lgkmcnt(5)
    buffer_store_dwordx4 v[100:103], v122, s[24:27], s39 offen offset:0 sc1 nt
    v_exp_f32 v65, v65
    v_mfma_f32_16x16x32_bf16 v[68:71], a[152:155], v[232:235], v[68:71]
    ds_read_b128 v[100:103], v124 offset:1088
    v_cvt_pk_bf16_f32 v72, v64, v65
    v_add_f32 v86, v86, v65
    v_accvgpr_read_b32 v88, a104
    v_accvgpr_read_b32 v89, a105
    v_mfma_f32_16x16x32_bf16 v[68:71], a[156:159], v[236:239], v[68:71]
    v_exp_f32 v66, v66
    v_accvgpr_read_b32 v90, a106
    v_accvgpr_read_b32 v91, a107
    v_accvgpr_read_b32 v92, a108
    v_mfma_f32_16x16x32_bf16 v[32:35], a[160:163], v[76:79], v[32:35]
    ds_read_b128 a[144:147], v120 offset:25856
    v_add_f32 v86, v86, v66
    v_accvgpr_read_b32 v93, a109
    v_accvgpr_read_b32 v94, a110
    v_accvgpr_read_b32 v95, a111
    v_mfma_f32_16x16x32_bf16 v[36:39], a[164:167], v[76:79], v[36:39]
    ds_read_b128 a[148:151], v120 offset:25920
    v_exp_f32 v67, v67
    v_mul_f32 v88, v88, v83
    v_mul_f32 v89, v89, v83
    v_mul_f32 v90, v90, v83
    v_mfma_f32_16x16x32_bf16 v[40:43], a[168:171], v[76:79], v[40:43]
    v_cvt_pk_bf16_f32 v73, v66, v67
    v_add_f32 v86, v86, v67
    v_mul_f32 v91, v91, v83
    v_mul_f32 v92, v92, v83
    v_mul_f32 v93, v93, v83
    v_mfma_f32_16x16x32_bf16 v[44:47], a[172:175], v[76:79], v[44:47]
    s_waitcnt lgkmcnt(9)
    v_exp_f32 v68, v68
    v_mul_f32 v94, v94, v83
    v_mul_f32 v95, v95, v83
    v_cvt_pk_bf16_f32 v96, v88, v89
    v_mfma_f32_16x16x32_bf16 v[64:67], a[128:131], v[192:195], v[104:107]
    s_waitcnt lgkmcnt(7)
    ds_read_b128 a[152:155], v120 offset:25984
    v_add_f32 v86, v86, v68
    v_cvt_pk_bf16_f32 v97, v90, v91
    v_cvt_pk_bf16_f32 v98, v92, v93
    v_cvt_pk_bf16_f32 v99, v94, v95
    v_mfma_f32_16x16x32_bf16 v[64:67], a[132:135], v[196:199], v[64:67]
    s_waitcnt lgkmcnt(7)
    ds_write_b64 v123, v[96:97] offset:4416
    v_exp_f32 v69, v69
    v_mfma_f32_16x16x32_bf16 v[64:67], a[136:139], v[200:203], v[64:67]
    s_waitcnt lgkmcnt(6)
    ds_write_b64 v123, v[98:99] offset:4448
    v_cvt_pk_bf16_f32 v74, v68, v69
    v_add_f32 v86, v86, v69
    v_mfma_f32_16x16x32_bf16 v[64:67], a[140:143], v[204:207], v[64:67]
    s_waitcnt lgkmcnt(5)
    buffer_store_dwordx4 v[100:103], v122, s[24:27], s39 offen offset:1024 sc1 nt
    v_exp_f32 v70, v70
    v_mfma_f32_16x16x32_bf16 v[48:51], a[176:179], v[76:79], v[48:51]
    ds_read_b128 a[156:159], v120 offset:26048
    ds_read_b128 v[100:103], v124 offset:2176
    v_add_f32 v86, v86, v70
    v_accvgpr_read_b32 v88, a112
    v_accvgpr_read_b32 v89, a113
    v_mfma_f32_16x16x32_bf16 v[52:55], a[180:183], v[76:79], v[52:55]
    v_exp_f32 v71, v71
    v_accvgpr_read_b32 v90, a114
    v_accvgpr_read_b32 v91, a115
    v_accvgpr_read_b32 v92, a116
    v_mfma_f32_16x16x32_bf16 v[56:59], a[184:187], v[76:79], v[56:59]
    v_cvt_pk_bf16_f32 v75, v70, v71
    v_add_f32 v86, v86, v71
    v_accvgpr_read_b32 v93, a117
    v_accvgpr_read_b32 v94, a118
    v_accvgpr_read_b32 v95, a119
    v_mfma_f32_16x16x32_bf16 v[60:63], a[188:191], v[76:79], v[60:63]
    s_waitcnt lgkmcnt(6)
    v_exp_f32 v64, v64
    v_mul_f32 v88, v88, v83
    v_mul_f32 v89, v89, v83
    v_mul_f32 v90, v90, v83
    v_mfma_f32_16x16x32_bf16 v[68:71], a[144:147], v[192:195], v[104:107]
    s_waitcnt lgkmcnt(5)
    v_add_f32 v84, v84, v64
    v_mul_f32 v91, v91, v83
    v_mul_f32 v92, v92, v83
    v_mul_f32 v93, v93, v83
    v_mfma_f32_16x16x32_bf16 v[68:71], a[148:151], v[196:199], v[68:71]
    s_waitcnt lgkmcnt(4)
    v_exp_f32 v65, v65
    v_mul_f32 v94, v94, v83
    v_mul_f32 v95, v95, v83
    v_cvt_pk_bf16_f32 v96, v88, v89
    v_mfma_f32_16x16x32_bf16 v[68:71], a[152:155], v[200:203], v[68:71]
    s_waitcnt lgkmcnt(1)
    v_cvt_pk_bf16_f32 v76, v64, v65
    v_add_f32 v84, v84, v65
    v_cvt_pk_bf16_f32 v97, v90, v91
    v_cvt_pk_bf16_f32 v98, v92, v93
    v_cvt_pk_bf16_f32 v99, v94, v95
    v_mfma_f32_16x16x32_bf16 v[68:71], a[156:159], v[204:207], v[68:71]
    ds_write_b64 v123, v[96:97] offset:4480
    v_exp_f32 v66, v66
    v_mfma_f32_16x16x32_bf16 a[192:195], a[160:163], v[72:75], a[192:195]
    ds_read_b64_tr_b16 a[160:161], v121 offset:25344
    ds_write_b64 v123, v[98:99] offset:4512
    v_add_f32 v84, v84, v66
    v_mfma_f32_16x16x32_bf16 a[196:199], a[164:167], v[72:75], a[196:199]
    s_waitcnt lgkmcnt(3)
    ds_read_b64_tr_b16 a[162:163], v121 offset:25856
    buffer_store_dwordx4 v[100:103], v122, s[24:27], s39 offen offset:2048 sc1 nt
    v_exp_f32 v67, v67
    v_mfma_f32_16x16x32_bf16 a[200:203], a[168:171], v[72:75], a[200:203]
    ds_read_b128 v[100:103], v124 offset:3264
    v_cvt_pk_bf16_f32 v77, v66, v67
    v_add_f32 v84, v84, v67
    v_accvgpr_read_b32 v88, a120
    v_accvgpr_read_b32 v89, a121
    v_mfma_f32_16x16x32_bf16 a[204:207], a[172:175], v[72:75], a[204:207]
    ds_read_b64_tr_b16 a[164:165], v121 offset:25376
    v_exp_f32 v68, v68
    v_accvgpr_read_b32 v90, a122
    v_accvgpr_read_b32 v91, a123
    v_accvgpr_read_b32 v92, a124
    v_mfma_f32_16x16x32_bf16 v[64:67], a[128:131], v[208:211], v[108:111]
    ds_read_b64_tr_b16 a[166:167], v121 offset:25888
    v_add_f32 v84, v84, v68
    v_accvgpr_read_b32 v93, a125
    v_accvgpr_read_b32 v94, a126
    v_accvgpr_read_b32 v95, a127
    v_mfma_f32_16x16x32_bf16 v[64:67], a[132:135], v[212:215], v[64:67]
    ds_read_b64_tr_b16 a[168:169], v121 offset:25408
    v_exp_f32 v69, v69
    v_mul_f32 v88, v88, v83
    v_mul_f32 v89, v89, v83
    v_mul_f32 v90, v90, v83
    v_mfma_f32_16x16x32_bf16 v[64:67], a[136:139], v[216:219], v[64:67]
    v_cvt_pk_bf16_f32 v78, v68, v69
    v_add_f32 v84, v84, v69
    v_mul_f32 v91, v91, v83
    v_mul_f32 v92, v92, v83
    v_mul_f32 v93, v93, v83
    v_mfma_f32_16x16x32_bf16 v[64:67], a[140:143], v[220:223], v[64:67]
    ds_read_b64_tr_b16 a[170:171], v121 offset:25920
    v_exp_f32 v70, v70
    v_mul_f32 v94, v94, v83
    v_mul_f32 v95, v95, v83
    v_cvt_pk_bf16_f32 v96, v88, v89
    v_mfma_f32_16x16x32_bf16 a[208:211], a[176:179], v[72:75], a[208:211]
    ds_read_b64_tr_b16 a[172:173], v121 offset:25440
    v_add_f32 v84, v84, v70
    v_cvt_pk_bf16_f32 v97, v90, v91
    v_cvt_pk_bf16_f32 v98, v92, v93
    v_cvt_pk_bf16_f32 v99, v94, v95
    v_mfma_f32_16x16x32_bf16 a[212:215], a[180:183], v[72:75], a[212:215]
    ds_read_b64_tr_b16 a[174:175], v121 offset:25952
    ds_write_b64 v123, v[96:97] offset:4544
    v_exp_f32 v71, v71
    v_mfma_f32_16x16x32_bf16 a[216:219], a[184:187], v[72:75], a[216:219]
    ds_write_b64 v123, v[98:99] offset:4576
    v_cvt_pk_bf16_f32 v79, v70, v71
    v_add_f32 v84, v84, v71
    v_mfma_f32_16x16x32_bf16 a[220:223], a[188:191], v[72:75], a[220:223]
    s_waitcnt lgkmcnt(8)
    ds_read_b64_tr_b16 a[176:177], v121 offset:25472
    buffer_store_dwordx4 v[100:103], v122, s[24:27], s39 offen offset:3072 sc1 nt
    v_exp_f32 v64, v64
    v_mfma_f32_16x16x32_bf16 v[68:71], a[144:147], v[208:211], v[108:111]
    s_add_u32 s39, s39, 4096
    ds_read_b64_tr_b16 a[178:179], v121 offset:25984
    ds_read_b128 v[100:103], v124 offset:4352
    v_add_f32 v85, v85, v64
    v_mfma_f32_16x16x32_bf16 v[68:71], a[148:151], v[212:215], v[68:71]
    ds_read_b64_tr_b16 a[180:181], v121 offset:25504
    v_exp_f32 v65, v65
    v_mfma_f32_16x16x32_bf16 v[68:71], a[152:155], v[216:219], v[68:71]
    v_cvt_pk_bf16_f32 v72, v64, v65
    v_add_f32 v85, v85, v65
    v_mfma_f32_16x16x32_bf16 v[68:71], a[156:159], v[220:223], v[68:71]
    s_waitcnt lgkmcnt(13)
    ds_read_b64_tr_b16 a[182:183], v121 offset:26016
    v_exp_f32 v66, v66
    v_mfma_f32_16x16x32_bf16 v[0:3], a[160:163], v[76:79], v[0:3]
    s_waitcnt lgkmcnt(11)
    ds_read_b64_tr_b16 a[184:185], v121 offset:25536
    v_add_f32 v85, v85, v66
    v_mfma_f32_16x16x32_bf16 v[4:7], a[164:167], v[76:79], v[4:7]
    s_waitcnt lgkmcnt(15)
    s_waitcnt lgkmcnt(3)
    ds_read_b64_tr_b16 a[186:187], v121 offset:26048
    buffer_store_dwordx4 v[100:103], v122, s[24:27], s39 offen offset:0 sc1 nt
    v_exp_f32 v67, v67
    v_mfma_f32_16x16x32_bf16 v[8:11], a[168:171], v[76:79], v[8:11]
    s_waitcnt lgkmcnt(9)
    v_cvt_pk_bf16_f32 v73, v66, v67
    v_add_f32 v85, v85, v67
    v_mfma_f32_16x16x32_bf16 v[12:15], a[172:175], v[76:79], v[12:15]
    ds_read_b64_tr_b16 a[188:189], v121 offset:25568
    v_exp_f32 v68, v68
    v_mfma_f32_16x16x32_bf16 v[64:67], a[128:131], v[224:227], v[112:115]
    ds_read_b64_tr_b16 a[190:191], v121 offset:26080
    v_add_f32 v85, v85, v68
    v_mfma_f32_16x16x32_bf16 v[64:67], a[132:135], v[228:231], v[64:67]
    v_exp_f32 v69, v69
    v_mfma_f32_16x16x32_bf16 v[64:67], a[136:139], v[232:235], v[64:67]
    v_cvt_pk_bf16_f32 v74, v68, v69
    v_add_f32 v85, v85, v69
    v_mfma_f32_16x16x32_bf16 v[64:67], a[140:143], v[236:239], v[64:67]
    s_waitcnt lgkmcnt(7)
    v_exp_f32 v70, v70
    v_mfma_f32_16x16x32_bf16 v[16:19], a[176:179], v[76:79], v[16:19]
    s_waitcnt lgkmcnt(4)
    v_add_f32 v85, v85, v70
    v_mfma_f32_16x16x32_bf16 v[20:23], a[180:183], v[76:79], v[20:23]
    s_waitcnt lgkmcnt(2)
    v_exp_f32 v71, v71
    v_mfma_f32_16x16x32_bf16 v[24:27], a[184:187], v[76:79], v[24:27]
    s_waitcnt lgkmcnt(0)
    ds_read_b128 v[100:103], v124 offset:5440
    v_cvt_pk_bf16_f32 v75, v70, v71
    v_add_f32 v85, v85, v71
    v_mfma_f32_16x16x32_bf16 v[28:31], a[188:191], v[76:79], v[28:31]
    v_exp_f32 v64, v64
    v_mfma_f32_16x16x32_bf16 v[68:71], a[144:147], v[224:227], v[112:115]
    v_add_f32 v86, v86, v64
    v_mfma_f32_16x16x32_bf16 v[68:71], a[148:151], v[228:231], v[68:71]
    v_exp_f32 v65, v65
    v_mfma_f32_16x16x32_bf16 v[68:71], a[152:155], v[232:235], v[68:71]
    v_cvt_pk_bf16_f32 v76, v64, v65
    v_add_f32 v86, v86, v65
    v_mfma_f32_16x16x32_bf16 v[68:71], a[156:159], v[236:239], v[68:71]
    s_waitcnt lgkmcnt(0)
    buffer_store_dwordx4 v[100:103], v122, s[24:27], s39 offen offset:1024 sc1 nt
    v_exp_f32 v66, v66
    v_mfma_f32_16x16x32_bf16 v[32:35], a[160:163], v[72:75], v[32:35]
    v_add_f32 v86, v86, v66
    v_mfma_f32_16x16x32_bf16 v[36:39], a[164:167], v[72:75], v[36:39]
    v_exp_f32 v67, v67
    v_mfma_f32_16x16x32_bf16 v[40:43], a[168:171], v[72:75], v[40:43]
    v_cvt_pk_bf16_f32 v77, v66, v67
    v_add_f32 v86, v86, v67
    v_mfma_f32_16x16x32_bf16 v[44:47], a[172:175], v[72:75], v[44:47]
    v_exp_f32 v68, v68
    s_nop 0
    v_add_f32 v86, v86, v68
    v_exp_f32 v69, v69
    s_nop 0
    v_cvt_pk_bf16_f32 v78, v68, v69
    v_add_f32 v86, v86, v69
    v_exp_f32 v70, v70
    v_mfma_f32_16x16x32_bf16 v[48:51], a[176:179], v[72:75], v[48:51]
    ds_read_b128 v[100:103], v124 offset:6528
    v_add_f32 v86, v86, v70
    v_mfma_f32_16x16x32_bf16 v[52:55], a[180:183], v[72:75], v[52:55]
    v_exp_f32 v71, v71
    v_mfma_f32_16x16x32_bf16 v[56:59], a[184:187], v[72:75], v[56:59]
    v_cvt_pk_bf16_f32 v79, v70, v71
    v_add_f32 v86, v86, v71
    v_mfma_f32_16x16x32_bf16 v[60:63], a[188:191], v[72:75], v[60:63]
    s_waitcnt lgkmcnt(0)
    buffer_store_dwordx4 v[100:103], v122, s[24:27], s39 offen offset:2048 sc1 nt
    v_mfma_f32_16x16x32_bf16 a[192:195], a[160:163], v[76:79], a[192:195]
    v_mfma_f32_16x16x32_bf16 a[196:199], a[164:167], v[76:79], a[196:199]
    v_mfma_f32_16x16x32_bf16 a[200:203], a[168:171], v[76:79], a[200:203]
    v_mfma_f32_16x16x32_bf16 a[204:207], a[172:175], v[76:79], a[204:207]
    ds_read_b128 v[100:103], v124 offset:7616
    v_mfma_f32_16x16x32_bf16 a[208:211], a[176:179], v[76:79], a[208:211]
    v_mfma_f32_16x16x32_bf16 a[212:215], a[180:183], v[76:79], a[212:215]
    v_mfma_f32_16x16x32_bf16 a[216:219], a[184:187], v[76:79], a[216:219]
    v_mfma_f32_16x16x32_bf16 a[220:223], a[188:191], v[76:79], a[220:223]
    s_waitcnt lgkmcnt(0)
    buffer_store_dwordx4 v[100:103], v122, s[24:27], s39 offen offset:3072 sc1 nt
    s_add_u32 s39, s39, 4096
    v_permlane32_swap_b32 v84, v85
    v_add_f32 v84, v84, v85
    v_mov_b32 v85, v84
    s_nop 1
    v_permlane16_swap_b32 v84, v85
    v_add_f32 v84, v84, v85
    v_cmp_nge_f32 vcc, 0x53800000, v84
    v_rcp_f32 v84, v84
    s_or_b64 s[48:49], s[48:49], vcc
    v_mov_b32 v85, v84
    s_nop 1
    v_permlane32_swap_b32 v84, v85
    v_mov_b32 v64, v86
    s_nop 1
    v_permlane32_swap_b32 v86, v64
    v_add_f32 v86, v86, v64
    v_mov_b32 v64, v86
    s_nop 1
    v_permlane16_swap_b32 v86, v64
    v_add_f32 v86, v86, v64
    v_cmp_nge_f32 vcc, 0x53800000, v86
    v_rcp_f32 v86, v86
    s_or_b64 s[48:49], s[48:49], vcc
    v_pk_mul_f32 v[0:1], v[0:1], v[84:85] op_sel:[0,0] op_sel_hi:[1,0]
    v_pk_mul_f32 v[2:3], v[2:3], v[84:85] op_sel:[0,0] op_sel_hi:[1,0]
    v_pk_mul_f32 v[4:5], v[4:5], v[84:85] op_sel:[0,0] op_sel_hi:[1,0]
    v_pk_mul_f32 v[6:7], v[6:7], v[84:85] op_sel:[0,0] op_sel_hi:[1,0]
    v_cvt_pk_bf16_f32 v96, v0, v1
    v_cvt_pk_bf16_f32 v97, v2, v3
    v_cvt_pk_bf16_f32 v98, v4, v5
    v_cvt_pk_bf16_f32 v99, v6, v7
    v_pk_mul_f32 v[8:9], v[8:9], v[84:85] op_sel:[0,0] op_sel_hi:[1,0]
    v_pk_mul_f32 v[10:11], v[10:11], v[84:85] op_sel:[0,0] op_sel_hi:[1,0]
    v_pk_mul_f32 v[12:13], v[12:13], v[84:85] op_sel:[0,0] op_sel_hi:[1,0]
    v_pk_mul_f32 v[14:15], v[14:15], v[84:85] op_sel:[0,0] op_sel_hi:[1,0]
    ds_write_b64 v123, v[96:97] offset:0
    ds_write_b64 v123, v[98:99] offset:32
    v_cvt_pk_bf16_f32 v112, v8, v9
    v_cvt_pk_bf16_f32 v113, v10, v11
    v_cvt_pk_bf16_f32 v114, v12, v13
    v_cvt_pk_bf16_f32 v115, v14, v15
    v_pk_mul_f32 v[16:17], v[16:17], v[84:85] op_sel:[0,0] op_sel_hi:[1,0]
    v_pk_mul_f32 v[18:19], v[18:19], v[84:85] op_sel:[0,0] op_sel_hi:[1,0]
    v_pk_mul_f32 v[20:21], v[20:21], v[84:85] op_sel:[0,0] op_sel_hi:[1,0]
    v_pk_mul_f32 v[22:23], v[22:23], v[84:85] op_sel:[0,0] op_sel_hi:[1,0]
    ds_write_b64 v123, v[112:113] offset:64
    ds_write_b64 v123, v[114:115] offset:96
    v_cvt_pk_bf16_f32 v96, v16, v17
    v_cvt_pk_bf16_f32 v97, v18, v19
    v_cvt_pk_bf16_f32 v98, v20, v21
    v_cvt_pk_bf16_f32 v99, v22, v23
    v_pk_mul_f32 v[24:25], v[24:25], v[84:85] op_sel:[0,0] op_sel_hi:[1,0]
    v_pk_mul_f32 v[26:27], v[26:27], v[84:85] op_sel:[0,0] op_sel_hi:[1,0]
    v_pk_mul_f32 v[28:29], v[28:29], v[84:85] op_sel:[0,0] op_sel_hi:[1,0]
    v_pk_mul_f32 v[30:31], v[30:31], v[84:85] op_sel:[0,0] op_sel_hi:[1,0]
    ds_write_b64 v123, v[96:97] offset:128
    ds_write_b64 v123, v[98:99] offset:160
    v_cvt_pk_bf16_f32 v112, v24, v25
    v_cvt_pk_bf16_f32 v113, v26, v27
    v_cvt_pk_bf16_f32 v114, v28, v29
    v_cvt_pk_bf16_f32 v115, v30, v31
    ds_write_b64 v123, v[112:113] offset:192
    ds_write_b64 v123, v[114:115] offset:224
    ds_read_b128 v[64:67], v124 offset:0
    ds_read_b128 v[68:71], v124 offset:1088
    ds_read_b128 v[72:75], v124 offset:2176
    ds_read_b128 v[76:79], v124 offset:3264
    v_pk_mul_f32 v[32:33], v[32:33], v[84:85] op_sel:[0,1] op_sel_hi:[1,1]
    v_pk_mul_f32 v[34:35], v[34:35], v[84:85] op_sel:[0,1] op_sel_hi:[1,1]
    v_pk_mul_f32 v[36:37], v[36:37], v[84:85] op_sel:[0,1] op_sel_hi:[1,1]
    v_pk_mul_f32 v[38:39], v[38:39], v[84:85] op_sel:[0,1] op_sel_hi:[1,1]
    v_cvt_pk_bf16_f32 v96, v32, v33
    v_cvt_pk_bf16_f32 v97, v34, v35
    v_cvt_pk_bf16_f32 v98, v36, v37
    v_cvt_pk_bf16_f32 v99, v38, v39
    v_pk_mul_f32 v[40:41], v[40:41], v[84:85] op_sel:[0,1] op_sel_hi:[1,1]
    v_pk_mul_f32 v[42:43], v[42:43], v[84:85] op_sel:[0,1] op_sel_hi:[1,1]
    v_pk_mul_f32 v[44:45], v[44:45], v[84:85] op_sel:[0,1] op_sel_hi:[1,1]
    v_pk_mul_f32 v[46:47], v[46:47], v[84:85] op_sel:[0,1] op_sel_hi:[1,1]
    s_waitcnt lgkmcnt(0)
    buffer_store_dwordx4 v[64:67], v122, s[24:27], s39 offen offset:0 sc1 nt
    buffer_store_dwordx4 v[68:71], v122, s[24:27], s39 offen offset:1024 sc1 nt
    buffer_store_dwordx4 v[72:75], v122, s[24:27], s39 offen offset:2048 sc1 nt
    buffer_store_dwordx4 v[76:79], v122, s[24:27], s39 offen offset:3072 sc1 nt
    s_add_u32 s39, s39, 4096
    ds_write_b64 v123, v[96:97] offset:4352
    ds_write_b64 v123, v[98:99] offset:4384
    v_cvt_pk_bf16_f32 v112, v40, v41
    v_cvt_pk_bf16_f32 v113, v42, v43
    v_cvt_pk_bf16_f32 v114, v44, v45
    v_cvt_pk_bf16_f32 v115, v46, v47
    v_pk_mul_f32 v[48:49], v[48:49], v[84:85] op_sel:[0,1] op_sel_hi:[1,1]
    v_pk_mul_f32 v[50:51], v[50:51], v[84:85] op_sel:[0,1] op_sel_hi:[1,1]
    v_pk_mul_f32 v[52:53], v[52:53], v[84:85] op_sel:[0,1] op_sel_hi:[1,1]
    v_pk_mul_f32 v[54:55], v[54:55], v[84:85] op_sel:[0,1] op_sel_hi:[1,1]
    ds_write_b64 v123, v[112:113] offset:4416
    ds_write_b64 v123, v[114:115] offset:4448
    v_cvt_pk_bf16_f32 v96, v48, v49
    v_cvt_pk_bf16_f32 v97, v50, v51
    v_cvt_pk_bf16_f32 v98, v52, v53
    v_cvt_pk_bf16_f32 v99, v54, v55
    v_pk_mul_f32 v[56:57], v[56:57], v[84:85] op_sel:[0,1] op_sel_hi:[1,1]
    v_pk_mul_f32 v[58:59], v[58:59], v[84:85] op_sel:[0,1] op_sel_hi:[1,1]
    v_pk_mul_f32 v[60:61], v[60:61], v[84:85] op_sel:[0,1] op_sel_hi:[1,1]
    v_pk_mul_f32 v[62:63], v[62:63], v[84:85] op_sel:[0,1] op_sel_hi:[1,1]
    ds_write_b64 v123, v[96:97] offset:4480
    ds_write_b64 v123, v[98:99] offset:4512
    v_cvt_pk_bf16_f32 v112, v56, v57
    v_cvt_pk_bf16_f32 v113, v58, v59
    v_cvt_pk_bf16_f32 v114, v60, v61
    v_cvt_pk_bf16_f32 v115, v62, v63
    ds_write_b64 v123, v[112:113] offset:4544
    ds_write_b64 v123, v[114:115] offset:4576
    ds_read_b128 v[0:3], v124 offset:4352
    ds_read_b128 v[4:7], v124 offset:5440
    ds_read_b128 v[8:11], v124 offset:6528
    ds_read_b128 v[12:15], v124 offset:7616
    v_accvgpr_read_b32 v88, a192
    v_accvgpr_read_b32 v89, a193
    v_accvgpr_read_b32 v90, a194
    v_accvgpr_read_b32 v91, a195
    v_accvgpr_read_b32 v92, a196
    v_accvgpr_read_b32 v93, a197
    v_accvgpr_read_b32 v94, a198
    v_accvgpr_read_b32 v95, a199
    v_pk_mul_f32 v[88:89], v[88:89], v[86:87] op_sel:[0,0] op_sel_hi:[1,0]
    v_pk_mul_f32 v[90:91], v[90:91], v[86:87] op_sel:[0,0] op_sel_hi:[1,0]
    v_pk_mul_f32 v[92:93], v[92:93], v[86:87] op_sel:[0,0] op_sel_hi:[1,0]
    v_pk_mul_f32 v[94:95], v[94:95], v[86:87] op_sel:[0,0] op_sel_hi:[1,0]
    v_cvt_pk_bf16_f32 v96, v88, v89
    v_cvt_pk_bf16_f32 v97, v90, v91
    v_cvt_pk_bf16_f32 v98, v92, v93
    v_cvt_pk_bf16_f32 v99, v94, v95
    v_accvgpr_read_b32 v104, a200
    v_accvgpr_read_b32 v105, a201
    v_accvgpr_read_b32 v106, a202
    v_accvgpr_read_b32 v107, a203
    v_accvgpr_read_b32 v108, a204
    v_accvgpr_read_b32 v109, a205
    v_accvgpr_read_b32 v110, a206
    v_accvgpr_read_b32 v111, a207
    s_waitcnt lgkmcnt(0)
    buffer_store_dwordx4 v[0:3], v122, s[24:27], s39 offen offset:0 sc1 nt
    buffer_store_dwordx4 v[4:7], v122, s[24:27], s39 offen offset:1024 sc1 nt
    buffer_store_dwordx4 v[8:11], v122, s[24:27], s39 offen offset:2048 sc1 nt
    buffer_store_dwordx4 v[12:15], v122, s[24:27], s39 offen offset:3072 sc1 nt
    s_add_u32 s39, s39, 4096
    v_pk_mul_f32 v[104:105], v[104:105], v[86:87] op_sel:[0,0] op_sel_hi:[1,0]
    v_pk_mul_f32 v[106:107], v[106:107], v[86:87] op_sel:[0,0] op_sel_hi:[1,0]
    v_pk_mul_f32 v[108:109], v[108:109], v[86:87] op_sel:[0,0] op_sel_hi:[1,0]
    v_pk_mul_f32 v[110:111], v[110:111], v[86:87] op_sel:[0,0] op_sel_hi:[1,0]
    ds_write_b64 v123, v[96:97] offset:0
    ds_write_b64 v123, v[98:99] offset:32
    v_cvt_pk_bf16_f32 v112, v104, v105
    v_cvt_pk_bf16_f32 v113, v106, v107
    v_cvt_pk_bf16_f32 v114, v108, v109
    v_cvt_pk_bf16_f32 v115, v110, v111
    v_accvgpr_read_b32 v88, a208
    v_accvgpr_read_b32 v89, a209
    v_accvgpr_read_b32 v90, a210
    v_accvgpr_read_b32 v91, a211
    v_accvgpr_read_b32 v92, a212
    v_accvgpr_read_b32 v93, a213
    v_accvgpr_read_b32 v94, a214
    v_accvgpr_read_b32 v95, a215
    v_pk_mul_f32 v[88:89], v[88:89], v[86:87] op_sel:[0,0] op_sel_hi:[1,0]
    v_pk_mul_f32 v[90:91], v[90:91], v[86:87] op_sel:[0,0] op_sel_hi:[1,0]
    v_pk_mul_f32 v[92:93], v[92:93], v[86:87] op_sel:[0,0] op_sel_hi:[1,0]
    v_pk_mul_f32 v[94:95], v[94:95], v[86:87] op_sel:[0,0] op_sel_hi:[1,0]
    ds_write_b64 v123, v[112:113] offset:64
    ds_write_b64 v123, v[114:115] offset:96
    v_cvt_pk_bf16_f32 v96, v88, v89
    v_cvt_pk_bf16_f32 v97, v90, v91
    v_cvt_pk_bf16_f32 v98, v92, v93
    v_cvt_pk_bf16_f32 v99, v94, v95
    v_accvgpr_read_b32 v104, a216
    v_accvgpr_read_b32 v105, a217
    v_accvgpr_read_b32 v106, a218
    v_accvgpr_read_b32 v107, a219
    v_accvgpr_read_b32 v108, a220
    v_accvgpr_read_b32 v109, a221
    v_accvgpr_read_b32 v110, a222
    v_accvgpr_read_b32 v111, a223
    v_pk_mul_f32 v[104:105], v[104:105], v[86:87] op_sel:[0,0] op_sel_hi:[1,0]
    v_pk_mul_f32 v[106:107], v[106:107], v[86:87] op_sel:[0,0] op_sel_hi:[1,0]
    v_pk_mul_f32 v[108:109], v[108:109], v[86:87] op_sel:[0,0] op_sel_hi:[1,0]
    v_pk_mul_f32 v[110:111], v[110:111], v[86:87] op_sel:[0,0] op_sel_hi:[1,0]
    ds_write_b64 v123, v[96:97] offset:128
    ds_write_b64 v123, v[98:99] offset:160
    v_cvt_pk_bf16_f32 v112, v104, v105
    v_cvt_pk_bf16_f32 v113, v106, v107
    v_cvt_pk_bf16_f32 v114, v108, v109
    v_cvt_pk_bf16_f32 v115, v110, v111
    ds_write_b64 v123, v[112:113] offset:192
    ds_write_b64 v123, v[114:115] offset:224
    ds_read_b128 v[16:19], v124 offset:0
    ds_read_b128 v[20:23], v124 offset:1088
    ds_read_b128 v[24:27], v124 offset:2176
    ds_read_b128 v[28:31], v124 offset:3264
    s_waitcnt lgkmcnt(0)
    buffer_store_dwordx4 v[16:19], v122, s[24:27], s39 offen offset:0 sc1 nt
    buffer_store_dwordx4 v[20:23], v122, s[24:27], s39 offen offset:1024 sc1 nt
    buffer_store_dwordx4 v[24:27], v122, s[24:27], s39 offen offset:2048 sc1 nt
    buffer_store_dwordx4 v[28:31], v122, s[24:27], s39 offen offset:3072 sc1 nt
    s_add_u32 s39, s39, 4096
L_fin:
    v_mov_b32 v64, 143360
    s_cmp_eq_u64 s[48:49], 0
    s_cbranch_scc1 L_good
    v_mov_b32 v65, 1
    ds_write_b32 v64, v65 offset:0
L_good:
    s_waitcnt lgkmcnt(0)
    s_barrier
    ds_read_b32 v65, v64 offset:0
    s_waitcnt lgkmcnt(0)
    v_readfirstlane_b32 s36, v65
    s_nop 3
    s_andn2_b32 s36, s36, s40
    s_cmp_eq_u32 s36, 0
    s_cbranch_scc1 L_done
    s_mov_b32 s40, 1
    v_lshrrev_b32 v37, 8, v122
    v_and_b32 v36, 0xf0, v122
    v_lshlrev_b32 v36, 4, v36
    v_lshl_add_u32 v36, v37, 4, v36
    v_mov_b32 v80, 0xff800000
    v_mov_b32 v81, 0xff800000
    v_mov_b32 v82, 0xff800000
    v_mov_b32 v83, 0xff800000
    v_mov_b32 v84, 0xff800000
    v_mov_b32 v85, 0xff800000
    v_mov_b32 v86, 0xff800000
    v_mov_b32 v87, 0xff800000
    s_mov_b32 s36, 0
L_full:
    buffer_load_dwordx4 v[40:43], v36, s[16:19], s36 offen offset:0
    buffer_load_dwordx4 v[44:47], v36, s[16:19], s36 offen offset:64
    buffer_load_dwordx4 v[48:51], v36, s[16:19], s36 offen offset:128
    buffer_load_dwordx4 v[52:55], v36, s[16:19], s36 offen offset:192
    s_waitcnt vmcnt(0)
    v_mfma_f32_16x16x32_bf16 v[64:67], v[40:43], v[128:131], 0
    v_mfma_f32_16x16x32_bf16 v[64:67], v[44:47], v[132:135], v[64:67]
    v_mfma_f32_16x16x32_bf16 v[64:67], v[48:51], v[136:139], v[64:67]
    v_mfma_f32_16x16x32_bf16 v[64:67], v[52:55], v[140:143], v[64:67]
    s_nop 7
    v_max3_f32 v80, v80, v64, v65
    v_max3_f32 v80, v80, v66, v67
    v_mfma_f32_16x16x32_bf16 v[68:71], v[40:43], v[144:147], 0
    v_mfma_f32_16x16x32_bf16 v[68:71], v[44:47], v[148:151], v[68:71]
    v_mfma_f32_16x16x32_bf16 v[68:71], v[48:51], v[152:155], v[68:71]
    v_mfma_f32_16x16x32_bf16 v[68:71], v[52:55], v[156:159], v[68:71]
    s_nop 7
    v_max3_f32 v81, v81, v68, v69
    v_max3_f32 v81, v81, v70, v71
    v_mfma_f32_16x16x32_bf16 v[64:67], v[40:43], v[160:163], 0
    v_mfma_f32_16x16x32_bf16 v[64:67], v[44:47], v[164:167], v[64:67]
    v_mfma_f32_16x16x32_bf16 v[64:67], v[48:51], v[168:171], v[64:67]
    v_mfma_f32_16x16x32_bf16 v[64:67], v[52:55], v[172:175], v[64:67]
    s_nop 7
    v_max3_f32 v82, v82, v64, v65
    v_max3_f32 v82, v82, v66, v67
    v_mfma_f32_16x16x32_bf16 v[68:71], v[40:43], v[176:179], 0
    v_mfma_f32_16x16x32_bf16 v[68:71], v[44:47], v[180:183], v[68:71]
    v_mfma_f32_16x16x32_bf16 v[68:71], v[48:51], v[184:187], v[68:71]
    v_mfma_f32_16x16x32_bf16 v[68:71], v[52:55], v[188:191], v[68:71]
    s_nop 7
    v_max3_f32 v83, v83, v68, v69
    v_max3_f32 v83, v83, v70, v71
    v_mfma_f32_16x16x32_bf16 v[64:67], v[40:43], v[192:195], 0
    v_mfma_f32_16x16x32_bf16 v[64:67], v[44:47], v[196:199], v[64:67]
    v_mfma_f32_16x16x32_bf16 v[64:67], v[48:51], v[200:203], v[64:67]
    v_mfma_f32_16x16x32_bf16 v[64:67], v[52:55], v[204:207], v[64:67]
    s_nop 7
    v_max3_f32 v84, v84, v64, v65
    v_max3_f32 v84, v84, v66, v67
    v_mfma_f32_16x16x32_bf16 v[68:71], v[40:43], v[208:211], 0
    v_mfma_f32_16x16x32_bf16 v[68:71], v[44:47], v[212:215], v[68:71]
    v_mfma_f32_16x16x32_bf16 v[68:71], v[48:51], v[216:219], v[68:71]
    v_mfma_f32_16x16x32_bf16 v[68:71], v[52:55], v[220:223], v[68:71]
    s_nop 7
    v_max3_f32 v85, v85, v68, v69
    v_max3_f32 v85, v85, v70, v71
    v_mfma_f32_16x16x32_bf16 v[64:67], v[40:43], v[224:227], 0
    v_mfma_f32_16x16x32_bf16 v[64:67], v[44:47], v[228:231], v[64:67]
    v_mfma_f32_16x16x32_bf16 v[64:67], v[48:51], v[232:235], v[64:67]
    v_mfma_f32_16x16x32_bf16 v[64:67], v[52:55], v[236:239], v[64:67]
    s_nop 7
    v_max3_f32 v86, v86, v64, v65
    v_max3_f32 v86, v86, v66, v67
    v_mfma_f32_16x16x32_bf16 v[68:71], v[40:43], v[240:243], 0
    v_mfma_f32_16x16x32_bf16 v[68:71], v[44:47], v[244:247], v[68:71]
    v_mfma_f32_16x16x32_bf16 v[68:71], v[48:51], v[248:251], v[68:71]
    v_mfma_f32_16x16x32_bf16 v[68:71], v[52:55], v[252:255], v[68:71]
    s_nop 7
    v_max3_f32 v87, v87, v68, v69
    v_max3_f32 v87, v87, v70, v71
    s_add_u32 s36, s36, 4096
    s_cmp_lt_u32 s36, 262144
    s_cbranch_scc1 L_full
    v_lshrrev_b32 v36, 2, v122
    s_lshl_b32 s36, s28, 11
    v_add_u32 v36, s36, v36
    v_add_u32 v36, 135168, v36
    v_mov_b32 v37, v80
    s_nop 1
    v_permlane32_swap_b32 v80, v37
    v_max_f32 v80, v80, v37
    v_mov_b32 v37, v80
    s_nop 1
    v_permlane16_swap_b32 v80, v37
    v_max_f32 v80, v80, v37
    v_sub_f32 v80, 0, v80
    ds_write_b32 v36, v80 offset:0
    v_mov_b32 v37, v81
    s_nop 1
    v_permlane32_swap_b32 v81, v37
    v_max_f32 v81, v81, v37
    v_mov_b32 v37, v81
    s_nop 1
    v_permlane16_swap_b32 v81, v37
    v_max_f32 v81, v81, v37
    v_sub_f32 v81, 0, v81
    ds_write_b32 v36, v81 offset:256
    v_mov_b32 v37, v82
    s_nop 1
    v_permlane32_swap_b32 v82, v37
    v_max_f32 v82, v82, v37
    v_mov_b32 v37, v82
    s_nop 1
    v_permlane16_swap_b32 v82, v37
    v_max_f32 v82, v82, v37
    v_sub_f32 v82, 0, v82
    ds_write_b32 v36, v82 offset:512
    v_mov_b32 v37, v83
    s_nop 1
    v_permlane32_swap_b32 v83, v37
    v_max_f32 v83, v83, v37
    v_mov_b32 v37, v83
    s_nop 1
    v_permlane16_swap_b32 v83, v37
    v_max_f32 v83, v83, v37
    v_sub_f32 v83, 0, v83
    ds_write_b32 v36, v83 offset:768
    v_mov_b32 v37, v84
    s_nop 1
    v_permlane32_swap_b32 v84, v37
    v_max_f32 v84, v84, v37
    v_mov_b32 v37, v84
    s_nop 1
    v_permlane16_swap_b32 v84, v37
    v_max_f32 v84, v84, v37
    v_sub_f32 v84, 0, v84
    ds_write_b32 v36, v84 offset:1024
    v_mov_b32 v37, v85
    s_nop 1
    v_permlane32_swap_b32 v85, v37
    v_max_f32 v85, v85, v37
    v_mov_b32 v37, v85
    s_nop 1
    v_permlane16_swap_b32 v85, v37
    v_max_f32 v85, v85, v37
    v_sub_f32 v85, 0, v85
    ds_write_b32 v36, v85 offset:1280
    v_mov_b32 v37, v86
    s_nop 1
    v_permlane32_swap_b32 v86, v37
    v_max_f32 v86, v86, v37
    v_mov_b32 v37, v86
    s_nop 1
    v_permlane16_swap_b32 v86, v37
    v_max_f32 v86, v86, v37
    v_sub_f32 v86, 0, v86
    ds_write_b32 v36, v86 offset:1536
    v_mov_b32 v37, v87
    s_nop 1
    v_permlane32_swap_b32 v87, v37
    v_max_f32 v87, v87, v37
    v_mov_b32 v37, v87
    s_nop 1
    v_permlane16_swap_b32 v87, v37
    v_max_f32 v87, v87, v37
    v_sub_f32 v87, 0, v87
    ds_write_b32 v36, v87 offset:1792
    s_waitcnt lgkmcnt(0)
    s_waitcnt vmcnt(0)
    s_barrier
    s_branch L_restart
L_done:
L_end:
    s_endpgm
.section .rodata,"a"
.p2align 6
.amdhsa_kernel standalone__mha_softmax__near_ridge_kernel
  .amdhsa_next_free_vgpr 512
  .amdhsa_next_free_sgpr 102
  .amdhsa_accum_offset 256
  .amdhsa_group_segment_fixed_size 0
  .amdhsa_kernarg_size 48
  .amdhsa_user_sgpr_count 2
  .amdhsa_user_sgpr_kernarg_segment_ptr 1
  .amdhsa_system_sgpr_workgroup_id_x 1
.end_amdhsa_kernel
```
